```python
import torch

def _softmax(x, axis=-1):
    return torch.softmax(x, dim=axis)
def _gelu(x):
    return torch.nn.functional.gelu(x, approximate="tanh")
def _silu(x):
    return torch.nn.functional.silu(x)
def _sigmoid(x):
    return torch.sigmoid(x)
def _layernorm(x, axis=-1, eps=1e-5):
    m = x.mean(dim=axis, keepdim=True)
    v = x.var(dim=axis, keepdim=True, unbiased=False)
    return (x - m) / torch.sqrt(v + eps)
def _scatter_add(tgt, idx, src, axis=0):
    return tgt.clone().index_add_(axis, idx, src)
def _segment_sum(src, seg, n):
    out = torch.zeros((n,) + src.shape[1:], dtype=src.dtype)
    return out.index_add_(0, seg, src)
def _pad(x, pw):
    flat = tuple(v for pair in reversed(pw) for v in pair)
    return torch.nn.functional.pad(x, flat)

kernel_name = 'concat_heads__mha_block_cached__gqa_block_cached__near_ridge'

def setup_inputs():

    _w = (lambda a: (lambda t: t.to(torch.bfloat16) if t.is_floating_point() else t)(torch.as_tensor(a)))
    def _A_setup():
        B, Sq, D = 8, 96, 512
        H, Sk, Dh = 32, 1024, 128
        return {
            "x": _w((lambda *s: torch.randn(*s, dtype=torch.bfloat16) * 0.8)(B, Sq, D)),
            "k_cache": _w((lambda *s: torch.randn(*s, dtype=torch.bfloat16) * 0.8)(B, H, Sk, Dh)),
            "v_cache": _w((lambda *s: torch.randn(*s, dtype=torch.bfloat16) * 0.05)(B, H, Sk, Dh)),
            "wq": _w((lambda *s: torch.randn(*s, dtype=torch.bfloat16) * 0.8)(D, H * Dh) * (D ** -0.5)),
            "wo": _w((lambda *s: torch.randn(*s, dtype=torch.bfloat16) * 0.05)(H * Dh, D) * ((H * Dh) ** -0.5)),
        }
    _A_in = _A_setup()

    def _B_setup():
        B, Sq, D = 8, 96, 512
        Hq, Hkv, Sk, Dh = 32, 32, 1024, 128
        assert Hq % Hkv == 0, (Hq, Hkv)
        return {
            "x": _w((lambda *s: torch.randn(*s, dtype=torch.bfloat16) * 0.8)(B, Sq, D)),
            "k_cache": _w((lambda *s: torch.randn(*s, dtype=torch.bfloat16) * 0.8)(B, Hkv, Sk, Dh)),
            "v_cache": _w((lambda *s: torch.randn(*s, dtype=torch.bfloat16) * 0.05)(B, Hkv, Sk, Dh)),
            "wq": _w((lambda *s: torch.randn(*s, dtype=torch.bfloat16) * 0.8)(D, Hq * Dh) * (D ** -0.5)),
            "wo": _w((lambda *s: torch.randn(*s, dtype=torch.bfloat16) * 0.05)(Hq * Dh, D) * ((Hq * Dh) ** -0.5)),
        }
    _B_in = _B_setup()

    return {
        "A_x": _A_in["x"],
        "A_k_cache": _A_in["k_cache"],
        "A_v_cache": _A_in["v_cache"],
        "A_wq": _A_in["wq"],
        "A_wo": _A_in["wo"],
        "B_x": _B_in["x"],
        "B_k_cache": _B_in["k_cache"],
        "B_v_cache": _B_in["v_cache"],
        "B_wq": _B_in["wq"],
        "B_wo": _B_in["wo"],
    }

def reference(A_x, A_k_cache, A_v_cache, A_wq, A_wo, B_x, B_k_cache, B_v_cache, B_wq, B_wo):
    def _A_ref(x, k_cache, v_cache, wq, wo):
        B, Sq, D = x.shape
        H, Dh = 32, 128
        q = (lambda x, *d: x.permute(*d))((x @ wq).reshape(B, Sq, H, Dh), 0, 2, 1, 3)
        scores = torch.einsum("bhqd,bhkd->bhqk", q, k_cache) * (Dh ** -0.5)
        p = _softmax(scores, axis=-1)
        o = torch.einsum("bhqk,bhkd->bhqd", p, v_cache)
        return (lambda x, *d: x.permute(*d))(o, 0, 2, 1, 3).reshape(B, Sq, H * Dh) @ wo

    def _B_ref(x, k_cache, v_cache, wq, wo):
        B, Sq, D = x.shape
        Hq, Dh = 32, 128
        Hkv = k_cache.shape[1]
        rep = Hq // Hkv
        q = (lambda x, *d: x.permute(*d))((x @ wq).reshape(B, Sq, Hq, Dh), 0, 2, 1, 3)
        k = (lambda x, n, axis: torch.repeat_interleave(x, n, dim=axis))(k_cache, rep, axis=1)
        v = (lambda x, n, axis: torch.repeat_interleave(x, n, dim=axis))(v_cache, rep, axis=1)
        scores = torch.einsum("bhqd,bhkd->bhqk", q, k) * (Dh ** -0.5)
        p = _softmax(scores, axis=-1)
        o = torch.einsum("bhqk,bhkd->bhqd", p, v)
        return (lambda x, *d: x.permute(*d))(o, 0, 2, 1, 3).reshape(B, Sq, Hq * Dh) @ wo

    a = _A_ref(A_x, A_k_cache, A_v_cache, A_wq, A_wo)
    b = _B_ref(B_x, B_k_cache, B_v_cache, B_wq, B_wo)
    return torch.concatenate([a, b], axis=-1)
```

```asm
; @launch grid=(256,1,1) block=(256,1,1) lds=163840
.amdgcn_target "amdgcn-amd-amdhsa--gfx950"
.text
.globl concat_heads__mha_block_cached__gqa_block_cached__near_ridge_kernel
.p2align 8
.type concat_heads__mha_block_cached__gqa_block_cached__near_ridge_kernel,@function
concat_heads__mha_block_cached__gqa_block_cached__near_ridge_kernel:
    s_cmp_ge_u32 s2, 256
    s_cbranch_scc1 L_end
    s_load_dwordx16 s[40:55], s[0:1], 0
    s_load_dwordx4 s[56:59], s[0:1], 64
    s_load_dwordx4 s[60:63], s[0:1], 80
    s_load_dwordx2 s[64:65], s[0:1], 96
    v_lshrrev_b32 v59, 6, v0
    v_and_b32 v1, 63, v0
    v_readfirstlane_b32 s3, v59
    s_and_b32 s30, s2, 7
    s_lshr_b32 s32, s2, 3
    s_and_b32 s38, s32, 3
    s_bfe_u32 s34, s32, 0x20002
    s_lshr_b32 s99, s32, 4
    s_lshl_b32 s39, s30, 2
    s_add_u32 s39, s39, s34
    s_lshl_b32 s35, s3, 13
    s_add_u32 s34, s34, 2
    s_and_b32 s34, s34, 3
    v_lshrrev_b32 v59, 4, v1
    v_and_b32 v60, 15, v1
    v_lshlrev_b32 v61, 2, v59
    v_xor_b32 v61, v61, v60
    v_xor_b32 v62, 0, v61
    v_lshlrev_b32 v62, 4, v62
    v_lshl_add_u32 v2, v59, 8, v62
    v_xor_b32 v62, 1, v61
    v_lshlrev_b32 v62, 4, v62
    v_lshl_add_u32 v3, v59, 8, v62
    v_xor_b32 v62, 2, v61
    v_lshlrev_b32 v62, 4, v62
    v_lshl_add_u32 v4, v59, 8, v62
    v_xor_b32 v62, 3, v61
    v_lshlrev_b32 v62, 4, v62
    v_lshl_add_u32 v5, v59, 8, v62
    s_and_b32 s31, s3, 1
    s_mul_i32 s31, s31, 48
    v_lshrrev_b32 v59, 3, v1
    v_add_u32 v59, s31, v59
    v_and_b32 v60, 7, v1
    v_lshlrev_b32 v59, 10, v59
    v_lshl_add_u32 v34, v60, 4, v59
    s_lshl_b32 s31, s3, 4
    v_lshrrev_b32 v59, 4, v1
    v_add_u32 v60, s31, v59
    v_and_b32 v61, 15, v1
    v_lshlrev_b32 v60, 13, v60
    v_lshl_add_u32 v35, v61, 4, v60
    s_waitcnt lgkmcnt(0)
    s_cmp_eq_u32 s99, 0
    s_cselect_b32 s40, s40, s50
    s_cselect_b32 s41, s41, s51
    s_cselect_b32 s42, s42, s52
    s_cselect_b32 s43, s43, s53
    s_cselect_b32 s44, s44, s54
    s_cselect_b32 s45, s45, s55
    s_cselect_b32 s46, s46, s56
    s_cselect_b32 s47, s47, s57
    s_cselect_b32 s48, s48, s58
    s_cselect_b32 s49, s49, s59
    s_mov_b32 s4, s40
    s_mov_b32 s5, s41
    s_mov_b32 s6, 786432
    s_mov_b32 s7, 0x20000
    s_mov_b32 s8, s46
    s_mov_b32 s9, s47
    s_mov_b32 s10, 0x400000
    s_mov_b32 s11, 0x20000
    s_lshr_b32 s66, s3, 1
    s_lshl_b32 s66, s66, 2
    s_add_u32 s66, s66, s38
    s_mul_i32 s66, s66, 98304
    s_lshl_b32 s68, s39, 8
    s_add_u32 s77, s38, s39
    s_and_b32 s77, s77, 3
    s_lshl_b32 s77, s77, 3
    s_and_b32 s77, s77, 7
    s_lshl_b32 s31, s77, 7
    s_add_u32 s31, s31, s66
    buffer_load_dwordx4 a[0:3], v34, s[4:7], s31 offen sc1
    s_add_u32 s31, s31, 8192
    buffer_load_dwordx4 a[4:7], v34, s[4:7], s31 offen sc1
    s_add_u32 s31, s31, 8192
    buffer_load_dwordx4 a[8:11], v34, s[4:7], s31 offen sc1
    s_add_u32 s31, s31, 8192
    buffer_load_dwordx4 a[12:15], v34, s[4:7], s31 offen sc1
    s_add_u32 s31, s31, 8192
    buffer_load_dwordx4 a[16:19], v34, s[4:7], s31 offen sc1
    s_add_u32 s31, s31, 8192
    buffer_load_dwordx4 a[20:23], v34, s[4:7], s31 offen sc1
    s_lshl_b32 s31, s77, 19
    s_add_u32 s31, s31, s68
    buffer_load_dwordx4 a[24:27], v35, s[8:11], s31 offen nt
    s_add_u32 s31, s31, 32768
    buffer_load_dwordx4 a[28:31], v35, s[8:11], s31 offen nt
    s_add_u32 s31, s31, 32768
    buffer_load_dwordx4 a[32:35], v35, s[8:11], s31 offen nt
    s_add_u32 s31, s31, 32768
    buffer_load_dwordx4 a[36:39], v35, s[8:11], s31 offen nt
    s_add_u32 s77, s77, 1
    s_and_b32 s77, s77, 7
    s_lshl_b32 s31, s77, 7
    s_add_u32 s31, s31, s66
    buffer_load_dwordx4 a[40:43], v34, s[4:7], s31 offen sc1
    s_add_u32 s31, s31, 8192
    buffer_load_dwordx4 a[44:47], v34, s[4:7], s31 offen sc1
    s_add_u32 s31, s31, 8192
    buffer_load_dwordx4 a[48:51], v34, s[4:7], s31 offen sc1
    s_add_u32 s31, s31, 8192
    buffer_load_dwordx4 a[52:55], v34, s[4:7], s31 offen sc1
    s_add_u32 s31, s31, 8192
    buffer_load_dwordx4 a[56:59], v34, s[4:7], s31 offen sc1
    s_add_u32 s31, s31, 8192
    buffer_load_dwordx4 a[60:63], v34, s[4:7], s31 offen sc1
    s_lshl_b32 s31, s77, 19
    s_add_u32 s31, s31, s68
    buffer_load_dwordx4 a[64:67], v35, s[8:11], s31 offen nt
    s_add_u32 s31, s31, 32768
    buffer_load_dwordx4 a[68:71], v35, s[8:11], s31 offen nt
    s_add_u32 s31, s31, 32768
    buffer_load_dwordx4 a[72:75], v35, s[8:11], s31 offen nt
    s_add_u32 s31, s31, 32768
    buffer_load_dwordx4 a[76:79], v35, s[8:11], s31 offen nt
    s_add_u32 s77, s77, 1
    s_and_b32 s77, s77, 7
    s_lshl_b32 s31, s77, 7
    s_add_u32 s31, s31, s66
    buffer_load_dwordx4 a[80:83], v34, s[4:7], s31 offen sc1
    s_add_u32 s31, s31, 8192
    buffer_load_dwordx4 a[84:87], v34, s[4:7], s31 offen sc1
    s_add_u32 s31, s31, 8192
    buffer_load_dwordx4 a[88:91], v34, s[4:7], s31 offen sc1
    s_add_u32 s31, s31, 8192
    buffer_load_dwordx4 a[92:95], v34, s[4:7], s31 offen sc1
    s_add_u32 s31, s31, 8192
    buffer_load_dwordx4 a[96:99], v34, s[4:7], s31 offen sc1
    s_add_u32 s31, s31, 8192
    buffer_load_dwordx4 a[100:103], v34, s[4:7], s31 offen sc1
    s_lshl_b32 s31, s77, 19
    s_add_u32 s31, s31, s68
    buffer_load_dwordx4 a[104:107], v35, s[8:11], s31 offen nt
    s_add_u32 s31, s31, 32768
    buffer_load_dwordx4 a[108:111], v35, s[8:11], s31 offen nt
    s_add_u32 s31, s31, 32768
    buffer_load_dwordx4 a[112:115], v35, s[8:11], s31 offen nt
    s_add_u32 s31, s31, 32768
    buffer_load_dwordx4 a[116:119], v35, s[8:11], s31 offen nt
    s_add_u32 s77, s77, 1
    s_and_b32 s77, s77, 7
    s_mov_b32 s12, s42
    s_mov_b32 s13, s43
    s_mov_b32 s14, 0x4000000
    s_mov_b32 s15, 0x20000
    s_mov_b32 s16, s44
    s_mov_b32 s17, s45
    s_mov_b32 s18, 0x4000000
    s_mov_b32 s19, 0x20000
    s_mov_b32 s20, s64
    s_mov_b32 s21, s65
    s_mov_b32 s22, 12582912
    s_mov_b32 s23, 0x20000
    s_add_u32 s24, s64, 16777216
    s_addc_u32 s25, s65, 0
    s_mov_b32 s26, 12582912
    s_mov_b32 s27, 0x20000
    s_lshl_b32 s98, s38, 5
    s_add_u32 s98, s98, s39
    s_lshl_b32 s98, s98, 18
    s_add_u32 s98, s98, s35
    s_add_u32 s74, s98, 0
    s_mov_b32 s75, s74
    s_mov_b32 s76, 0
    s_lshl_b32 s95, s30, 19
    s_lshl_b32 s31, s3, 15
    s_add_u32 s95, s95, s31
    s_lshl_b32 s31, s34, 8
    s_add_u32 s95, s95, s31
    s_or_b32 s31, s2, s3
    s_cmp_lg_u32 s31, 0
    s_cbranch_scc1 Ltag_1
    s_memrealtime s[32:33]
    s_waitcnt lgkmcnt(0)
    s_or_b32 s32, s32, 1
    v_mov_b32 v59, 0
    v_mov_b32 v60, s32
    s_mov_b64 exec, 1
    global_store_dword v59, v60, s[62:63] sc1
    s_mov_b64 exec, -1
Ltag_1:
    s_lshl_b32 s32, s34, 2
    s_add_u32 s32, s32, s38
    s_lshl_b32 s32, s32, 1
    s_and_b32 s78, s3, 1
    s_add_u32 s32, s32, s78
    s_lshl_b32 s32, s32, 4
    v_and_b32 v248, 15, v1
    v_add_u32 v248, s32, v248
    s_cmp_lt_u32 s3, 2
    s_cselect_b32 s32, 13, 10
    s_cselect_b32 s78, 10, 19
    s_cselect_b32 s92, s46, s48
    s_cselect_b32 s93, s47, s49
    s_mov_b32 s94, 0x400000
    s_mov_b32 s101, s95
    s_mov_b32 s95, 0x20000
    v_lshlrev_b32 v248, s32, v248
    s_lshl_b32 s78, s30, s78
    s_add_u32 s78, s78, 384
    buffer_load_dword v255, v248, s[92:95], s78 offen
    s_mov_b32 s95, s101
    v_and_b32 v59, 31, v1
    v_and_b32 v60, 0x13, v59
    v_and_b32 v61, 4, v59
    v_lshl_or_b32 v60, v61, 1, v60
    v_and_b32 v61, 8, v59
    v_lshrrev_b32 v61, 1, v61
    v_or_b32 v60, v60, v61
    v_and_b32 v61, 3, v60
    v_lshlrev_b32 v61, 2, v61
    v_bfe_u32 v62, v60, 2, 2
    v_or_b32 v61, v61, v62
    v_lshrrev_b32 v62, 5, v1
    v_lshlrev_b32 v63, 8, v60
    v_add_u32 v63, s35, v63
    v_add_u32 v248, 0, v62
    v_xor_b32 v248, v248, v61
    v_lshl_add_u32 v8, v248, 4, v63
    v_add_u32 v248, 2, v62
    v_xor_b32 v248, v248, v61
    v_lshl_add_u32 v9, v248, 4, v63
    v_add_u32 v248, 4, v62
    v_xor_b32 v248, v248, v61
    v_lshl_add_u32 v10, v248, 4, v63
    v_add_u32 v248, 6, v62
    v_xor_b32 v248, v248, v61
    v_lshl_add_u32 v11, v248, 4, v63
    v_add_u32 v248, 8, v62
    v_xor_b32 v248, v248, v61
    v_lshl_add_u32 v12, v248, 4, v63
    v_add_u32 v248, 10, v62
    v_xor_b32 v248, v248, v61
    v_lshl_add_u32 v13, v248, 4, v63
    v_add_u32 v248, 12, v62
    v_xor_b32 v248, v248, v61
    v_lshl_add_u32 v14, v248, 4, v63
    v_add_u32 v248, 14, v62
    v_xor_b32 v248, v248, v61
    v_lshl_add_u32 v15, v248, 4, v63
    v_lshrrev_b32 v59, 5, v1
    v_bfe_u32 v60, v1, 2, 2
    v_xor_b32 v61, s3, v60
    v_lshlrev_b32 v61, 2, v61
    v_bfe_u32 v62, v1, 4, 1
    v_lshlrev_b32 v62, 1, v62
    v_and_b32 v63, 1, v1
    v_add_u32 v62, v62, v63
    v_bfe_u32 v63, v1, 1, 1
    v_lshl_add_u32 v248, v59, 1, 0
    v_xor_b32 v248, v248, v62
    v_add_u32 v248, v248, v61
    v_lshlrev_b32 v248, 4, v248
    v_lshl_add_u32 v248, v63, 3, v248
    v_lshl_add_u32 v249, v59, 3, v60
    v_add_u32 v249, 0, v249
    v_lshl_add_u32 v24, v249, 8, v248
    v_lshl_add_u32 v248, v59, 1, 1
    v_xor_b32 v248, v248, v62
    v_add_u32 v248, v248, v61
    v_lshlrev_b32 v248, 4, v248
    v_lshl_add_u32 v248, v63, 3, v248
    v_lshl_add_u32 v249, v59, 3, v60
    v_add_u32 v249, 4, v249
    v_lshl_add_u32 v25, v249, 8, v248
    v_add_u32 v248, v61, v62
    v_lshlrev_b32 v248, 4, v248
    v_lshl_add_u32 v248, v63, 3, v248
    v_lshl_add_u32 v249, v59, 3, v60
    v_lshl_add_u32 v248, v249, 8, v248
    v_add_u32 v44, 122880, v248
    s_mul_i32 s31, s3, 6144
    v_lshlrev_b32 v248, 4, v1
    v_add_u32 v29, 98304, v248
    v_add_u32 v28, s31, v29
    v_add_u32 v46, s31, v248
    s_mul_i32 s31, s3, 48
    v_lshrrev_b32 v59, 3, v1
    v_add_u32 v59, s31, v59
    v_and_b32 v60, 7, v1
    v_lshrrev_b32 v61, 4, v1
    v_add_u32 v62, 0, v61
    v_xor_b32 v62, v62, v60
    v_lshlrev_b32 v62, 4, v62
    v_lshl_add_u32 v62, v59, 7, v62
    v_add_u32 v36, 98304, v62
    v_add_u32 v62, 4, v61
    v_xor_b32 v62, v62, v60
    v_lshlrev_b32 v62, 4, v62
    v_lshl_add_u32 v62, v59, 7, v62
    v_add_u32 v37, 98304, v62
    s_lshl_b32 s31, s3, 4
    v_lshrrev_b32 v59, 4, v1
    v_add_u32 v60, s31, v59
    v_and_b32 v61, 15, v1
    v_lshlrev_b32 v62, 2, v59
    v_xor_b32 v62, v62, v61
    v_lshlrev_b32 v62, 4, v62
    v_lshl_add_u32 v62, v60, 8, v62
    v_add_u32 v39, 122880, v62
    v_and_b32 v59, 31, v1
    v_lshrrev_b32 v60, 5, v1
    v_lshrrev_b32 v61, 1, v59
    v_and_b32 v61, 7, v61
    v_add_u32 v62, 0, v60
    v_xor_b32 v62, v62, v61
    v_lshlrev_b32 v62, 4, v62
    v_lshl_add_u32 v62, v59, 7, v62
    v_add_u32 v40, 98304, v62
    v_add_u32 v62, 2, v60
    v_xor_b32 v62, v62, v61
    v_lshlrev_b32 v62, 4, v62
    v_lshl_add_u32 v62, v59, 7, v62
    v_add_u32 v41, 98304, v62
    v_add_u32 v62, 4, v60
    v_xor_b32 v62, v62, v61
    v_lshlrev_b32 v62, 4, v62
    v_lshl_add_u32 v62, v59, 7, v62
    v_add_u32 v42, 98304, v62
    v_add_u32 v62, 6, v60
    v_xor_b32 v62, v62, v61
    v_lshlrev_b32 v62, 4, v62
    v_lshl_add_u32 v62, v59, 7, v62
    v_add_u32 v43, 98304, v62
    v_lshlrev_b32 v61, 5, v59
    v_add_u32 v49, 151552, v61
    s_lshl_b32 s31, s3, 3
    v_lshl_add_u32 v61, v60, 2, v49
    v_add_u32 v48, s31, v61
    v_mov_b32 v6, 154624
    v_mov_b32 v7, 0
    ds_write_b32 v6, v7
    s_mov_b32 s36, 0x3e0293ee
    s_mov_b32 s37, 0x43800000
    s_mov_b32 s71, 0
    s_mov_b32 s29, 32768
    s_mov_b32 s92, 65536
    v_add_u32 v80, 0xffff8000, v36
    v_add_u32 v81, 0xffff8000, v37
    s_mov_b32 s31, 0xffff8000
    s_mov_b32 s32, 0x6000
    s_cmp_lt_u32 s3, 2
    s_cselect_b32 s31, s31, s32
    v_add_u32 v82, s31, v39
    v_add_u32 v83, 0xffff8000, v40
    v_add_u32 v84, 0xffff8000, v41
    v_add_u32 v85, 0xffff8000, v42
    v_add_u32 v86, 0xffff8000, v43
    v_add_u32 v87, 0xffff8000, v44
    v_add_u32 v88, 0x6000, v44
    s_waitcnt vmcnt(20)
    ds_write_b128 v36, a[0:3] offset:0
    ds_write_b128 v37, a[4:7] offset:1024
    ds_write_b128 v36, a[8:11] offset:2048
    ds_write_b128 v37, a[12:15] offset:3072
    ds_write_b128 v36, a[16:19] offset:4096
    ds_write_b128 v37, a[20:23] offset:5120
    ds_write_b128 v39, a[24:27] offset:0
    ds_write_b128 v39, a[28:31] offset:1024
    ds_write_b128 v39, a[32:35] offset:2048
    ds_write_b128 v39, a[36:39] offset:3072
    s_waitcnt lgkmcnt(0)
    s_barrier
    ds_read_b64_tr_b16 v[64:65], v44 offset:0
    ds_read_b64_tr_b16 v[66:67], v44 offset:1024
    ds_read_b128 a[160:163], v40 offset:0
    ds_read_b128 a[164:167], v40 offset:4096
    ds_read_b128 a[168:171], v40 offset:8192
    ds_read_b128 a[172:175], v40 offset:12288
    ds_read_b128 a[176:179], v40 offset:16384
    ds_read_b128 a[180:183], v40 offset:20480
    ds_read_b64_tr_b16 v[68:69], v44 offset:4096
    ds_read_b64_tr_b16 v[70:71], v44 offset:5120
    ds_read_b128 a[184:187], v41 offset:0
    ds_read_b128 a[188:191], v41 offset:4096
    ds_read_b128 a[192:195], v41 offset:8192
    ds_read_b128 a[196:199], v41 offset:12288
    ds_read_b128 a[200:203], v41 offset:16384
    ds_read_b128 a[204:207], v41 offset:20480
    s_waitcnt lgkmcnt(8)
    v_mfma_f32_32x32x16_bf16 v[112:127], v[64:67], a[160:163], 0
    ds_read_b64_tr_b16 v[72:73], v44 offset:8192
    ds_read_b64_tr_b16 v[74:75], v44 offset:9216
    v_mfma_f32_32x32x16_bf16 v[128:143], v[64:67], a[164:167], 0
    ds_read_b128 a[208:211], v42 offset:0
    ds_read_b128 a[212:215], v42 offset:4096
    s_lshl_b32 s31, s77, 7
    s_add_u32 s31, s31, s66
    buffer_load_dwordx4 a[120:123], v34, s[4:7], s31 offen sc1
    v_mfma_f32_32x32x16_bf16 v[144:159], v[64:67], a[168:171], 0
    ds_read_b128 a[216:219], v42 offset:8192
    ds_read_b128 a[220:223], v42 offset:12288
    v_mfma_f32_32x32x16_bf16 v[160:175], v[64:67], a[172:175], 0
    ds_read_b128 a[224:227], v42 offset:16384
    ds_read_b128 a[228:231], v42 offset:20480
    s_add_u32 s31, s31, 8192
    buffer_load_dwordx4 a[124:127], v34, s[4:7], s31 offen sc1
    s_waitcnt vmcnt(12)
    v_mfma_f32_32x32x16_bf16 v[176:191], v[64:67], a[176:179], 0
    ds_read_b64_tr_b16 v[76:77], v44 offset:12288
    ds_read_b64_tr_b16 v[78:79], v44 offset:13312
    v_mfma_f32_32x32x16_bf16 v[192:207], v[64:67], a[180:183], 0
    ds_read_b128 a[232:235], v43 offset:0
    ds_read_b128 a[236:239], v43 offset:4096
    s_add_u32 s31, s31, 8192
    buffer_load_dwordx4 a[128:131], v34, s[4:7], s31 offen sc1
    s_waitcnt lgkmcnt(12)
    v_mfma_f32_32x32x16_bf16 v[112:127], v[68:71], a[184:187], v[112:127]
    ds_read_b128 a[240:243], v43 offset:8192
    ds_read_b128 a[244:247], v43 offset:12288
    v_mfma_f32_32x32x16_bf16 v[128:143], v[68:71], a[188:191], v[128:143]
    ds_read_b128 a[248:251], v43 offset:16384
    ds_read_b128 a[252:255], v43 offset:20480
    s_add_u32 s31, s31, 8192
    buffer_load_dwordx4 a[132:135], v34, s[4:7], s31 offen sc1
    v_mfma_f32_32x32x16_bf16 v[144:159], v[68:71], a[192:195], v[144:159]
    ds_write_b128 v80, a[40:43] offset:0
    v_mfma_f32_32x32x16_bf16 v[160:175], v[68:71], a[196:199], v[160:175]
    ds_write_b128 v81, a[44:47] offset:1024
    s_add_u32 s31, s31, 8192
    buffer_load_dwordx4 a[136:139], v34, s[4:7], s31 offen sc1
    v_mfma_f32_32x32x16_bf16 v[176:191], v[68:71], a[200:203], v[176:191]
    ds_write_b128 v80, a[48:51] offset:2048
    v_mfma_f32_32x32x16_bf16 v[192:207], v[68:71], a[204:207], v[192:207]
    ds_write_b128 v81, a[52:55] offset:3072
    s_add_u32 s31, s31, 8192
    buffer_load_dwordx4 a[140:143], v34, s[4:7], s31 offen sc1
    s_waitcnt lgkmcnt(12)
    v_mfma_f32_32x32x16_bf16 v[112:127], v[72:75], a[208:211], v[112:127]
    ds_write_b128 v80, a[56:59] offset:4096
    v_mfma_f32_32x32x16_bf16 v[128:143], v[72:75], a[212:215], v[128:143]
    ds_write_b128 v81, a[60:63] offset:5120
    s_lshl_b32 s31, s77, 19
    s_add_u32 s31, s31, s68
    buffer_load_dwordx4 a[144:147], v35, s[8:11], s31 offen nt
    v_mfma_f32_32x32x16_bf16 v[144:159], v[72:75], a[216:219], v[144:159]
    ds_write_b128 v82, a[64:67] offset:0
    v_mfma_f32_32x32x16_bf16 v[160:175], v[72:75], a[220:223], v[160:175]
    ds_write_b128 v82, a[68:71] offset:1024
    s_add_u32 s31, s31, 32768
    buffer_load_dwordx4 a[148:151], v35, s[8:11], s31 offen nt
    v_mfma_f32_32x32x16_bf16 v[176:191], v[72:75], a[224:227], v[176:191]
    ds_write_b128 v82, a[72:75] offset:2048
    v_mfma_f32_32x32x16_bf16 v[192:207], v[72:75], a[228:231], v[192:207]
    ds_write_b128 v82, a[76:79] offset:3072
    s_add_u32 s31, s31, 32768
    buffer_load_dwordx4 a[152:155], v35, s[8:11], s31 offen nt
    s_waitcnt lgkmcnt(10)
    v_mfma_f32_32x32x16_bf16 v[112:127], v[76:79], a[232:235], v[112:127]
    v_mfma_f32_32x32x16_bf16 v[128:143], v[76:79], a[236:239], v[128:143]
    s_add_u32 s31, s31, 32768
    buffer_load_dwordx4 a[156:159], v35, s[8:11], s31 offen nt
    v_mfma_f32_32x32x16_bf16 v[144:159], v[76:79], a[240:243], v[144:159]
    v_mfma_f32_32x32x16_bf16 v[160:175], v[76:79], a[244:247], v[160:175]
    s_add_u32 s77, s77, 1
    s_and_b32 s77, s77, 7
    v_mfma_f32_32x32x16_bf16 v[176:191], v[76:79], a[248:251], v[176:191]
    v_mfma_f32_32x32x16_bf16 v[192:207], v[76:79], a[252:255], v[192:207]
    s_waitcnt lgkmcnt(0)
    s_barrier
    ds_read_b64_tr_b16 v[64:65], v87 offset:0
    ds_read_b64_tr_b16 v[66:67], v87 offset:1024
    ds_read_b128 a[160:163], v83 offset:0
    ds_read_b128 a[164:167], v83 offset:4096
    ds_read_b128 a[168:171], v83 offset:8192
    ds_read_b128 a[172:175], v83 offset:12288
    ds_read_b128 a[176:179], v83 offset:16384
    ds_read_b128 a[180:183], v83 offset:20480
    ds_read_b64_tr_b16 v[68:69], v87 offset:4096
    ds_read_b64_tr_b16 v[70:71], v87 offset:5120
    ds_read_b128 a[184:187], v84 offset:0
    ds_read_b128 a[188:191], v84 offset:4096
    ds_read_b128 a[192:195], v84 offset:8192
    ds_read_b128 a[196:199], v84 offset:12288
    ds_read_b128 a[200:203], v84 offset:16384
    ds_read_b128 a[204:207], v84 offset:20480
    s_waitcnt lgkmcnt(8)
    v_mfma_f32_32x32x16_bf16 v[112:127], v[64:67], a[160:163], v[112:127]
    ds_read_b64_tr_b16 v[72:73], v88 offset:8192
    ds_read_b64_tr_b16 v[74:75], v88 offset:9216
    v_mfma_f32_32x32x16_bf16 v[128:143], v[64:67], a[164:167], v[128:143]
    ds_read_b128 a[208:211], v85 offset:0
    ds_read_b128 a[212:215], v85 offset:4096
    s_lshl_b32 s31, s77, 7
    s_add_u32 s31, s31, s66
    buffer_load_dwordx4 a[0:3], v34, s[4:7], s31 offen sc1
    v_mfma_f32_32x32x16_bf16 v[144:159], v[64:67], a[168:171], v[144:159]
    ds_read_b128 a[216:219], v85 offset:8192
    ds_read_b128 a[220:223], v85 offset:12288
    v_mfma_f32_32x32x16_bf16 v[160:175], v[64:67], a[172:175], v[160:175]
    ds_read_b128 a[224:227], v85 offset:16384
    ds_read_b128 a[228:231], v85 offset:20480
    s_add_u32 s31, s31, 8192
    buffer_load_dwordx4 a[4:7], v34, s[4:7], s31 offen sc1
    s_waitcnt vmcnt(12)
    v_mfma_f32_32x32x16_bf16 v[176:191], v[64:67], a[176:179], v[176:191]
    ds_read_b64_tr_b16 v[76:77], v88 offset:12288
    ds_read_b64_tr_b16 v[78:79], v88 offset:13312
    v_mfma_f32_32x32x16_bf16 v[192:207], v[64:67], a[180:183], v[192:207]
    ds_read_b128 a[232:235], v86 offset:0
    ds_read_b128 a[236:239], v86 offset:4096
    s_add_u32 s31, s31, 8192
    buffer_load_dwordx4 a[8:11], v34, s[4:7], s31 offen sc1
    s_waitcnt lgkmcnt(12)
    v_mfma_f32_32x32x16_bf16 v[112:127], v[68:71], a[184:187], v[112:127]
    ds_read_b128 a[240:243], v86 offset:8192
    ds_read_b128 a[244:247], v86 offset:12288
    v_mfma_f32_32x32x16_bf16 v[128:143], v[68:71], a[188:191], v[128:143]
    ds_read_b128 a[248:251], v86 offset:16384
    ds_read_b128 a[252:255], v86 offset:20480
    s_add_u32 s31, s31, 8192
    buffer_load_dwordx4 a[12:15], v34, s[4:7], s31 offen sc1
    v_mfma_f32_32x32x16_bf16 v[144:159], v[68:71], a[192:195], v[144:159]
    ds_write_b128 v36, a[80:83] offset:0
    v_mfma_f32_32x32x16_bf16 v[160:175], v[68:71], a[196:199], v[160:175]
    ds_write_b128 v37, a[84:87] offset:1024
    s_add_u32 s31, s31, 8192
    buffer_load_dwordx4 a[16:19], v34, s[4:7], s31 offen sc1
    v_mfma_f32_32x32x16_bf16 v[176:191], v[68:71], a[200:203], v[176:191]
    ds_write_b128 v36, a[88:91] offset:2048
    v_mfma_f32_32x32x16_bf16 v[192:207], v[68:71], a[204:207], v[192:207]
    ds_write_b128 v37, a[92:95] offset:3072
    s_add_u32 s31, s31, 8192
    buffer_load_dwordx4 a[20:23], v34, s[4:7], s31 offen sc1
    s_waitcnt lgkmcnt(12)
    v_mfma_f32_32x32x16_bf16 v[112:127], v[72:75], a[208:211], v[112:127]
    ds_write_b128 v36, a[96:99] offset:4096
    v_mfma_f32_32x32x16_bf16 v[128:143], v[72:75], a[212:215], v[128:143]
    ds_write_b128 v37, a[100:103] offset:5120
    s_lshl_b32 s31, s77, 19
    s_add_u32 s31, s31, s68
    buffer_load_dwordx4 a[24:27], v35, s[8:11], s31 offen nt
    v_mfma_f32_32x32x16_bf16 v[144:159], v[72:75], a[216:219], v[144:159]
    ds_write_b128 v39, a[104:107] offset:0
    v_mfma_f32_32x32x16_bf16 v[160:175], v[72:75], a[220:223], v[160:175]
    ds_write_b128 v39, a[108:111] offset:1024
    s_add_u32 s31, s31, 32768
    buffer_load_dwordx4 a[28:31], v35, s[8:11], s31 offen nt
    v_mfma_f32_32x32x16_bf16 v[176:191], v[72:75], a[224:227], v[176:191]
    ds_write_b128 v39, a[112:115] offset:2048
    v_mfma_f32_32x32x16_bf16 v[192:207], v[72:75], a[228:231], v[192:207]
    ds_write_b128 v39, a[116:119] offset:3072
    s_add_u32 s31, s31, 32768
    buffer_load_dwordx4 a[32:35], v35, s[8:11], s31 offen nt
    s_waitcnt lgkmcnt(10)
    v_mfma_f32_32x32x16_bf16 v[112:127], v[76:79], a[232:235], v[112:127]
    v_mfma_f32_32x32x16_bf16 v[128:143], v[76:79], a[236:239], v[128:143]
    s_add_u32 s31, s31, 32768
    buffer_load_dwordx4 a[36:39], v35, s[8:11], s31 offen nt
    v_mfma_f32_32x32x16_bf16 v[144:159], v[76:79], a[240:243], v[144:159]
    v_mfma_f32_32x32x16_bf16 v[160:175], v[76:79], a[244:247], v[160:175]
    s_add_u32 s77, s77, 1
    s_and_b32 s77, s77, 7
    v_mfma_f32_32x32x16_bf16 v[176:191], v[76:79], a[248:251], v[176:191]
    v_mfma_f32_32x32x16_bf16 v[192:207], v[76:79], a[252:255], v[192:207]
    s_waitcnt lgkmcnt(0)
    s_barrier
    ds_read_b64_tr_b16 v[64:65], v44 offset:0
    ds_read_b64_tr_b16 v[66:67], v44 offset:1024
    ds_read_b128 a[160:163], v40 offset:0
    ds_read_b128 a[164:167], v40 offset:4096
    ds_read_b128 a[168:171], v40 offset:8192
    ds_read_b128 a[172:175], v40 offset:12288
    ds_read_b128 a[176:179], v40 offset:16384
    ds_read_b128 a[180:183], v40 offset:20480
    ds_read_b64_tr_b16 v[68:69], v44 offset:4096
    ds_read_b64_tr_b16 v[70:71], v44 offset:5120
    ds_read_b128 a[184:187], v41 offset:0
    ds_read_b128 a[188:191], v41 offset:4096
    ds_read_b128 a[192:195], v41 offset:8192
    ds_read_b128 a[196:199], v41 offset:12288
    ds_read_b128 a[200:203], v41 offset:16384
    ds_read_b128 a[204:207], v41 offset:20480
    s_waitcnt lgkmcnt(8)
    v_mfma_f32_32x32x16_bf16 v[112:127], v[64:67], a[160:163], v[112:127]
    ds_read_b64_tr_b16 v[72:73], v44 offset:8192
    ds_read_b64_tr_b16 v[74:75], v44 offset:9216
    v_mfma_f32_32x32x16_bf16 v[128:143], v[64:67], a[164:167], v[128:143]
    ds_read_b128 a[208:211], v42 offset:0
    ds_read_b128 a[212:215], v42 offset:4096
    s_lshl_b32 s31, s77, 7
    s_add_u32 s31, s31, s66
    buffer_load_dwordx4 a[40:43], v34, s[4:7], s31 offen sc1
    v_mfma_f32_32x32x16_bf16 v[144:159], v[64:67], a[168:171], v[144:159]
    ds_read_b128 a[216:219], v42 offset:8192
    ds_read_b128 a[220:223], v42 offset:12288
    v_mfma_f32_32x32x16_bf16 v[160:175], v[64:67], a[172:175], v[160:175]
    ds_read_b128 a[224:227], v42 offset:16384
    ds_read_b128 a[228:231], v42 offset:20480
    s_add_u32 s31, s31, 8192
    buffer_load_dwordx4 a[44:47], v34, s[4:7], s31 offen sc1
    s_waitcnt vmcnt(12)
    v_mfma_f32_32x32x16_bf16 v[176:191], v[64:67], a[176:179], v[176:191]
    ds_read_b64_tr_b16 v[76:77], v44 offset:12288
    ds_read_b64_tr_b16 v[78:79], v44 offset:13312
    v_mfma_f32_32x32x16_bf16 v[192:207], v[64:67], a[180:183], v[192:207]
    ds_read_b128 a[232:235], v43 offset:0
    ds_read_b128 a[236:239], v43 offset:4096
    s_add_u32 s31, s31, 8192
    buffer_load_dwordx4 a[48:51], v34, s[4:7], s31 offen sc1
    s_waitcnt lgkmcnt(12)
    v_mfma_f32_32x32x16_bf16 v[112:127], v[68:71], a[184:187], v[112:127]
    ds_read_b128 a[240:243], v43 offset:8192
    ds_read_b128 a[244:247], v43 offset:12288
    v_mfma_f32_32x32x16_bf16 v[128:143], v[68:71], a[188:191], v[128:143]
    ds_read_b128 a[248:251], v43 offset:16384
    ds_read_b128 a[252:255], v43 offset:20480
    s_add_u32 s31, s31, 8192
    buffer_load_dwordx4 a[52:55], v34, s[4:7], s31 offen sc1
    v_mfma_f32_32x32x16_bf16 v[144:159], v[68:71], a[192:195], v[144:159]
    ds_write_b128 v80, a[120:123] offset:0
    v_mfma_f32_32x32x16_bf16 v[160:175], v[68:71], a[196:199], v[160:175]
    ds_write_b128 v81, a[124:127] offset:1024
    s_add_u32 s31, s31, 8192
    buffer_load_dwordx4 a[56:59], v34, s[4:7], s31 offen sc1
    v_mfma_f32_32x32x16_bf16 v[176:191], v[68:71], a[200:203], v[176:191]
    ds_write_b128 v80, a[128:131] offset:2048
    v_mfma_f32_32x32x16_bf16 v[192:207], v[68:71], a[204:207], v[192:207]
    ds_write_b128 v81, a[132:135] offset:3072
    s_add_u32 s31, s31, 8192
    buffer_load_dwordx4 a[60:63], v34, s[4:7], s31 offen sc1
    s_waitcnt lgkmcnt(12)
    v_mfma_f32_32x32x16_bf16 v[112:127], v[72:75], a[208:211], v[112:127]
    ds_write_b128 v80, a[136:139] offset:4096
    v_mfma_f32_32x32x16_bf16 v[128:143], v[72:75], a[212:215], v[128:143]
    ds_write_b128 v81, a[140:143] offset:5120
    s_lshl_b32 s31, s77, 19
    s_add_u32 s31, s31, s68
    buffer_load_dwordx4 a[64:67], v35, s[8:11], s31 offen nt
    v_mfma_f32_32x32x16_bf16 v[144:159], v[72:75], a[216:219], v[144:159]
    ds_write_b128 v82, a[144:147] offset:0
    v_mfma_f32_32x32x16_bf16 v[160:175], v[72:75], a[220:223], v[160:175]
    ds_write_b128 v82, a[148:151] offset:1024
    s_add_u32 s31, s31, 32768
    buffer_load_dwordx4 a[68:71], v35, s[8:11], s31 offen nt
    v_mfma_f32_32x32x16_bf16 v[176:191], v[72:75], a[224:227], v[176:191]
    ds_write_b128 v82, a[152:155] offset:2048
    v_mfma_f32_32x32x16_bf16 v[192:207], v[72:75], a[228:231], v[192:207]
    ds_write_b128 v82, a[156:159] offset:3072
    s_add_u32 s31, s31, 32768
    buffer_load_dwordx4 a[72:75], v35, s[8:11], s31 offen nt
    s_waitcnt lgkmcnt(10)
    v_mfma_f32_32x32x16_bf16 v[112:127], v[76:79], a[232:235], v[112:127]
    v_mfma_f32_32x32x16_bf16 v[128:143], v[76:79], a[236:239], v[128:143]
    s_add_u32 s31, s31, 32768
    buffer_load_dwordx4 a[76:79], v35, s[8:11], s31 offen nt
    v_mfma_f32_32x32x16_bf16 v[144:159], v[76:79], a[240:243], v[144:159]
    v_mfma_f32_32x32x16_bf16 v[160:175], v[76:79], a[244:247], v[160:175]
    s_add_u32 s77, s77, 1
    s_and_b32 s77, s77, 7
    v_mfma_f32_32x32x16_bf16 v[176:191], v[76:79], a[248:251], v[176:191]
    v_mfma_f32_32x32x16_bf16 v[192:207], v[76:79], a[252:255], v[192:207]
    s_waitcnt lgkmcnt(0)
    s_barrier
    ds_read_b64_tr_b16 v[64:65], v87 offset:0
    ds_read_b64_tr_b16 v[66:67], v87 offset:1024
    ds_read_b128 a[160:163], v83 offset:0
    ds_read_b128 a[164:167], v83 offset:4096
    ds_read_b128 a[168:171], v83 offset:8192
    ds_read_b128 a[172:175], v83 offset:12288
    ds_read_b128 a[176:179], v83 offset:16384
    ds_read_b128 a[180:183], v83 offset:20480
    ds_read_b64_tr_b16 v[68:69], v87 offset:4096
    ds_read_b64_tr_b16 v[70:71], v87 offset:5120
    ds_read_b128 a[184:187], v84 offset:0
    ds_read_b128 a[188:191], v84 offset:4096
    ds_read_b128 a[192:195], v84 offset:8192
    ds_read_b128 a[196:199], v84 offset:12288
    ds_read_b128 a[200:203], v84 offset:16384
    ds_read_b128 a[204:207], v84 offset:20480
    s_waitcnt lgkmcnt(8)
    v_mfma_f32_32x32x16_bf16 v[112:127], v[64:67], a[160:163], v[112:127]
    ds_read_b64_tr_b16 v[72:73], v88 offset:8192
    ds_read_b64_tr_b16 v[74:75], v88 offset:9216
    v_mfma_f32_32x32x16_bf16 v[128:143], v[64:67], a[164:167], v[128:143]
    ds_read_b128 a[208:211], v85 offset:0
    ds_read_b128 a[212:215], v85 offset:4096
    s_lshl_b32 s31, s77, 7
    s_add_u32 s31, s31, s66
    buffer_load_dwordx4 a[80:83], v34, s[4:7], s31 offen sc1
    v_mfma_f32_32x32x16_bf16 v[144:159], v[64:67], a[168:171], v[144:159]
    ds_read_b128 a[216:219], v85 offset:8192
    ds_read_b128 a[220:223], v85 offset:12288
    v_mfma_f32_32x32x16_bf16 v[160:175], v[64:67], a[172:175], v[160:175]
    ds_read_b128 a[224:227], v85 offset:16384
    ds_read_b128 a[228:231], v85 offset:20480
    s_add_u32 s31, s31, 8192
    buffer_load_dwordx4 a[84:87], v34, s[4:7], s31 offen sc1
    s_waitcnt vmcnt(12)
    v_mfma_f32_32x32x16_bf16 v[176:191], v[64:67], a[176:179], v[176:191]
    ds_read_b64_tr_b16 v[76:77], v88 offset:12288
    ds_read_b64_tr_b16 v[78:79], v88 offset:13312
    v_mfma_f32_32x32x16_bf16 v[192:207], v[64:67], a[180:183], v[192:207]
    ds_read_b128 a[232:235], v86 offset:0
    ds_read_b128 a[236:239], v86 offset:4096
    s_add_u32 s31, s31, 8192
    buffer_load_dwordx4 a[88:91], v34, s[4:7], s31 offen sc1
    s_waitcnt lgkmcnt(12)
    v_mfma_f32_32x32x16_bf16 v[112:127], v[68:71], a[184:187], v[112:127]
    ds_read_b128 a[240:243], v86 offset:8192
    ds_read_b128 a[244:247], v86 offset:12288
    v_mfma_f32_32x32x16_bf16 v[128:143], v[68:71], a[188:191], v[128:143]
    ds_read_b128 a[248:251], v86 offset:16384
    ds_read_b128 a[252:255], v86 offset:20480
    s_add_u32 s31, s31, 8192
    buffer_load_dwordx4 a[92:95], v34, s[4:7], s31 offen sc1
    v_mfma_f32_32x32x16_bf16 v[144:159], v[68:71], a[192:195], v[144:159]
    ds_write_b128 v36, a[0:3] offset:0
    v_mfma_f32_32x32x16_bf16 v[160:175], v[68:71], a[196:199], v[160:175]
    ds_write_b128 v37, a[4:7] offset:1024
    s_add_u32 s31, s31, 8192
    buffer_load_dwordx4 a[96:99], v34, s[4:7], s31 offen sc1
    v_mfma_f32_32x32x16_bf16 v[176:191], v[68:71], a[200:203], v[176:191]
    ds_write_b128 v36, a[8:11] offset:2048
    v_mfma_f32_32x32x16_bf16 v[192:207], v[68:71], a[204:207], v[192:207]
    ds_write_b128 v37, a[12:15] offset:3072
    s_add_u32 s31, s31, 8192
    buffer_load_dwordx4 a[100:103], v34, s[4:7], s31 offen sc1
    s_waitcnt lgkmcnt(12)
    v_mfma_f32_32x32x16_bf16 v[112:127], v[72:75], a[208:211], v[112:127]
    ds_write_b128 v36, a[16:19] offset:4096
    v_mfma_f32_32x32x16_bf16 v[128:143], v[72:75], a[212:215], v[128:143]
    ds_write_b128 v37, a[20:23] offset:5120
    s_lshl_b32 s31, s77, 19
    s_add_u32 s31, s31, s68
    buffer_load_dwordx4 a[104:107], v35, s[8:11], s31 offen nt
    v_mfma_f32_32x32x16_bf16 v[144:159], v[72:75], a[216:219], v[144:159]
    ds_write_b128 v39, a[24:27] offset:0
    v_mfma_f32_32x32x16_bf16 v[160:175], v[72:75], a[220:223], v[160:175]
    ds_write_b128 v39, a[28:31] offset:1024
    s_add_u32 s31, s31, 32768
    buffer_load_dwordx4 a[108:111], v35, s[8:11], s31 offen nt
    v_mfma_f32_32x32x16_bf16 v[176:191], v[72:75], a[224:227], v[176:191]
    ds_write_b128 v39, a[32:35] offset:2048
    v_mfma_f32_32x32x16_bf16 v[192:207], v[72:75], a[228:231], v[192:207]
    ds_write_b128 v39, a[36:39] offset:3072
    s_add_u32 s31, s31, 32768
    buffer_load_dwordx4 a[112:115], v35, s[8:11], s31 offen nt
    s_waitcnt lgkmcnt(10)
    v_mfma_f32_32x32x16_bf16 v[112:127], v[76:79], a[232:235], v[112:127]
    v_mfma_f32_32x32x16_bf16 v[128:143], v[76:79], a[236:239], v[128:143]
    s_add_u32 s31, s31, 32768
    buffer_load_dwordx4 a[116:119], v35, s[8:11], s31 offen nt
    v_mfma_f32_32x32x16_bf16 v[144:159], v[76:79], a[240:243], v[144:159]
    v_mfma_f32_32x32x16_bf16 v[160:175], v[76:79], a[244:247], v[160:175]
    s_add_u32 s77, s77, 1
    s_and_b32 s77, s77, 7
    v_mfma_f32_32x32x16_bf16 v[176:191], v[76:79], a[248:251], v[176:191]
    v_mfma_f32_32x32x16_bf16 v[192:207], v[76:79], a[252:255], v[192:207]
    s_waitcnt lgkmcnt(0)
    s_barrier
    ds_read_b64_tr_b16 v[64:65], v44 offset:0
    ds_read_b64_tr_b16 v[66:67], v44 offset:1024
    ds_read_b128 a[160:163], v40 offset:0
    ds_read_b128 a[164:167], v40 offset:4096
    ds_read_b128 a[168:171], v40 offset:8192
    ds_read_b128 a[172:175], v40 offset:12288
    ds_read_b128 a[176:179], v40 offset:16384
    ds_read_b128 a[180:183], v40 offset:20480
    ds_read_b64_tr_b16 v[68:69], v44 offset:4096
    ds_read_b64_tr_b16 v[70:71], v44 offset:5120
    ds_read_b128 a[184:187], v41 offset:0
    ds_read_b128 a[188:191], v41 offset:4096
    ds_read_b128 a[192:195], v41 offset:8192
    ds_read_b128 a[196:199], v41 offset:12288
    ds_read_b128 a[200:203], v41 offset:16384
    ds_read_b128 a[204:207], v41 offset:20480
    s_waitcnt lgkmcnt(8)
    v_mfma_f32_32x32x16_bf16 v[112:127], v[64:67], a[160:163], v[112:127]
    ds_read_b64_tr_b16 v[72:73], v44 offset:8192
    ds_read_b64_tr_b16 v[74:75], v44 offset:9216
    v_mfma_f32_32x32x16_bf16 v[128:143], v[64:67], a[164:167], v[128:143]
    ds_read_b128 a[208:211], v42 offset:0
    ds_read_b128 a[212:215], v42 offset:4096
    s_lshl_b32 s31, s77, 7
    s_add_u32 s31, s31, s66
    buffer_load_dwordx4 a[120:123], v34, s[4:7], s31 offen sc1
    v_mfma_f32_32x32x16_bf16 v[144:159], v[64:67], a[168:171], v[144:159]
    ds_read_b128 a[216:219], v42 offset:8192
    ds_read_b128 a[220:223], v42 offset:12288
    v_mfma_f32_32x32x16_bf16 v[160:175], v[64:67], a[172:175], v[160:175]
    ds_read_b128 a[224:227], v42 offset:16384
    ds_read_b128 a[228:231], v42 offset:20480
    s_add_u32 s31, s31, 8192
    buffer_load_dwordx4 a[124:127], v34, s[4:7], s31 offen sc1
    s_waitcnt vmcnt(12)
    v_mfma_f32_32x32x16_bf16 v[176:191], v[64:67], a[176:179], v[176:191]
    ds_read_b64_tr_b16 v[76:77], v44 offset:12288
    ds_read_b64_tr_b16 v[78:79], v44 offset:13312
    v_mfma_f32_32x32x16_bf16 v[192:207], v[64:67], a[180:183], v[192:207]
    ds_read_b128 a[232:235], v43 offset:0
    ds_read_b128 a[236:239], v43 offset:4096
    s_add_u32 s31, s31, 8192
    buffer_load_dwordx4 a[128:131], v34, s[4:7], s31 offen sc1
    s_waitcnt lgkmcnt(12)
    v_mfma_f32_32x32x16_bf16 v[112:127], v[68:71], a[184:187], v[112:127]
    ds_read_b128 a[240:243], v43 offset:8192
    ds_read_b128 a[244:247], v43 offset:12288
    v_mfma_f32_32x32x16_bf16 v[128:143], v[68:71], a[188:191], v[128:143]
    ds_read_b128 a[248:251], v43 offset:16384
    ds_read_b128 a[252:255], v43 offset:20480
    s_add_u32 s31, s31, 8192
    buffer_load_dwordx4 a[132:135], v34, s[4:7], s31 offen sc1
    v_mfma_f32_32x32x16_bf16 v[144:159], v[68:71], a[192:195], v[144:159]
    ds_write_b128 v80, a[40:43] offset:0
    v_mfma_f32_32x32x16_bf16 v[160:175], v[68:71], a[196:199], v[160:175]
    ds_write_b128 v81, a[44:47] offset:1024
    s_add_u32 s31, s31, 8192
    buffer_load_dwordx4 a[136:139], v34, s[4:7], s31 offen sc1
    v_mfma_f32_32x32x16_bf16 v[176:191], v[68:71], a[200:203], v[176:191]
    ds_write_b128 v80, a[48:51] offset:2048
    v_mfma_f32_32x32x16_bf16 v[192:207], v[68:71], a[204:207], v[192:207]
    ds_write_b128 v81, a[52:55] offset:3072
    s_add_u32 s31, s31, 8192
    buffer_load_dwordx4 a[140:143], v34, s[4:7], s31 offen sc1
    s_waitcnt lgkmcnt(12)
    v_mfma_f32_32x32x16_bf16 v[112:127], v[72:75], a[208:211], v[112:127]
    ds_write_b128 v80, a[56:59] offset:4096
    v_mfma_f32_32x32x16_bf16 v[128:143], v[72:75], a[212:215], v[128:143]
    ds_write_b128 v81, a[60:63] offset:5120
    s_lshl_b32 s31, s77, 19
    s_add_u32 s31, s31, s68
    buffer_load_dwordx4 a[144:147], v35, s[8:11], s31 offen nt
    v_mfma_f32_32x32x16_bf16 v[144:159], v[72:75], a[216:219], v[144:159]
    ds_write_b128 v82, a[64:67] offset:0
    v_mfma_f32_32x32x16_bf16 v[160:175], v[72:75], a[220:223], v[160:175]
    ds_write_b128 v82, a[68:71] offset:1024
    s_add_u32 s31, s31, 32768
    buffer_load_dwordx4 a[148:151], v35, s[8:11], s31 offen nt
    v_mfma_f32_32x32x16_bf16 v[176:191], v[72:75], a[224:227], v[176:191]
    ds_write_b128 v82, a[72:75] offset:2048
    v_mfma_f32_32x32x16_bf16 v[192:207], v[72:75], a[228:231], v[192:207]
    ds_write_b128 v82, a[76:79] offset:3072
    s_add_u32 s31, s31, 32768
    buffer_load_dwordx4 a[152:155], v35, s[8:11], s31 offen nt
    s_waitcnt lgkmcnt(10)
    v_mfma_f32_32x32x16_bf16 v[112:127], v[76:79], a[232:235], v[112:127]
    v_mfma_f32_32x32x16_bf16 v[128:143], v[76:79], a[236:239], v[128:143]
    s_add_u32 s31, s31, 32768
    buffer_load_dwordx4 a[156:159], v35, s[8:11], s31 offen nt
    v_mfma_f32_32x32x16_bf16 v[144:159], v[76:79], a[240:243], v[144:159]
    v_mfma_f32_32x32x16_bf16 v[160:175], v[76:79], a[244:247], v[160:175]
    s_add_u32 s77, s77, 1
    s_and_b32 s77, s77, 7
    v_mfma_f32_32x32x16_bf16 v[176:191], v[76:79], a[248:251], v[176:191]
    v_mfma_f32_32x32x16_bf16 v[192:207], v[76:79], a[252:255], v[192:207]
    s_waitcnt lgkmcnt(0)
    s_barrier
    ds_read_b64_tr_b16 v[64:65], v87 offset:0
    ds_read_b64_tr_b16 v[66:67], v87 offset:1024
    ds_read_b128 a[160:163], v83 offset:0
    ds_read_b128 a[164:167], v83 offset:4096
    ds_read_b128 a[168:171], v83 offset:8192
    ds_read_b128 a[172:175], v83 offset:12288
    ds_read_b128 a[176:179], v83 offset:16384
    ds_read_b128 a[180:183], v83 offset:20480
    ds_read_b64_tr_b16 v[68:69], v87 offset:4096
    ds_read_b64_tr_b16 v[70:71], v87 offset:5120
    ds_read_b128 a[184:187], v84 offset:0
    ds_read_b128 a[188:191], v84 offset:4096
    ds_read_b128 a[192:195], v84 offset:8192
    ds_read_b128 a[196:199], v84 offset:12288
    ds_read_b128 a[200:203], v84 offset:16384
    ds_read_b128 a[204:207], v84 offset:20480
    s_waitcnt lgkmcnt(8)
    v_mfma_f32_32x32x16_bf16 v[112:127], v[64:67], a[160:163], v[112:127]
    ds_read_b64_tr_b16 v[72:73], v88 offset:8192
    ds_read_b64_tr_b16 v[74:75], v88 offset:9216
    v_mfma_f32_32x32x16_bf16 v[128:143], v[64:67], a[164:167], v[128:143]
    ds_read_b128 a[208:211], v85 offset:0
    ds_read_b128 a[212:215], v85 offset:4096
    v_mfma_f32_32x32x16_bf16 v[144:159], v[64:67], a[168:171], v[144:159]
    ds_read_b128 a[216:219], v85 offset:8192
    ds_read_b128 a[220:223], v85 offset:12288
    s_add_u32 m0, s71, s35
    s_add_u32 s33, s74, 4096
    buffer_load_dwordx4 v2, s[12:15], s74 offen offset:0 nt lds
    v_mfma_f32_32x32x16_bf16 v[160:175], v[64:67], a[172:175], v[160:175]
    ds_read_b128 a[224:227], v85 offset:16384
    ds_read_b128 a[228:231], v85 offset:20480
    s_waitcnt vmcnt(11)
    v_mfma_f32_32x32x16_bf16 v[176:191], v[64:67], a[176:179], v[176:191]
    ds_read_b64_tr_b16 v[76:77], v88 offset:12288
    ds_read_b64_tr_b16 v[78:79], v88 offset:13312
    v_mfma_f32_32x32x16_bf16 v[192:207], v[64:67], a[180:183], v[192:207]
    ds_read_b128 a[232:235], v86 offset:0
    ds_read_b128 a[236:239], v86 offset:4096
    buffer_load_dwordx4 v3, s[12:15], s74 offen offset:1024 nt lds
    s_waitcnt lgkmcnt(12)
    v_mfma_f32_32x32x16_bf16 v[112:127], v[68:71], a[184:187], v[112:127]
    ds_read_b128 a[240:243], v86 offset:8192
    ds_read_b128 a[244:247], v86 offset:12288
    v_mfma_f32_32x32x16_bf16 v[128:143], v[68:71], a[188:191], v[128:143]
    ds_read_b128 a[248:251], v86 offset:16384
    ds_read_b128 a[252:255], v86 offset:20480
    v_mfma_f32_32x32x16_bf16 v[144:159], v[68:71], a[192:195], v[144:159]
    ds_write_b128 v36, a[80:83] offset:0
    buffer_load_dwordx4 v4, s[12:15], s74 offen offset:2048 nt lds
    v_mfma_f32_32x32x16_bf16 v[160:175], v[68:71], a[196:199], v[160:175]
    ds_write_b128 v37, a[84:87] offset:1024
    v_mfma_f32_32x32x16_bf16 v[176:191], v[68:71], a[200:203], v[176:191]
    ds_write_b128 v36, a[88:91] offset:2048
    v_mfma_f32_32x32x16_bf16 v[192:207], v[68:71], a[204:207], v[192:207]
    ds_write_b128 v37, a[92:95] offset:3072
    buffer_load_dwordx4 v5, s[12:15], s74 offen offset:3072 nt lds
    s_waitcnt lgkmcnt(12)
    v_mfma_f32_32x32x16_bf16 v[112:127], v[72:75], a[208:211], v[112:127]
    ds_write_b128 v36, a[96:99] offset:4096
    v_mfma_f32_32x32x16_bf16 v[128:143], v[72:75], a[212:215], v[128:143]
    ds_write_b128 v37, a[100:103] offset:5120
    v_mfma_f32_32x32x16_bf16 v[144:159], v[72:75], a[216:219], v[144:159]
    ds_write_b128 v39, a[104:107] offset:0
    s_add_u32 m0, m0, 4096
    s_add_u32 s74, s74, 32768
    buffer_load_dwordx4 v2, s[12:15], s33 offen offset:0 nt lds
    v_mfma_f32_32x32x16_bf16 v[160:175], v[72:75], a[220:223], v[160:175]
    ds_write_b128 v39, a[108:111] offset:1024
    v_mfma_f32_32x32x16_bf16 v[176:191], v[72:75], a[224:227], v[176:191]
    ds_write_b128 v39, a[112:115] offset:2048
    v_mfma_f32_32x32x16_bf16 v[192:207], v[72:75], a[228:231], v[192:207]
    ds_write_b128 v39, a[116:119] offset:3072
    buffer_load_dwordx4 v3, s[12:15], s33 offen offset:1024 nt lds
    s_waitcnt lgkmcnt(10)
    v_mfma_f32_32x32x16_bf16 v[112:127], v[76:79], a[232:235], v[112:127]
    v_mfma_f32_32x32x16_bf16 v[128:143], v[76:79], a[236:239], v[128:143]
    v_mfma_f32_32x32x16_bf16 v[144:159], v[76:79], a[240:243], v[144:159]
    buffer_load_dwordx4 v4, s[12:15], s33 offen offset:2048 nt lds
    v_mfma_f32_32x32x16_bf16 v[160:175], v[76:79], a[244:247], v[160:175]
    v_mfma_f32_32x32x16_bf16 v[176:191], v[76:79], a[248:251], v[176:191]
    v_mfma_f32_32x32x16_bf16 v[192:207], v[76:79], a[252:255], v[192:207]
    buffer_load_dwordx4 v5, s[12:15], s33 offen offset:3072 nt lds
    s_waitcnt lgkmcnt(0)
    s_barrier
    ds_read_b64_tr_b16 v[64:65], v44 offset:0
    ds_read_b64_tr_b16 v[66:67], v44 offset:1024
    ds_read_b128 a[160:163], v40 offset:0
    ds_read_b128 a[164:167], v40 offset:4096
    ds_read_b128 a[168:171], v40 offset:8192
    ds_read_b128 a[172:175], v40 offset:12288
    ds_read_b128 a[176:179], v40 offset:16384
    ds_read_b128 a[180:183], v40 offset:20480
    ds_read_b64_tr_b16 v[68:69], v44 offset:4096
    ds_read_b64_tr_b16 v[70:71], v44 offset:5120
    ds_read_b128 a[184:187], v41 offset:0
    ds_read_b128 a[188:191], v41 offset:4096
    ds_read_b128 a[192:195], v41 offset:8192
    ds_read_b128 a[196:199], v41 offset:12288
    ds_read_b128 a[200:203], v41 offset:16384
    ds_read_b128 a[204:207], v41 offset:20480
    s_waitcnt lgkmcnt(8)
    v_mfma_f32_32x32x16_bf16 v[112:127], v[64:67], a[160:163], v[112:127]
    ds_read_b64_tr_b16 v[72:73], v44 offset:8192
    ds_read_b64_tr_b16 v[74:75], v44 offset:9216
    v_mfma_f32_32x32x16_bf16 v[128:143], v[64:67], a[164:167], v[128:143]
    ds_read_b128 a[208:211], v42 offset:0
    ds_read_b128 a[212:215], v42 offset:4096
    v_mfma_f32_32x32x16_bf16 v[144:159], v[64:67], a[168:171], v[144:159]
    ds_read_b128 a[216:219], v42 offset:8192
    ds_read_b128 a[220:223], v42 offset:12288
    s_add_u32 m0, s29, s35
    s_add_u32 s33, s74, 4096
    buffer_load_dwordx4 v2, s[12:15], s74 offen offset:0 nt lds
    v_mfma_f32_32x32x16_bf16 v[160:175], v[64:67], a[172:175], v[160:175]
    ds_read_b128 a[224:227], v42 offset:16384
    ds_read_b128 a[228:231], v42 offset:20480
    s_waitcnt vmcnt(9)
    v_mfma_f32_32x32x16_bf16 v[176:191], v[64:67], a[176:179], v[176:191]
    ds_read_b64_tr_b16 v[76:77], v44 offset:12288
    ds_read_b64_tr_b16 v[78:79], v44 offset:13312
    v_mfma_f32_32x32x16_bf16 v[192:207], v[64:67], a[180:183], v[192:207]
    ds_read_b128 a[232:235], v43 offset:0
    ds_read_b128 a[236:239], v43 offset:4096
    buffer_load_dwordx4 v3, s[12:15], s74 offen offset:1024 nt lds
    s_waitcnt lgkmcnt(12)
    v_mfma_f32_32x32x16_bf16 v[112:127], v[68:71], a[184:187], v[112:127]
    ds_read_b128 a[240:243], v43 offset:8192
    ds_read_b128 a[244:247], v43 offset:12288
    v_mfma_f32_32x32x16_bf16 v[128:143], v[68:71], a[188:191], v[128:143]
    ds_read_b128 a[248:251], v43 offset:16384
    ds_read_b128 a[252:255], v43 offset:20480
    v_mfma_f32_32x32x16_bf16 v[144:159], v[68:71], a[192:195], v[144:159]
    ds_write_b128 v80, a[120:123] offset:0
    buffer_load_dwordx4 v4, s[12:15], s74 offen offset:2048 nt lds
    v_mfma_f32_32x32x16_bf16 v[160:175], v[68:71], a[196:199], v[160:175]
    ds_write_b128 v81, a[124:127] offset:1024
    v_mfma_f32_32x32x16_bf16 v[176:191], v[68:71], a[200:203], v[176:191]
    ds_write_b128 v80, a[128:131] offset:2048
    v_mfma_f32_32x32x16_bf16 v[192:207], v[68:71], a[204:207], v[192:207]
    ds_write_b128 v81, a[132:135] offset:3072
    buffer_load_dwordx4 v5, s[12:15], s74 offen offset:3072 nt lds
    s_waitcnt lgkmcnt(12)
    v_mfma_f32_32x32x16_bf16 v[112:127], v[72:75], a[208:211], v[112:127]
    ds_write_b128 v80, a[136:139] offset:4096
    v_mfma_f32_32x32x16_bf16 v[128:143], v[72:75], a[212:215], v[128:143]
    ds_write_b128 v81, a[140:143] offset:5120
    v_mfma_f32_32x32x16_bf16 v[144:159], v[72:75], a[216:219], v[144:159]
    ds_write_b128 v82, a[144:147] offset:0
    s_add_u32 m0, m0, 4096
    s_add_u32 s74, s74, 32768
    buffer_load_dwordx4 v2, s[12:15], s33 offen offset:0 nt lds
    v_mfma_f32_32x32x16_bf16 v[160:175], v[72:75], a[220:223], v[160:175]
    ds_write_b128 v82, a[148:151] offset:1024
    v_mfma_f32_32x32x16_bf16 v[176:191], v[72:75], a[224:227], v[176:191]
    ds_write_b128 v82, a[152:155] offset:2048
    v_mfma_f32_32x32x16_bf16 v[192:207], v[72:75], a[228:231], v[192:207]
    ds_write_b128 v82, a[156:159] offset:3072
    buffer_load_dwordx4 v3, s[12:15], s33 offen offset:1024 nt lds
    s_waitcnt lgkmcnt(10)
    v_mfma_f32_32x32x16_bf16 v[112:127], v[76:79], a[232:235], v[112:127]
    v_mfma_f32_32x32x16_bf16 v[128:143], v[76:79], a[236:239], v[128:143]
    v_mfma_f32_32x32x16_bf16 v[144:159], v[76:79], a[240:243], v[144:159]
    buffer_load_dwordx4 v4, s[12:15], s33 offen offset:2048 nt lds
    v_mfma_f32_32x32x16_bf16 v[160:175], v[76:79], a[244:247], v[160:175]
    v_mfma_f32_32x32x16_bf16 v[176:191], v[76:79], a[248:251], v[176:191]
    v_mfma_f32_32x32x16_bf16 v[192:207], v[76:79], a[252:255], v[192:207]
    buffer_load_dwordx4 v5, s[12:15], s33 offen offset:3072 nt lds
    s_waitcnt lgkmcnt(0)
    s_barrier
    ds_read_b64_tr_b16 v[64:65], v87 offset:0
    ds_read_b64_tr_b16 v[66:67], v87 offset:1024
    ds_read_b128 a[160:163], v83 offset:0
    ds_read_b128 a[164:167], v83 offset:4096
    ds_read_b128 a[168:171], v83 offset:8192
    ds_read_b128 a[172:175], v83 offset:12288
    ds_read_b128 a[176:179], v83 offset:16384
    ds_read_b128 a[180:183], v83 offset:20480
    ds_read_b64_tr_b16 v[68:69], v87 offset:4096
    ds_read_b64_tr_b16 v[70:71], v87 offset:5120
    ds_read_b128 a[184:187], v84 offset:0
    ds_read_b128 a[188:191], v84 offset:4096
    ds_read_b128 a[192:195], v84 offset:8192
    ds_read_b128 a[196:199], v84 offset:12288
    ds_read_b128 a[200:203], v84 offset:16384
    ds_read_b128 a[204:207], v84 offset:20480
    s_waitcnt lgkmcnt(8)
    v_mfma_f32_32x32x16_bf16 v[112:127], v[64:67], a[160:163], v[112:127]
    ds_read_b64_tr_b16 v[72:73], v88 offset:8192
    ds_read_b64_tr_b16 v[74:75], v88 offset:9216
    v_mfma_f32_32x32x16_bf16 v[128:143], v[64:67], a[164:167], v[128:143]
    ds_read_b128 a[208:211], v85 offset:0
    ds_read_b128 a[212:215], v85 offset:4096
    v_mfma_f32_32x32x16_bf16 v[144:159], v[64:67], a[168:171], v[144:159]
    ds_read_b128 a[216:219], v85 offset:8192
    ds_read_b128 a[220:223], v85 offset:12288
    v_mfma_f32_32x32x16_bf16 v[160:175], v[64:67], a[172:175], v[160:175]
    ds_read_b128 a[224:227], v85 offset:16384
    ds_read_b128 a[228:231], v85 offset:20480
    v_mfma_f32_32x32x16_bf16 v[176:191], v[64:67], a[176:179], v[176:191]
    ds_read_b64_tr_b16 v[76:77], v88 offset:12288
    ds_read_b64_tr_b16 v[78:79], v88 offset:13312
    v_mfma_f32_32x32x16_bf16 v[192:207], v[64:67], a[180:183], v[192:207]
    ds_read_b128 a[232:235], v86 offset:0
    ds_read_b128 a[236:239], v86 offset:4096
    s_waitcnt lgkmcnt(12)
    v_mfma_f32_32x32x16_bf16 v[112:127], v[68:71], a[184:187], v[112:127]
    ds_read_b128 a[240:243], v86 offset:8192
    ds_read_b128 a[244:247], v86 offset:12288
    v_mfma_f32_32x32x16_bf16 v[128:143], v[68:71], a[188:191], v[128:143]
    ds_read_b128 a[248:251], v86 offset:16384
    ds_read_b128 a[252:255], v86 offset:20480
    v_mfma_f32_32x32x16_bf16 v[144:159], v[68:71], a[192:195], v[144:159]
    v_mfma_f32_32x32x16_bf16 v[160:175], v[68:71], a[196:199], v[160:175]
    v_mfma_f32_32x32x16_bf16 v[176:191], v[68:71], a[200:203], v[176:191]
    v_mfma_f32_32x32x16_bf16 v[192:207], v[68:71], a[204:207], v[192:207]
    s_waitcnt lgkmcnt(8)
    v_mfma_f32_32x32x16_bf16 v[112:127], v[72:75], a[208:211], v[112:127]
    v_mfma_f32_32x32x16_bf16 v[128:143], v[72:75], a[212:215], v[128:143]
    v_mfma_f32_32x32x16_bf16 v[144:159], v[72:75], a[216:219], v[144:159]
    v_mfma_f32_32x32x16_bf16 v[160:175], v[72:75], a[220:223], v[160:175]
    v_mfma_f32_32x32x16_bf16 v[176:191], v[72:75], a[224:227], v[176:191]
    v_mfma_f32_32x32x16_bf16 v[192:207], v[72:75], a[228:231], v[192:207]
    s_waitcnt lgkmcnt(0)
    v_mfma_f32_32x32x16_bf16 v[112:127], v[76:79], a[232:235], v[112:127]
    v_mfma_f32_32x32x16_bf16 v[128:143], v[76:79], a[236:239], v[128:143]
    v_mfma_f32_32x32x16_bf16 v[144:159], v[76:79], a[240:243], v[144:159]
    v_mfma_f32_32x32x16_bf16 v[160:175], v[76:79], a[244:247], v[160:175]
    v_mfma_f32_32x32x16_bf16 v[176:191], v[76:79], a[248:251], v[176:191]
    v_mfma_f32_32x32x16_bf16 v[192:207], v[76:79], a[252:255], v[192:207]
    s_waitcnt lgkmcnt(0)
    s_barrier
    s_add_u32 m0, s92, s35
    s_add_u32 s33, s75, 4096
    buffer_load_dwordx4 v2, s[16:19], s75 offen offset:0 nt lds
    buffer_load_dwordx4 v3, s[16:19], s75 offen offset:1024 nt lds
    buffer_load_dwordx4 v4, s[16:19], s75 offen offset:2048 nt lds
    buffer_load_dwordx4 v5, s[16:19], s75 offen offset:3072 nt lds
    s_add_u32 m0, m0, 4096
    s_add_u32 s75, s75, 32768
    buffer_load_dwordx4 v2, s[16:19], s33 offen offset:0 nt lds
    buffer_load_dwordx4 v3, s[16:19], s33 offen offset:1024 nt lds
    buffer_load_dwordx4 v4, s[16:19], s33 offen offset:2048 nt lds
    buffer_load_dwordx4 v5, s[16:19], s33 offen offset:3072 nt lds
    global_load_dword v45, v7, s[62:63] sc1
    s_nop 15
    v_cvt_pk_bf16_f32 v64, v112, v113
    v_cvt_pk_bf16_f32 v65, v114, v115
    v_cvt_pk_bf16_f32 v66, v116, v117
    v_cvt_pk_bf16_f32 v67, v118, v119
    v_cvt_pk_bf16_f32 v68, v120, v121
    v_cvt_pk_bf16_f32 v69, v122, v123
    v_cvt_pk_bf16_f32 v70, v124, v125
    v_cvt_pk_bf16_f32 v71, v126, v127
    v_cvt_pk_bf16_f32 v72, v128, v129
    v_cvt_pk_bf16_f32 v73, v130, v131
    v_cvt_pk_bf16_f32 v74, v132, v133
    v_cvt_pk_bf16_f32 v75, v134, v135
    v_cvt_pk_bf16_f32 v76, v136, v137
    v_cvt_pk_bf16_f32 v77, v138, v139
    v_cvt_pk_bf16_f32 v78, v140, v141
    v_cvt_pk_bf16_f32 v79, v142, v143
    v_cvt_pk_bf16_f32 v80, v144, v145
    v_cvt_pk_bf16_f32 v81, v146, v147
    v_cvt_pk_bf16_f32 v82, v148, v149
    v_cvt_pk_bf16_f32 v83, v150, v151
    v_cvt_pk_bf16_f32 v84, v152, v153
    v_cvt_pk_bf16_f32 v85, v154, v155
    v_cvt_pk_bf16_f32 v86, v156, v157
    v_cvt_pk_bf16_f32 v87, v158, v159
    v_cvt_pk_bf16_f32 v88, v160, v161
    v_cvt_pk_bf16_f32 v89, v162, v163
    v_cvt_pk_bf16_f32 v90, v164, v165
    v_cvt_pk_bf16_f32 v91, v166, v167
    v_cvt_pk_bf16_f32 v92, v168, v169
    v_cvt_pk_bf16_f32 v93, v170, v171
    v_cvt_pk_bf16_f32 v94, v172, v173
    v_cvt_pk_bf16_f32 v95, v174, v175
    v_cvt_pk_bf16_f32 v96, v176, v177
    v_cvt_pk_bf16_f32 v97, v178, v179
    v_cvt_pk_bf16_f32 v98, v180, v181
    v_cvt_pk_bf16_f32 v99, v182, v183
    v_cvt_pk_bf16_f32 v100, v184, v185
    v_cvt_pk_bf16_f32 v101, v186, v187
    v_cvt_pk_bf16_f32 v102, v188, v189
    v_cvt_pk_bf16_f32 v103, v190, v191
    v_cvt_pk_bf16_f32 v104, v192, v193
    v_cvt_pk_bf16_f32 v105, v194, v195
    v_cvt_pk_bf16_f32 v106, v196, v197
    v_cvt_pk_bf16_f32 v107, v198, v199
    v_cvt_pk_bf16_f32 v108, v200, v201
    v_cvt_pk_bf16_f32 v109, v202, v203
    v_cvt_pk_bf16_f32 v110, v204, v205
    v_cvt_pk_bf16_f32 v111, v206, v207
    ds_write_b128 v28, v[64:67] offset:0
    ds_write_b128 v28, v[68:71] offset:3072
    ds_write_b128 v28, v[72:75] offset:1024
    ds_write_b128 v28, v[76:79] offset:4096
    ds_write_b128 v28, v[80:83] offset:2048
    ds_write_b128 v28, v[84:87] offset:5120
    ds_write_b128 v28, v[88:91] offset:24576
    ds_write_b128 v28, v[92:95] offset:27648
    ds_write_b128 v28, v[96:99] offset:25600
    ds_write_b128 v28, v[100:103] offset:28672
    ds_write_b128 v28, v[104:107] offset:26624
    ds_write_b128 v28, v[108:111] offset:29696
    v_mov_b32 v50, 0
    v_mov_b32 v53, 0
    v_mov_b32 v51, 0
    v_mov_b32 v54, 0
    v_mov_b32 v52, 0
    v_mov_b32 v55, 0
    s_waitcnt lgkmcnt(0)
    s_barrier
    ds_read_b128 a[0:3], v29 offset:0
    ds_read_b128 a[4:7], v29 offset:3072
    ds_read_b128 a[8:11], v29 offset:6144
    ds_read_b128 a[12:15], v29 offset:9216
    ds_read_b128 a[16:19], v29 offset:12288
    ds_read_b128 a[20:23], v29 offset:15360
    ds_read_b128 a[24:27], v29 offset:18432
    ds_read_b128 a[28:31], v29 offset:21504
    ds_read_b128 a[32:35], v29 offset:1024
    ds_read_b128 a[36:39], v29 offset:4096
    ds_read_b128 a[40:43], v29 offset:7168
    ds_read_b128 a[44:47], v29 offset:10240
    ds_read_b128 a[48:51], v29 offset:13312
    ds_read_b128 a[52:55], v29 offset:16384
    ds_read_b128 a[56:59], v29 offset:19456
    ds_read_b128 a[60:63], v29 offset:22528
    ds_read_b128 a[64:67], v29 offset:2048
    ds_read_b128 a[68:71], v29 offset:5120
    ds_read_b128 a[72:75], v29 offset:8192
    ds_read_b128 a[76:79], v29 offset:11264
    ds_read_b128 a[80:83], v29 offset:14336
    ds_read_b128 a[84:87], v29 offset:17408
    ds_read_b128 a[88:91], v29 offset:20480
    ds_read_b128 a[92:95], v29 offset:23552
    s_waitcnt lgkmcnt(0)
    s_barrier
    s_mov_b32 s71, s76
    s_add_u32 s76, s76, 32768
    s_cmp_ge_u32 s76, 98304
    s_cselect_b32 s76, 0, s76
    s_waitcnt vmcnt(16)
    v_add_u32 v16, s71, v8
    v_add_u32 v17, s71, v9
    v_add_u32 v18, s71, v10
    v_add_u32 v19, s71, v11
    v_add_u32 v20, s71, v12
    v_add_u32 v21, s71, v13
    v_add_u32 v22, s71, v14
    v_add_u32 v23, s71, v15
    ds_read_b128 a[96:99], v16
    ds_read_b128 a[100:103], v17
    ds_read_b128 a[104:107], v18
    ds_read_b128 a[108:111], v19
    ds_read_b128 a[112:115], v20
    ds_read_b128 a[116:119], v21
    ds_read_b128 a[120:123], v22
    ds_read_b128 a[124:127], v23
    s_waitcnt lgkmcnt(7)
    v_mfma_f32_32x32x16_bf16 v[64:79], a[96:99], a[0:3], 0
    s_waitcnt lgkmcnt(6)
    v_mfma_f32_32x32x16_bf16 v[64:79], a[100:103], a[4:7], v[64:79]
    s_waitcnt lgkmcnt(5)
    v_mfma_f32_32x32x16_bf16 v[64:79], a[104:107], a[8:11], v[64:79]
    s_waitcnt lgkmcnt(4)
    v_mfma_f32_32x32x16_bf16 v[64:79], a[108:111], a[12:15], v[64:79]
    s_waitcnt lgkmcnt(3)
    v_mfma_f32_32x32x16_bf16 v[64:79], a[112:115], a[16:19], v[64:79]
    s_waitcnt lgkmcnt(2)
    v_mfma_f32_32x32x16_bf16 v[64:79], a[116:119], a[20:23], v[64:79]
    s_waitcnt lgkmcnt(1)
    v_mfma_f32_32x32x16_bf16 v[64:79], a[120:123], a[24:27], v[64:79]
    s_waitcnt lgkmcnt(0)
    v_mfma_f32_32x32x16_bf16 v[64:79], a[124:127], a[28:31], v[64:79]
    v_mfma_f32_32x32x16_bf16 v[80:95], a[96:99], a[32:35], 0
    s_add_u32 m0, s71, s35
    s_add_u32 s33, s74, 4096
    buffer_load_dwordx4 v2, s[12:15], s74 offen offset:0 nt lds
    v_mfma_f32_32x32x16_bf16 v[80:95], a[100:103], a[36:39], v[80:95]
    buffer_load_dwordx4 v3, s[12:15], s74 offen offset:1024 nt lds
    s_waitcnt lgkmcnt(15)
    v_mfma_f32_32x32x16_bf16 v[80:95], a[104:107], a[40:43], v[80:95]
    s_nop 3
    v_fma_f32 v184, v64, s36, -v50
    v_fma_f32 v185, v65, s36, -v50
    v_fma_f32 v186, v66, s36, -v50
    v_fma_f32 v187, v67, s36, -v50
    v_exp_f32 v184, v184
    buffer_load_dwordx4 v4, s[12:15], s74 offen offset:2048 nt lds
    v_mfma_f32_32x32x16_bf16 v[80:95], a[108:111], a[44:47], v[80:95]
    v_exp_f32 v185, v185
    v_fma_f32 v188, v68, s36, -v50
    v_fma_f32 v189, v69, s36, -v50
    v_exp_f32 v186, v186
    buffer_load_dwordx4 v5, s[12:15], s74 offen offset:3072 nt lds
    v_mfma_f32_32x32x16_bf16 v[80:95], a[112:115], a[48:51], v[80:95]
    v_exp_f32 v187, v187
    v_add_f32 v56, v184, v185
    v_cvt_pk_bf16_f32 v160, v184, v185
    v_fma_f32 v190, v70, s36, -v50
    s_add_u32 m0, m0, 4096
    s_add_u32 s74, s74, 32768
    buffer_load_dwordx4 v2, s[12:15], s33 offen offset:0 nt lds
    v_mfma_f32_32x32x16_bf16 v[80:95], a[116:119], a[52:55], v[80:95]
    v_fma_f32 v191, v71, s36, -v50
    v_exp_f32 v188, v188
    v_exp_f32 v189, v189
    buffer_load_dwordx4 v3, s[12:15], s33 offen offset:1024 nt lds
    v_mfma_f32_32x32x16_bf16 v[80:95], a[120:123], a[56:59], v[80:95]
    v_add_f32 v56, v56, v186
    v_add_f32 v56, v56, v187
    v_cvt_pk_bf16_f32 v161, v186, v187
    v_fma_f32 v184, v72, s36, -v50
    v_fma_f32 v185, v73, s36, -v50
    buffer_load_dwordx4 v4, s[12:15], s33 offen offset:2048 nt lds
    v_mfma_f32_32x32x16_bf16 v[80:95], a[124:127], a[60:63], v[80:95]
    v_exp_f32 v190, v190
    v_exp_f32 v191, v191
    v_add_f32 v56, v56, v188
    buffer_load_dwordx4 v5, s[12:15], s33 offen offset:3072 nt lds
    v_mfma_f32_32x32x16_bf16 v[96:111], a[96:99], a[64:67], 0
    v_add_f32 v56, v56, v189
    v_cvt_pk_bf16_f32 v162, v188, v189
    v_fma_f32 v186, v74, s36, -v50
    v_fma_f32 v187, v75, s36, -v50
    v_exp_f32 v184, v184
    v_mfma_f32_32x32x16_bf16 v[96:111], a[100:103], a[68:71], v[96:111]
    v_exp_f32 v185, v185
    v_add_f32 v56, v56, v190
    v_add_f32 v56, v56, v191
    v_cvt_pk_bf16_f32 v163, v190, v191
    s_waitcnt lgkmcnt(0)
    s_barrier
    v_mfma_f32_32x32x16_bf16 v[96:111], a[104:107], a[72:75], v[96:111]
    v_fma_f32 v188, v76, s36, -v50
    v_fma_f32 v189, v77, s36, -v50
    v_exp_f32 v186, v186
    v_exp_f32 v187, v187
    v_mfma_f32_32x32x16_bf16 v[96:111], a[108:111], a[76:79], v[96:111]
    v_add_f32 v56, v56, v184
    v_add_f32 v56, v56, v185
    v_cvt_pk_bf16_f32 v164, v184, v185
    v_fma_f32 v190, v78, s36, -v50
    v_fma_f32 v191, v79, s36, -v50
    v_mfma_f32_32x32x16_bf16 v[96:111], a[112:115], a[80:83], v[96:111]
    v_exp_f32 v188, v188
    v_exp_f32 v189, v189
    v_add_f32 v56, v56, v186
    v_mfma_f32_32x32x16_bf16 v[96:111], a[116:119], a[84:87], v[96:111]
    v_add_f32 v56, v56, v187
    v_cvt_pk_bf16_f32 v165, v186, v187
    v_exp_f32 v190, v190
    v_exp_f32 v191, v191
    v_mfma_f32_32x32x16_bf16 v[96:111], a[120:123], a[88:91], v[96:111]
    v_add_f32 v56, v56, v188
    v_add_f32 v56, v56, v189
    v_cvt_pk_bf16_f32 v166, v188, v189
    v_add_f32 v56, v56, v190
    v_add_f32 v56, v56, v191
    v_mfma_f32_32x32x16_bf16 v[96:111], a[124:127], a[92:95], v[96:111]
    v_cvt_pk_bf16_f32 v167, v190, v191
    v_cmp_lt_f32 vcc, s37, v56
    s_nop 0
    s_mov_b64 s[72:73], vcc
    v_cmp_gt_f32 vcc, 0x33800000, v56
    s_nop 0
    s_or_b64 s[72:73], s[72:73], vcc
    v_fma_f32 v192, v80, s36, -v51
    v_fma_f32 v193, v81, s36, -v51
    v_fma_f32 v194, v82, s36, -v51
    v_fma_f32 v195, v83, s36, -v51
    v_exp_f32 v192, v192
    v_exp_f32 v193, v193
    v_fma_f32 v196, v84, s36, -v51
    v_fma_f32 v197, v85, s36, -v51
    v_exp_f32 v194, v194
    v_exp_f32 v195, v195
    v_add_f32 v57, v192, v193
    v_cvt_pk_bf16_f32 v168, v192, v193
    v_fma_f32 v198, v86, s36, -v51
    v_fma_f32 v199, v87, s36, -v51
    v_exp_f32 v196, v196
    v_exp_f32 v197, v197
    v_add_f32 v57, v57, v194
    v_add_f32 v57, v57, v195
    v_cvt_pk_bf16_f32 v169, v194, v195
    v_fma_f32 v192, v88, s36, -v51
    v_fma_f32 v193, v89, s36, -v51
    v_exp_f32 v198, v198
    v_exp_f32 v199, v199
    v_add_f32 v57, v57, v196
    v_add_f32 v57, v57, v197
    v_cvt_pk_bf16_f32 v170, v196, v197
    v_fma_f32 v194, v90, s36, -v51
    v_fma_f32 v195, v91, s36, -v51
    v_exp_f32 v192, v192
    v_exp_f32 v193, v193
    v_add_f32 v57, v57, v198
    v_add_f32 v57, v57, v199
    v_cvt_pk_bf16_f32 v171, v198, v199
    v_fma_f32 v196, v92, s36, -v51
    v_fma_f32 v197, v93, s36, -v51
    v_exp_f32 v194, v194
    v_exp_f32 v195, v195
    v_add_f32 v57, v57, v192
    v_add_f32 v57, v57, v193
    v_cvt_pk_bf16_f32 v172, v192, v193
    v_fma_f32 v198, v94, s36, -v51
    v_fma_f32 v199, v95, s36, -v51
    v_exp_f32 v196, v196
    v_exp_f32 v197, v197
    v_add_f32 v57, v57, v194
    v_add_f32 v57, v57, v195
    v_cvt_pk_bf16_f32 v173, v194, v195
    v_exp_f32 v198, v198
    v_exp_f32 v199, v199
    v_add_f32 v57, v57, v196
    v_add_f32 v57, v57, v197
    v_cvt_pk_bf16_f32 v174, v196, v197
    v_add_f32 v57, v57, v198
    v_add_f32 v57, v57, v199
    v_cvt_pk_bf16_f32 v175, v198, v199
    v_cmp_lt_f32 vcc, s37, v57
    s_nop 0
    s_or_b64 s[72:73], s[72:73], vcc
    v_cmp_gt_f32 vcc, 0x33800000, v57
    s_nop 0
    s_or_b64 s[72:73], s[72:73], vcc
    v_fma_f32 v184, v96, s36, -v52
    v_fma_f32 v185, v97, s36, -v52
    v_fma_f32 v186, v98, s36, -v52
    v_fma_f32 v187, v99, s36, -v52
    v_exp_f32 v184, v184
    v_exp_f32 v185, v185
    v_fma_f32 v188, v100, s36, -v52
    v_fma_f32 v189, v101, s36, -v52
    v_exp_f32 v186, v186
    v_exp_f32 v187, v187
    v_add_f32 v58, v184, v185
    v_cvt_pk_bf16_f32 v176, v184, v185
    v_fma_f32 v190, v102, s36, -v52
    v_fma_f32 v191, v103, s36, -v52
    v_exp_f32 v188, v188
    v_exp_f32 v189, v189
    v_add_f32 v58, v58, v186
    v_add_f32 v58, v58, v187
    v_cvt_pk_bf16_f32 v177, v186, v187
    v_fma_f32 v184, v104, s36, -v52
    v_fma_f32 v185, v105, s36, -v52
    v_exp_f32 v190, v190
    v_exp_f32 v191, v191
    v_add_f32 v58, v58, v188
    v_add_f32 v58, v58, v189
    v_cvt_pk_bf16_f32 v178, v188, v189
    v_fma_f32 v186, v106, s36, -v52
    v_fma_f32 v187, v107, s36, -v52
    v_exp_f32 v184, v184
    v_exp_f32 v185, v185
    v_add_f32 v58, v58, v190
    v_add_f32 v58, v58, v191
    v_cvt_pk_bf16_f32 v179, v190, v191
    v_fma_f32 v188, v108, s36, -v52
    v_fma_f32 v189, v109, s36, -v52
    v_exp_f32 v186, v186
    v_exp_f32 v187, v187
    v_add_f32 v58, v58, v184
    v_add_f32 v58, v58, v185
    v_cvt_pk_bf16_f32 v180, v184, v185
    v_fma_f32 v190, v110, s36, -v52
    v_fma_f32 v191, v111, s36, -v52
    v_exp_f32 v188, v188
    v_exp_f32 v189, v189
    v_add_f32 v58, v58, v186
    v_add_f32 v58, v58, v187
    v_cvt_pk_bf16_f32 v181, v186, v187
    v_exp_f32 v190, v190
    v_exp_f32 v191, v191
    v_add_f32 v58, v58, v188
    v_add_f32 v58, v58, v189
    v_cvt_pk_bf16_f32 v182, v188, v189
    v_add_f32 v58, v58, v190
    v_add_f32 v58, v58, v191
    v_cvt_pk_bf16_f32 v183, v190, v191
    v_cmp_lt_f32 vcc, s37, v58
    s_nop 0
    s_or_b64 s[72:73], s[72:73], vcc
    v_cmp_gt_f32 vcc, 0x33800000, v58
    s_nop 0
    s_or_b64 s[72:73], s[72:73], vcc
    s_cmp_eq_u64 s[72:73], 0
    s_cbranch_scc1 Lnf_2
    v_mov_b32 v59, 1
    ds_write_b32 v6, v59
Lnf_2:
    s_waitcnt lgkmcnt(0)
    s_barrier
    ds_read_b32 v59, v6
    s_mov_b32 s71, s76
    s_add_u32 s76, s76, 32768
    s_cmp_ge_u32 s76, 98304
    s_cselect_b32 s76, 0, s76
    s_waitcnt vmcnt(16)
    v_add_u32 v16, s71, v8
    v_add_u32 v17, s71, v9
    v_add_u32 v18, s71, v10
    v_add_u32 v19, s71, v11
    v_add_u32 v20, s71, v12
    v_add_u32 v21, s71, v13
    v_add_u32 v22, s71, v14
    v_add_u32 v23, s71, v15
    ds_read_b128 a[96:99], v16
    ds_read_b128 a[100:103], v17
    ds_read_b128 a[104:107], v18
    ds_read_b128 a[108:111], v19
    ds_read_b128 a[112:115], v20
    ds_read_b128 a[116:119], v21
    ds_read_b128 a[120:123], v22
    ds_read_b128 a[124:127], v23
    ds_write_b128 v28, v[160:163] offset:0
    ds_write_b128 v28, v[164:167] offset:3072
    ds_write_b128 v28, v[168:171] offset:1024
    ds_write_b128 v28, v[172:175] offset:4096
    ds_write_b128 v28, v[176:179] offset:2048
    ds_write_b128 v28, v[180:183] offset:5120
    s_waitcnt lgkmcnt(14)
    v_readfirstlane_b32 s31, v59
    s_nop 0
    s_cmp_lg_u32 s31, 0
    s_cbranch_scc1 Lslow_4
Lpost_3:
    v_add_f32 v53, v53, v56
    v_add_f32 v54, v54, v57
    v_add_f32 v55, v55, v58
    s_waitcnt lgkmcnt(13)
    v_mfma_f32_32x32x16_bf16 v[64:79], a[96:99], a[0:3], 0
    s_waitcnt lgkmcnt(12)
    v_mfma_f32_32x32x16_bf16 v[64:79], a[100:103], a[4:7], v[64:79]
    s_waitcnt lgkmcnt(11)
    v_mfma_f32_32x32x16_bf16 v[64:79], a[104:107], a[8:11], v[64:79]
    s_waitcnt lgkmcnt(10)
    v_mfma_f32_32x32x16_bf16 v[64:79], a[108:111], a[12:15], v[64:79]
    s_waitcnt lgkmcnt(9)
    v_mfma_f32_32x32x16_bf16 v[64:79], a[112:115], a[16:19], v[64:79]
    s_waitcnt lgkmcnt(8)
    v_mfma_f32_32x32x16_bf16 v[64:79], a[116:119], a[20:23], v[64:79]
    s_waitcnt lgkmcnt(7)
    v_mfma_f32_32x32x16_bf16 v[64:79], a[120:123], a[24:27], v[64:79]
    s_waitcnt lgkmcnt(6)
    v_mfma_f32_32x32x16_bf16 v[64:79], a[124:127], a[28:31], v[64:79]
    v_mfma_f32_32x32x16_bf16 v[80:95], a[96:99], a[32:35], 0
    s_add_u32 m0, s71, s35
    s_add_u32 s33, s75, 4096
    buffer_load_dwordx4 v2, s[16:19], s75 offen offset:0 nt lds
    v_mfma_f32_32x32x16_bf16 v[80:95], a[100:103], a[36:39], v[80:95]
    buffer_load_dwordx4 v3, s[16:19], s75 offen offset:1024 nt lds
    s_waitcnt lgkmcnt(0)
    v_mfma_f32_32x32x16_bf16 v[80:95], a[104:107], a[40:43], v[80:95]
    s_nop 3
    v_fma_f32 v184, v64, s36, -v50
    v_fma_f32 v185, v65, s36, -v50
    v_fma_f32 v186, v66, s36, -v50
    v_fma_f32 v187, v67, s36, -v50
    v_exp_f32 v184, v184
    buffer_load_dwordx4 v4, s[16:19], s75 offen offset:2048 nt lds
    v_mfma_f32_32x32x16_bf16 v[80:95], a[108:111], a[44:47], v[80:95]
    v_exp_f32 v185, v185
    v_fma_f32 v188, v68, s36, -v50
    v_fma_f32 v189, v69, s36, -v50
    v_exp_f32 v186, v186
    buffer_load_dwordx4 v5, s[16:19], s75 offen offset:3072 nt lds
    v_mfma_f32_32x32x16_bf16 v[80:95], a[112:115], a[48:51], v[80:95]
    v_exp_f32 v187, v187
    v_add_f32 v56, v184, v185
    v_cvt_pk_bf16_f32 v160, v184, v185
    v_fma_f32 v190, v70, s36, -v50
    s_add_u32 m0, m0, 4096
    s_add_u32 s75, s75, 32768
    buffer_load_dwordx4 v2, s[16:19], s33 offen offset:0 nt lds
    v_mfma_f32_32x32x16_bf16 v[80:95], a[116:119], a[52:55], v[80:95]
    v_fma_f32 v191, v71, s36, -v50
    v_exp_f32 v188, v188
    v_exp_f32 v189, v189
    buffer_load_dwordx4 v3, s[16:19], s33 offen offset:1024 nt lds
    v_mfma_f32_32x32x16_bf16 v[80:95], a[120:123], a[56:59], v[80:95]
    v_add_f32 v56, v56, v186
    v_add_f32 v56, v56, v187
    v_cvt_pk_bf16_f32 v161, v186, v187
    v_fma_f32 v184, v72, s36, -v50
    v_fma_f32 v185, v73, s36, -v50
    buffer_load_dwordx4 v4, s[16:19], s33 offen offset:2048 nt lds
    v_mfma_f32_32x32x16_bf16 v[80:95], a[124:127], a[60:63], v[80:95]
    v_exp_f32 v190, v190
    v_exp_f32 v191, v191
    v_add_f32 v56, v56, v188
    buffer_load_dwordx4 v5, s[16:19], s33 offen offset:3072 nt lds
    v_mfma_f32_32x32x16_bf16 v[96:111], a[96:99], a[64:67], 0
    v_add_f32 v56, v56, v189
    v_cvt_pk_bf16_f32 v162, v188, v189
    v_fma_f32 v186, v74, s36, -v50
    v_fma_f32 v187, v75, s36, -v50
    v_exp_f32 v184, v184
    v_mfma_f32_32x32x16_bf16 v[96:111], a[100:103], a[68:71], v[96:111]
    v_exp_f32 v185, v185
    v_add_f32 v56, v56, v190
    v_add_f32 v56, v56, v191
    v_cvt_pk_bf16_f32 v163, v190, v191
    s_waitcnt vmcnt(16)
    s_waitcnt lgkmcnt(0)
    s_barrier
    s_mov_b32 s29, s76
    s_add_u32 s76, s76, 32768
    s_cmp_ge_u32 s76, 98304
    s_cselect_b32 s76, 0, s76
    v_add_u32 v26, s29, v24
    v_add_u32 v27, s29, v25
    v_mfma_f32_32x32x16_bf16 v[96:111], a[104:107], a[72:75], v[96:111]
    v_fma_f32 v188, v76, s36, -v50
    v_fma_f32 v189, v77, s36, -v50
    v_exp_f32 v186, v186
    v_exp_f32 v187, v187
    ds_read_b64_tr_b16 a[128:129], v26 offset:0
    ds_read_b64_tr_b16 a[130:131], v27 offset:0
    ds_read_b128 a[140:143], v29 offset:0
    v_mfma_f32_32x32x16_bf16 v[96:111], a[108:111], a[76:79], v[96:111]
    v_add_f32 v56, v56, v184
    v_add_f32 v56, v56, v185
    v_cvt_pk_bf16_f32 v164, v184, v185
    v_fma_f32 v190, v78, s36, -v50
    v_fma_f32 v191, v79, s36, -v50
    ds_read_b128 a[144:147], v29 offset:1024
    ds_read_b128 a[148:151], v29 offset:2048
    ds_read_b64_tr_b16 a[132:133], v26 offset:4096
    v_mfma_f32_32x32x16_bf16 v[96:111], a[112:115], a[80:83], v[96:111]
    v_exp_f32 v188, v188
    v_exp_f32 v189, v189
    v_add_f32 v56, v56, v186
    ds_read_b64_tr_b16 a[134:135], v27 offset:4096
    ds_read_b128 a[152:155], v29 offset:3072
    ds_read_b128 a[156:159], v29 offset:4096
    v_mfma_f32_32x32x16_bf16 v[96:111], a[116:119], a[84:87], v[96:111]
    v_add_f32 v56, v56, v187
    v_cvt_pk_bf16_f32 v165, v186, v187
    v_exp_f32 v190, v190
    v_exp_f32 v191, v191
    ds_read_b128 a[160:163], v29 offset:5120
    ds_read_b64_tr_b16 a[136:137], v26 offset:8192
    ds_read_b64_tr_b16 a[138:139], v27 offset:8192
    v_mfma_f32_32x32x16_bf16 v[96:111], a[120:123], a[88:91], v[96:111]
    v_add_f32 v56, v56, v188
    v_add_f32 v56, v56, v189
    v_cvt_pk_bf16_f32 v166, v188, v189
    v_add_f32 v56, v56, v190
    v_add_f32 v56, v56, v191
    ds_read_b128 a[164:167], v29 offset:6144
    ds_read_b128 a[168:171], v29 offset:7168
    ds_read_b128 a[172:175], v29 offset:8192
    v_mfma_f32_32x32x16_bf16 v[96:111], a[124:127], a[92:95], v[96:111]
    v_cvt_pk_bf16_f32 v167, v190, v191
    s_waitcnt lgkmcnt(10)
    v_mfma_f32_32x32x16_bf16 v[112:127], a[128:131], a[140:143], 0
    v_cmp_lt_f32 vcc, s37, v56
    s_nop 0
    s_mov_b64 s[72:73], vcc
    v_fma_f32 v192, v80, s36, -v51
    v_fma_f32 v193, v81, s36, -v51
    v_fma_f32 v194, v82, s36, -v51
    v_fma_f32 v195, v83, s36, -v51
    v_mfma_f32_32x32x16_bf16 v[128:143], a[128:131], a[144:147], 0
    v_exp_f32 v192, v192
    v_exp_f32 v193, v193
    v_fma_f32 v196, v84, s36, -v51
    v_fma_f32 v197, v85, s36, -v51
    v_mfma_f32_32x32x16_bf16 v[144:159], a[128:131], a[148:151], 0
    v_exp_f32 v194, v194
    v_exp_f32 v195, v195
    v_add_f32 v57, v192, v193
    v_cvt_pk_bf16_f32 v168, v192, v193
    s_waitcnt lgkmcnt(5)
    v_mfma_f32_32x32x16_bf16 v[112:127], a[132:135], a[152:155], v[112:127]
    ds_read_b64_tr_b16 a[128:129], v26 offset:12288
    ds_read_b64_tr_b16 a[130:131], v27 offset:12288
    v_fma_f32 v198, v86, s36, -v51
    v_fma_f32 v199, v87, s36, -v51
    v_exp_f32 v196, v196
    v_exp_f32 v197, v197
    v_mfma_f32_32x32x16_bf16 v[128:143], a[132:135], a[156:159], v[128:143]
    ds_read_b128 a[140:143], v29 offset:9216
    ds_read_b128 a[144:147], v29 offset:10240
    v_add_f32 v57, v57, v194
    v_add_f32 v57, v57, v195
    v_cvt_pk_bf16_f32 v169, v194, v195
    v_fma_f32 v192, v88, s36, -v51
    v_fma_f32 v193, v89, s36, -v51
    v_exp_f32 v198, v198
    v_mfma_f32_32x32x16_bf16 v[144:159], a[132:135], a[160:163], v[144:159]
    ds_read_b128 a[148:151], v29 offset:11264
    v_exp_f32 v199, v199
    v_add_f32 v57, v57, v196
    v_add_f32 v57, v57, v197
    v_cvt_pk_bf16_f32 v170, v196, v197
    v_fma_f32 v194, v90, s36, -v51
    s_waitcnt lgkmcnt(5)
    v_mfma_f32_32x32x16_bf16 v[112:127], a[136:139], a[164:167], v[112:127]
    ds_read_b64_tr_b16 a[132:133], v26 offset:16384
    ds_read_b64_tr_b16 a[134:135], v27 offset:16384
    v_fma_f32 v195, v91, s36, -v51
    v_exp_f32 v192, v192
    v_exp_f32 v193, v193
    v_add_f32 v57, v57, v198
    v_mfma_f32_32x32x16_bf16 v[128:143], a[136:139], a[168:171], v[128:143]
    ds_read_b128 a[152:155], v29 offset:12288
    ds_read_b128 a[156:159], v29 offset:13312
    v_add_f32 v57, v57, v199
    v_cvt_pk_bf16_f32 v171, v198, v199
    v_fma_f32 v196, v92, s36, -v51
    v_fma_f32 v197, v93, s36, -v51
    v_exp_f32 v194, v194
    v_mfma_f32_32x32x16_bf16 v[144:159], a[136:139], a[172:175], v[144:159]
    ds_read_b128 a[160:163], v29 offset:14336
    v_exp_f32 v195, v195
    v_add_f32 v57, v57, v192
    v_add_f32 v57, v57, v193
    v_cvt_pk_bf16_f32 v172, v192, v193
    v_fma_f32 v198, v94, s36, -v51
    s_waitcnt lgkmcnt(5)
    v_mfma_f32_32x32x16_bf16 v[112:127], a[128:131], a[140:143], v[112:127]
    ds_read_b64_tr_b16 a[136:137], v26 offset:20480
    ds_read_b64_tr_b16 a[138:139], v27 offset:20480
    v_fma_f32 v199, v95, s36, -v51
    v_exp_f32 v196, v196
    v_exp_f32 v197, v197
    v_add_f32 v57, v57, v194
    v_mfma_f32_32x32x16_bf16 v[128:143], a[128:131], a[144:147], v[128:143]
    ds_read_b128 a[164:167], v29 offset:15360
    ds_read_b128 a[168:171], v29 offset:16384
    v_add_f32 v57, v57, v195
    v_cvt_pk_bf16_f32 v173, v194, v195
    v_exp_f32 v198, v198
    v_exp_f32 v199, v199
    v_mfma_f32_32x32x16_bf16 v[144:159], a[128:131], a[148:151], v[144:159]
    ds_read_b128 a[172:175], v29 offset:17408
    v_add_f32 v57, v57, v196
    v_add_f32 v57, v57, v197
    v_cvt_pk_bf16_f32 v174, v196, v197
    v_add_f32 v57, v57, v198
    v_add_f32 v57, v57, v199
    v_cvt_pk_bf16_f32 v175, v198, v199
    s_waitcnt lgkmcnt(5)
    v_mfma_f32_32x32x16_bf16 v[112:127], a[132:135], a[152:155], v[112:127]
    ds_read_b64_tr_b16 a[128:129], v26 offset:24576
    ds_read_b64_tr_b16 a[130:131], v27 offset:24576
    v_cmp_lt_f32 vcc, s37, v57
    s_nop 0
    s_or_b64 s[72:73], s[72:73], vcc
    v_fma_f32 v184, v96, s36, -v52
    v_fma_f32 v185, v97, s36, -v52
    v_fma_f32 v186, v98, s36, -v52
    v_fma_f32 v187, v99, s36, -v52
    v_mfma_f32_32x32x16_bf16 v[128:143], a[132:135], a[156:159], v[128:143]
    ds_read_b128 a[140:143], v29 offset:18432
    ds_read_b128 a[144:147], v29 offset:19456
    v_exp_f32 v184, v184
    v_exp_f32 v185, v185
    v_fma_f32 v188, v100, s36, -v52
    v_fma_f32 v189, v101, s36, -v52
    v_mfma_f32_32x32x16_bf16 v[144:159], a[132:135], a[160:163], v[144:159]
    ds_read_b128 a[148:151], v29 offset:20480
    v_exp_f32 v186, v186
    v_exp_f32 v187, v187
    v_add_f32 v58, v184, v185
    v_cvt_pk_bf16_f32 v176, v184, v185
    s_waitcnt lgkmcnt(5)
    v_mfma_f32_32x32x16_bf16 v[112:127], a[136:139], a[164:167], v[112:127]
    ds_read_b64_tr_b16 a[132:133], v26 offset:28672
    ds_read_b64_tr_b16 a[134:135], v27 offset:28672
    v_fma_f32 v190, v102, s36, -v52
    v_fma_f32 v191, v103, s36, -v52
    v_exp_f32 v188, v188
    v_exp_f32 v189, v189
    v_mfma_f32_32x32x16_bf16 v[128:143], a[136:139], a[168:171], v[128:143]
    ds_read_b128 a[152:155], v29 offset:21504
    ds_read_b128 a[156:159], v29 offset:22528
    v_add_f32 v58, v58, v186
    v_add_f32 v58, v58, v187
    v_cvt_pk_bf16_f32 v177, v186, v187
    v_fma_f32 v184, v104, s36, -v52
    v_fma_f32 v185, v105, s36, -v52
    v_exp_f32 v190, v190
    v_mfma_f32_32x32x16_bf16 v[144:159], a[136:139], a[172:175], v[144:159]
    ds_read_b128 a[160:163], v29 offset:23552
    v_exp_f32 v191, v191
    v_add_f32 v58, v58, v188
    v_add_f32 v58, v58, v189
    v_cvt_pk_bf16_f32 v178, v188, v189
    v_fma_f32 v186, v106, s36, -v52
    s_waitcnt lgkmcnt(5)
    v_mfma_f32_32x32x16_bf16 v[112:127], a[128:131], a[140:143], v[112:127]
    v_fma_f32 v187, v107, s36, -v52
    v_exp_f32 v184, v184
    v_exp_f32 v185, v185
    v_add_f32 v58, v58, v190
    v_mfma_f32_32x32x16_bf16 v[128:143], a[128:131], a[144:147], v[128:143]
    v_add_f32 v58, v58, v191
    v_cvt_pk_bf16_f32 v179, v190, v191
    v_fma_f32 v188, v108, s36, -v52
    v_fma_f32 v189, v109, s36, -v52
    v_exp_f32 v186, v186
    v_mfma_f32_32x32x16_bf16 v[144:159], a[128:131], a[148:151], v[144:159]
    v_exp_f32 v187, v187
    v_add_f32 v58, v58, v184
    v_add_f32 v58, v58, v185
    v_cvt_pk_bf16_f32 v180, v184, v185
    v_fma_f32 v190, v110, s36, -v52
    s_waitcnt lgkmcnt(0)
    v_mfma_f32_32x32x16_bf16 v[112:127], a[132:135], a[152:155], v[112:127]
    v_fma_f32 v191, v111, s36, -v52
    v_exp_f32 v188, v188
    v_exp_f32 v189, v189
    v_add_f32 v58, v58, v186
    v_mfma_f32_32x32x16_bf16 v[128:143], a[132:135], a[156:159], v[128:143]
    v_add_f32 v58, v58, v187
    v_cvt_pk_bf16_f32 v181, v186, v187
    v_exp_f32 v190, v190
    v_exp_f32 v191, v191
    v_mfma_f32_32x32x16_bf16 v[144:159], a[132:135], a[160:163], v[144:159]
    v_add_f32 v58, v58, v188
    v_add_f32 v58, v58, v189
    v_cvt_pk_bf16_f32 v182, v188, v189
    v_add_f32 v58, v58, v190
    v_add_f32 v58, v58, v191
    v_cvt_pk_bf16_f32 v183, v190, v191
    v_cmp_lt_f32 vcc, s37, v58
    s_nop 0
    s_or_b64 s[72:73], s[72:73], vcc
    s_cmp_eq_u64 s[72:73], 0
    s_cbranch_scc1 Lnf_5
    v_mov_b32 v59, 1
    ds_write_b32 v6, v59
Lnf_5:
    s_waitcnt lgkmcnt(0)
    s_barrier
    ds_read_b32 v59, v6
    s_mov_b32 s71, s76
    s_add_u32 s76, s76, 32768
    s_cmp_ge_u32 s76, 98304
    s_cselect_b32 s76, 0, s76
    s_waitcnt vmcnt(8)
    v_add_u32 v16, s71, v8
    v_add_u32 v17, s71, v9
    v_add_u32 v18, s71, v10
    v_add_u32 v19, s71, v11
    v_add_u32 v20, s71, v12
    v_add_u32 v21, s71, v13
    v_add_u32 v22, s71, v14
    v_add_u32 v23, s71, v15
    ds_read_b128 a[96:99], v16
    ds_read_b128 a[100:103], v17
    ds_read_b128 a[104:107], v18
    ds_read_b128 a[108:111], v19
    ds_read_b128 a[112:115], v20
    ds_read_b128 a[116:119], v21
    ds_read_b128 a[120:123], v22
    ds_read_b128 a[124:127], v23
    s_add_u32 m0, s29, s35
    s_add_u32 s33, s74, 4096
    buffer_load_dwordx4 v2, s[12:15], s74 offen offset:0 nt lds
    ds_write_b128 v28, v[160:163] offset:0
    ds_write_b128 v28, v[164:167] offset:3072
    ds_write_b128 v28, v[168:171] offset:1024
    ds_write_b128 v28, v[172:175] offset:4096
    ds_write_b128 v28, v[176:179] offset:2048
    ds_write_b128 v28, v[180:183] offset:5120
    buffer_load_dwordx4 v3, s[12:15], s74 offen offset:1024 nt lds
    buffer_load_dwordx4 v4, s[12:15], s74 offen offset:2048 nt lds
    buffer_load_dwordx4 v5, s[12:15], s74 offen offset:3072 nt lds
    s_waitcnt lgkmcnt(14)
    v_readfirstlane_b32 s31, v59
    s_nop 0
    s_cmp_lg_u32 s31, 0
    s_cbranch_scc1 Lslow_7
Lpost_6:
    v_add_f32 v53, v53, v56
    v_add_f32 v54, v54, v57
    v_add_f32 v55, v55, v58
    s_waitcnt lgkmcnt(13)
    v_mfma_f32_32x32x16_bf16 v[64:79], a[96:99], a[0:3], 0
    s_add_u32 m0, m0, 4096
    s_add_u32 s74, s74, 32768
    buffer_load_dwordx4 v2, s[12:15], s33 offen offset:0 nt lds
    s_waitcnt lgkmcnt(12)
    v_mfma_f32_32x32x16_bf16 v[64:79], a[100:103], a[4:7], v[64:79]
    buffer_load_dwordx4 v3, s[12:15], s33 offen offset:1024 nt lds
    s_waitcnt lgkmcnt(11)
    v_mfma_f32_32x32x16_bf16 v[64:79], a[104:107], a[8:11], v[64:79]
    buffer_load_dwordx4 v4, s[12:15], s33 offen offset:2048 nt lds
    s_waitcnt lgkmcnt(10)
    v_mfma_f32_32x32x16_bf16 v[64:79], a[108:111], a[12:15], v[64:79]
    buffer_load_dwordx4 v5, s[12:15], s33 offen offset:3072 nt lds
    s_waitcnt lgkmcnt(9)
    v_mfma_f32_32x32x16_bf16 v[64:79], a[112:115], a[16:19], v[64:79]
    s_waitcnt lgkmcnt(8)
    v_mfma_f32_32x32x16_bf16 v[64:79], a[116:119], a[20:23], v[64:79]
    s_waitcnt lgkmcnt(7)
    v_mfma_f32_32x32x16_bf16 v[64:79], a[120:123], a[24:27], v[64:79]
    s_waitcnt lgkmcnt(6)
    v_mfma_f32_32x32x16_bf16 v[64:79], a[124:127], a[28:31], v[64:79]
    v_mfma_f32_32x32x16_bf16 v[80:95], a[96:99], a[32:35], 0
    s_add_u32 m0, s71, s35
    s_add_u32 s33, s75, 4096
    buffer_load_dwordx4 v2, s[16:19], s75 offen offset:0 nt lds
    v_mfma_f32_32x32x16_bf16 v[80:95], a[100:103], a[36:39], v[80:95]
    buffer_load_dwordx4 v3, s[16:19], s75 offen offset:1024 nt lds
    s_waitcnt lgkmcnt(0)
    v_mfma_f32_32x32x16_bf16 v[80:95], a[104:107], a[40:43], v[80:95]
    s_nop 3
    v_fma_f32 v184, v64, s36, -v50
    v_fma_f32 v185, v65, s36, -v50
    v_fma_f32 v186, v66, s36, -v50
    v_fma_f32 v187, v67, s36, -v50
    v_exp_f32 v184, v184
    buffer_load_dwordx4 v4, s[16:19], s75 offen offset:2048 nt lds
    v_mfma_f32_32x32x16_bf16 v[80:95], a[108:111], a[44:47], v[80:95]
    v_exp_f32 v185, v185
    v_fma_f32 v188, v68, s36, -v50
    v_fma_f32 v189, v69, s36, -v50
    v_exp_f32 v186, v186
    buffer_load_dwordx4 v5, s[16:19], s75 offen offset:3072 nt lds
    v_mfma_f32_32x32x16_bf16 v[80:95], a[112:115], a[48:51], v[80:95]
    v_exp_f32 v187, v187
    v_add_f32 v56, v184, v185
    v_cvt_pk_bf16_f32 v160, v184, v185
    v_fma_f32 v190, v70, s36, -v50
    s_add_u32 m0, m0, 4096
    s_add_u32 s75, s75, 32768
    buffer_load_dwordx4 v2, s[16:19], s33 offen offset:0 nt lds
    v_mfma_f32_32x32x16_bf16 v[80:95], a[116:119], a[52:55], v[80:95]
    v_fma_f32 v191, v71, s36, -v50
    v_exp_f32 v188, v188
    v_exp_f32 v189, v189
    buffer_load_dwordx4 v3, s[16:19], s33 offen offset:1024 nt lds
    v_mfma_f32_32x32x16_bf16 v[80:95], a[120:123], a[56:59], v[80:95]
    v_add_f32 v56, v56, v186
    v_add_f32 v56, v56, v187
    v_cvt_pk_bf16_f32 v161, v186, v187
    v_fma_f32 v184, v72, s36, -v50
    v_fma_f32 v185, v73, s36, -v50
    buffer_load_dwordx4 v4, s[16:19], s33 offen offset:2048 nt lds
    v_mfma_f32_32x32x16_bf16 v[80:95], a[124:127], a[60:63], v[80:95]
    v_exp_f32 v190, v190
    v_exp_f32 v191, v191
    v_add_f32 v56, v56, v188
    buffer_load_dwordx4 v5, s[16:19], s33 offen offset:3072 nt lds
    v_mfma_f32_32x32x16_bf16 v[96:111], a[96:99], a[64:67], 0
    v_add_f32 v56, v56, v189
    v_cvt_pk_bf16_f32 v162, v188, v189
    v_fma_f32 v186, v74, s36, -v50
    v_fma_f32 v187, v75, s36, -v50
    v_exp_f32 v184, v184
    v_mfma_f32_32x32x16_bf16 v[96:111], a[100:103], a[68:71], v[96:111]
    v_exp_f32 v185, v185
    v_add_f32 v56, v56, v190
    v_add_f32 v56, v56, v191
    v_cvt_pk_bf16_f32 v163, v190, v191
    s_waitcnt vmcnt(16)
    s_waitcnt lgkmcnt(0)
    s_barrier
    s_mov_b32 s29, s76
    s_add_u32 s76, s76, 32768
    s_cmp_ge_u32 s76, 98304
    s_cselect_b32 s76, 0, s76
    v_add_u32 v26, s29, v24
    v_add_u32 v27, s29, v25
    v_mfma_f32_32x32x16_bf16 v[96:111], a[104:107], a[72:75], v[96:111]
    v_fma_f32 v188, v76, s36, -v50
    v_fma_f32 v189, v77, s36, -v50
    v_exp_f32 v186, v186
    v_exp_f32 v187, v187
    ds_read_b64_tr_b16 a[128:129], v26 offset:0
    ds_read_b64_tr_b16 a[130:131], v27 offset:0
    ds_read_b128 a[140:143], v29 offset:0
    v_mfma_f32_32x32x16_bf16 v[96:111], a[108:111], a[76:79], v[96:111]
    v_add_f32 v56, v56, v184
    v_add_f32 v56, v56, v185
    v_cvt_pk_bf16_f32 v164, v184, v185
    v_fma_f32 v190, v78, s36, -v50
    v_fma_f32 v191, v79, s36, -v50
    ds_read_b128 a[144:147], v29 offset:1024
    ds_read_b128 a[148:151], v29 offset:2048
    ds_read_b64_tr_b16 a[132:133], v26 offset:4096
    v_mfma_f32_32x32x16_bf16 v[96:111], a[112:115], a[80:83], v[96:111]
    v_exp_f32 v188, v188
    v_exp_f32 v189, v189
    v_add_f32 v56, v56, v186
    ds_read_b64_tr_b16 a[134:135], v27 offset:4096
    ds_read_b128 a[152:155], v29 offset:3072
    ds_read_b128 a[156:159], v29 offset:4096
    v_mfma_f32_32x32x16_bf16 v[96:111], a[116:119], a[84:87], v[96:111]
    v_add_f32 v56, v56, v187
    v_cvt_pk_bf16_f32 v165, v186, v187
    v_exp_f32 v190, v190
    v_exp_f32 v191, v191
    ds_read_b128 a[160:163], v29 offset:5120
    ds_read_b64_tr_b16 a[136:137], v26 offset:8192
    ds_read_b64_tr_b16 a[138:139], v27 offset:8192
    v_mfma_f32_32x32x16_bf16 v[96:111], a[120:123], a[88:91], v[96:111]
    v_add_f32 v56, v56, v188
    v_add_f32 v56, v56, v189
    v_cvt_pk_bf16_f32 v166, v188, v189
    v_add_f32 v56, v56, v190
    v_add_f32 v56, v56, v191
    ds_read_b128 a[164:167], v29 offset:6144
    ds_read_b128 a[168:171], v29 offset:7168
    ds_read_b128 a[172:175], v29 offset:8192
    v_mfma_f32_32x32x16_bf16 v[96:111], a[124:127], a[92:95], v[96:111]
    v_cvt_pk_bf16_f32 v167, v190, v191
    s_mov_b32 s28, 0
Lloop_32:
    s_waitcnt lgkmcnt(10)
    v_mfma_f32_32x32x16_bf16 v[112:127], a[128:131], a[140:143], v[112:127]
    v_cmp_lt_f32 vcc, s37, v56
    s_nop 0
    s_mov_b64 s[72:73], vcc
    v_fma_f32 v192, v80, s36, -v51
    v_fma_f32 v193, v81, s36, -v51
    v_fma_f32 v194, v82, s36, -v51
    v_fma_f32 v195, v83, s36, -v51
    v_mfma_f32_32x32x16_bf16 v[128:143], a[128:131], a[144:147], v[128:143]
    v_exp_f32 v192, v192
    v_exp_f32 v193, v193
    v_fma_f32 v196, v84, s36, -v51
    v_fma_f32 v197, v85, s36, -v51
    v_mfma_f32_32x32x16_bf16 v[144:159], a[128:131], a[148:151], v[144:159]
    v_exp_f32 v194, v194
    v_exp_f32 v195, v195
    v_add_f32 v57, v192, v193
    v_cvt_pk_bf16_f32 v168, v192, v193
    s_waitcnt lgkmcnt(5)
    v_mfma_f32_32x32x16_bf16 v[112:127], a[132:135], a[152:155], v[112:127]
    ds_read_b64_tr_b16 a[128:129], v26 offset:12288
    ds_read_b64_tr_b16 a[130:131], v27 offset:12288
    v_fma_f32 v198, v86, s36, -v51
    v_fma_f32 v199, v87, s36, -v51
    v_exp_f32 v196, v196
    v_exp_f32 v197, v197
    v_mfma_f32_32x32x16_bf16 v[128:143], a[132:135], a[156:159], v[128:143]
    ds_read_b128 a[140:143], v29 offset:9216
    ds_read_b128 a[144:147], v29 offset:10240
    v_add_f32 v57, v57, v194
    v_add_f32 v57, v57, v195
    v_cvt_pk_bf16_f32 v169, v194, v195
    v_fma_f32 v192, v88, s36, -v51
    v_fma_f32 v193, v89, s36, -v51
    v_exp_f32 v198, v198
    v_mfma_f32_32x32x16_bf16 v[144:159], a[132:135], a[160:163], v[144:159]
    ds_read_b128 a[148:151], v29 offset:11264
    v_exp_f32 v199, v199
    v_add_f32 v57, v57, v196
    v_add_f32 v57, v57, v197
    v_cvt_pk_bf16_f32 v170, v196, v197
    v_fma_f32 v194, v90, s36, -v51
    s_waitcnt lgkmcnt(5)
    v_mfma_f32_32x32x16_bf16 v[112:127], a[136:139], a[164:167], v[112:127]
    ds_read_b64_tr_b16 a[132:133], v26 offset:16384
    ds_read_b64_tr_b16 a[134:135], v27 offset:16384
    v_fma_f32 v195, v91, s36, -v51
    v_exp_f32 v192, v192
    v_exp_f32 v193, v193
    v_add_f32 v57, v57, v198
    v_mfma_f32_32x32x16_bf16 v[128:143], a[136:139], a[168:171], v[128:143]
    ds_read_b128 a[152:155], v29 offset:12288
    ds_read_b128 a[156:159], v29 offset:13312
    v_add_f32 v57, v57, v199
    v_cvt_pk_bf16_f32 v171, v198, v199
    v_fma_f32 v196, v92, s36, -v51
    v_fma_f32 v197, v93, s36, -v51
    v_exp_f32 v194, v194
    v_mfma_f32_32x32x16_bf16 v[144:159], a[136:139], a[172:175], v[144:159]
    ds_read_b128 a[160:163], v29 offset:14336
    v_exp_f32 v195, v195
    v_add_f32 v57, v57, v192
    v_add_f32 v57, v57, v193
    v_cvt_pk_bf16_f32 v172, v192, v193
    v_fma_f32 v198, v94, s36, -v51
    s_waitcnt lgkmcnt(5)
    v_mfma_f32_32x32x16_bf16 v[112:127], a[128:131], a[140:143], v[112:127]
    ds_read_b64_tr_b16 a[136:137], v26 offset:20480
    ds_read_b64_tr_b16 a[138:139], v27 offset:20480
    v_fma_f32 v199, v95, s36, -v51
    v_exp_f32 v196, v196
    v_exp_f32 v197, v197
    v_add_f32 v57, v57, v194
    v_mfma_f32_32x32x16_bf16 v[128:143], a[128:131], a[144:147], v[128:143]
    ds_read_b128 a[164:167], v29 offset:15360
    ds_read_b128 a[168:171], v29 offset:16384
    v_add_f32 v57, v57, v195
    v_cvt_pk_bf16_f32 v173, v194, v195
    v_exp_f32 v198, v198
    v_exp_f32 v199, v199
    v_mfma_f32_32x32x16_bf16 v[144:159], a[128:131], a[148:151], v[144:159]
    ds_read_b128 a[172:175], v29 offset:17408
    v_add_f32 v57, v57, v196
    v_add_f32 v57, v57, v197
    v_cvt_pk_bf16_f32 v174, v196, v197
    v_add_f32 v57, v57, v198
    v_add_f32 v57, v57, v199
    v_cvt_pk_bf16_f32 v175, v198, v199
    s_waitcnt lgkmcnt(5)
    v_mfma_f32_32x32x16_bf16 v[112:127], a[132:135], a[152:155], v[112:127]
    ds_read_b64_tr_b16 a[128:129], v26 offset:24576
    ds_read_b64_tr_b16 a[130:131], v27 offset:24576
    v_cmp_lt_f32 vcc, s37, v57
    s_nop 0
    s_or_b64 s[72:73], s[72:73], vcc
    v_fma_f32 v184, v96, s36, -v52
    v_fma_f32 v185, v97, s36, -v52
    v_fma_f32 v186, v98, s36, -v52
    v_fma_f32 v187, v99, s36, -v52
    v_mfma_f32_32x32x16_bf16 v[128:143], a[132:135], a[156:159], v[128:143]
    ds_read_b128 a[140:143], v29 offset:18432
    ds_read_b128 a[144:147], v29 offset:19456
    v_exp_f32 v184, v184
    v_exp_f32 v185, v185
    v_fma_f32 v188, v100, s36, -v52
    v_fma_f32 v189, v101, s36, -v52
    v_mfma_f32_32x32x16_bf16 v[144:159], a[132:135], a[160:163], v[144:159]
    ds_read_b128 a[148:151], v29 offset:20480
    v_exp_f32 v186, v186
    v_exp_f32 v187, v187
    v_add_f32 v58, v184, v185
    v_cvt_pk_bf16_f32 v176, v184, v185
    s_waitcnt lgkmcnt(5)
    v_mfma_f32_32x32x16_bf16 v[112:127], a[136:139], a[164:167], v[112:127]
    ds_read_b64_tr_b16 a[132:133], v26 offset:28672
    ds_read_b64_tr_b16 a[134:135], v27 offset:28672
    v_fma_f32 v190, v102, s36, -v52
    v_fma_f32 v191, v103, s36, -v52
    v_exp_f32 v188, v188
    v_exp_f32 v189, v189
    v_mfma_f32_32x32x16_bf16 v[128:143], a[136:139], a[168:171], v[128:143]
    ds_read_b128 a[152:155], v29 offset:21504
    ds_read_b128 a[156:159], v29 offset:22528
    v_add_f32 v58, v58, v186
    v_add_f32 v58, v58, v187
    v_cvt_pk_bf16_f32 v177, v186, v187
    v_fma_f32 v184, v104, s36, -v52
    v_fma_f32 v185, v105, s36, -v52
    v_exp_f32 v190, v190
    v_mfma_f32_32x32x16_bf16 v[144:159], a[136:139], a[172:175], v[144:159]
    ds_read_b128 a[160:163], v29 offset:23552
    v_exp_f32 v191, v191
    v_add_f32 v58, v58, v188
    v_add_f32 v58, v58, v189
    v_cvt_pk_bf16_f32 v178, v188, v189
    v_fma_f32 v186, v106, s36, -v52
    s_waitcnt lgkmcnt(5)
    v_mfma_f32_32x32x16_bf16 v[112:127], a[128:131], a[140:143], v[112:127]
    v_fma_f32 v187, v107, s36, -v52
    v_exp_f32 v184, v184
    v_exp_f32 v185, v185
    v_add_f32 v58, v58, v190
    v_mfma_f32_32x32x16_bf16 v[128:143], a[128:131], a[144:147], v[128:143]
    v_add_f32 v58, v58, v191
    v_cvt_pk_bf16_f32 v179, v190, v191
    v_fma_f32 v188, v108, s36, -v52
    v_fma_f32 v189, v109, s36, -v52
    v_exp_f32 v186, v186
    v_mfma_f32_32x32x16_bf16 v[144:159], a[128:131], a[148:151], v[144:159]
    v_exp_f32 v187, v187
    v_add_f32 v58, v58, v184
    v_add_f32 v58, v58, v185
    v_cvt_pk_bf16_f32 v180, v184, v185
    v_fma_f32 v190, v110, s36, -v52
    s_waitcnt lgkmcnt(0)
    v_mfma_f32_32x32x16_bf16 v[112:127], a[132:135], a[152:155], v[112:127]
    v_fma_f32 v191, v111, s36, -v52
    v_exp_f32 v188, v188
    v_exp_f32 v189, v189
    v_add_f32 v58, v58, v186
    v_mfma_f32_32x32x16_bf16 v[128:143], a[132:135], a[156:159], v[128:143]
    v_add_f32 v58, v58, v187
    v_cvt_pk_bf16_f32 v181, v186, v187
    v_exp_f32 v190, v190
    v_exp_f32 v191, v191
    v_mfma_f32_32x32x16_bf16 v[144:159], a[132:135], a[160:163], v[144:159]
    v_add_f32 v58, v58, v188
    v_add_f32 v58, v58, v189
    v_cvt_pk_bf16_f32 v182, v188, v189
    v_add_f32 v58, v58, v190
    v_add_f32 v58, v58, v191
    v_cvt_pk_bf16_f32 v183, v190, v191
    v_cmp_lt_f32 vcc, s37, v58
    s_nop 0
    s_or_b64 s[72:73], s[72:73], vcc
    s_cmp_eq_u64 s[72:73], 0
    s_cbranch_scc1 Lnf_33
    v_mov_b32 v59, 1
    ds_write_b32 v6, v59
Lnf_33:
    s_waitcnt lgkmcnt(0)
    s_barrier
    ds_read_b32 v59, v6
    s_mov_b32 s71, s76
    s_add_u32 s76, s76, 32768
    s_cmp_ge_u32 s76, 98304
    s_cselect_b32 s76, 0, s76
    s_waitcnt vmcnt(8)
    v_add_u32 v16, s71, v8
    v_add_u32 v17, s71, v9
    v_add_u32 v18, s71, v10
    v_add_u32 v19, s71, v11
    v_add_u32 v20, s71, v12
    v_add_u32 v21, s71, v13
    v_add_u32 v22, s71, v14
    v_add_u32 v23, s71, v15
    ds_read_b128 a[96:99], v16
    ds_read_b128 a[100:103], v17
    ds_read_b128 a[104:107], v18
    ds_read_b128 a[108:111], v19
    ds_read_b128 a[112:115], v20
    ds_read_b128 a[116:119], v21
    ds_read_b128 a[120:123], v22
    ds_read_b128 a[124:127], v23
    s_add_u32 m0, s29, s35
    s_add_u32 s33, s74, 4096
    buffer_load_dwordx4 v2, s[12:15], s74 offen offset:0 nt lds
    ds_write_b128 v28, v[160:163] offset:0
    ds_write_b128 v28, v[164:167] offset:3072
    ds_write_b128 v28, v[168:171] offset:1024
    ds_write_b128 v28, v[172:175] offset:4096
    ds_write_b128 v28, v[176:179] offset:2048
    ds_write_b128 v28, v[180:183] offset:5120
    buffer_load_dwordx4 v3, s[12:15], s74 offen offset:1024 nt lds
    buffer_load_dwordx4 v4, s[12:15], s74 offen offset:2048 nt lds
    buffer_load_dwordx4 v5, s[12:15], s74 offen offset:3072 nt lds
    s_waitcnt lgkmcnt(14)
    v_readfirstlane_b32 s31, v59
    s_nop 0
    s_cmp_lg_u32 s31, 0
    s_cbranch_scc1 Lslow_35
Lpost_34:
    v_add_f32 v53, v53, v56
    v_add_f32 v54, v54, v57
    v_add_f32 v55, v55, v58
    s_waitcnt lgkmcnt(13)
    v_mfma_f32_32x32x16_bf16 v[64:79], a[96:99], a[0:3], 0
    s_add_u32 m0, m0, 4096
    s_add_u32 s74, s74, 32768
    buffer_load_dwordx4 v2, s[12:15], s33 offen offset:0 nt lds
    s_waitcnt lgkmcnt(12)
    v_mfma_f32_32x32x16_bf16 v[64:79], a[100:103], a[4:7], v[64:79]
    buffer_load_dwordx4 v3, s[12:15], s33 offen offset:1024 nt lds
    s_waitcnt lgkmcnt(11)
    v_mfma_f32_32x32x16_bf16 v[64:79], a[104:107], a[8:11], v[64:79]
    buffer_load_dwordx4 v4, s[12:15], s33 offen offset:2048 nt lds
    s_waitcnt lgkmcnt(10)
    v_mfma_f32_32x32x16_bf16 v[64:79], a[108:111], a[12:15], v[64:79]
    buffer_load_dwordx4 v5, s[12:15], s33 offen offset:3072 nt lds
    s_waitcnt lgkmcnt(9)
    v_mfma_f32_32x32x16_bf16 v[64:79], a[112:115], a[16:19], v[64:79]
    s_waitcnt lgkmcnt(8)
    v_mfma_f32_32x32x16_bf16 v[64:79], a[116:119], a[20:23], v[64:79]
    s_waitcnt lgkmcnt(7)
    v_mfma_f32_32x32x16_bf16 v[64:79], a[120:123], a[24:27], v[64:79]
    s_waitcnt lgkmcnt(6)
    v_mfma_f32_32x32x16_bf16 v[64:79], a[124:127], a[28:31], v[64:79]
    v_mfma_f32_32x32x16_bf16 v[80:95], a[96:99], a[32:35], 0
    s_add_u32 m0, s71, s35
    s_add_u32 s33, s75, 4096
    buffer_load_dwordx4 v2, s[16:19], s75 offen offset:0 nt lds
    v_mfma_f32_32x32x16_bf16 v[80:95], a[100:103], a[36:39], v[80:95]
    buffer_load_dwordx4 v3, s[16:19], s75 offen offset:1024 nt lds
    s_waitcnt lgkmcnt(0)
    v_mfma_f32_32x32x16_bf16 v[80:95], a[104:107], a[40:43], v[80:95]
    s_nop 3
    v_fma_f32 v184, v64, s36, -v50
    v_fma_f32 v185, v65, s36, -v50
    v_fma_f32 v186, v66, s36, -v50
    v_fma_f32 v187, v67, s36, -v50
    v_exp_f32 v184, v184
    buffer_load_dwordx4 v4, s[16:19], s75 offen offset:2048 nt lds
    v_mfma_f32_32x32x16_bf16 v[80:95], a[108:111], a[44:47], v[80:95]
    v_exp_f32 v185, v185
    v_fma_f32 v188, v68, s36, -v50
    v_fma_f32 v189, v69, s36, -v50
    v_exp_f32 v186, v186
    buffer_load_dwordx4 v5, s[16:19], s75 offen offset:3072 nt lds
    v_mfma_f32_32x32x16_bf16 v[80:95], a[112:115], a[48:51], v[80:95]
    v_exp_f32 v187, v187
    v_add_f32 v56, v184, v185
    v_cvt_pk_bf16_f32 v160, v184, v185
    v_fma_f32 v190, v70, s36, -v50
    s_add_u32 m0, m0, 4096
    s_add_u32 s75, s75, 32768
    buffer_load_dwordx4 v2, s[16:19], s33 offen offset:0 nt lds
    v_mfma_f32_32x32x16_bf16 v[80:95], a[116:119], a[52:55], v[80:95]
    v_fma_f32 v191, v71, s36, -v50
    v_exp_f32 v188, v188
    v_exp_f32 v189, v189
    buffer_load_dwordx4 v3, s[16:19], s33 offen offset:1024 nt lds
    v_mfma_f32_32x32x16_bf16 v[80:95], a[120:123], a[56:59], v[80:95]
    v_add_f32 v56, v56, v186
    v_add_f32 v56, v56, v187
    v_cvt_pk_bf16_f32 v161, v186, v187
    v_fma_f32 v184, v72, s36, -v50
    v_fma_f32 v185, v73, s36, -v50
    buffer_load_dwordx4 v4, s[16:19], s33 offen offset:2048 nt lds
    v_mfma_f32_32x32x16_bf16 v[80:95], a[124:127], a[60:63], v[80:95]
    v_exp_f32 v190, v190
    v_exp_f32 v191, v191
    v_add_f32 v56, v56, v188
    buffer_load_dwordx4 v5, s[16:19], s33 offen offset:3072 nt lds
    v_mfma_f32_32x32x16_bf16 v[96:111], a[96:99], a[64:67], 0
    v_add_f32 v56, v56, v189
    v_cvt_pk_bf16_f32 v162, v188, v189
    v_fma_f32 v186, v74, s36, -v50
    v_fma_f32 v187, v75, s36, -v50
    v_exp_f32 v184, v184
    v_mfma_f32_32x32x16_bf16 v[96:111], a[100:103], a[68:71], v[96:111]
    v_exp_f32 v185, v185
    v_add_f32 v56, v56, v190
    v_add_f32 v56, v56, v191
    v_cvt_pk_bf16_f32 v163, v190, v191
    s_waitcnt vmcnt(16)
    s_waitcnt lgkmcnt(0)
    s_barrier
    s_mov_b32 s29, s76
    s_add_u32 s76, s76, 32768
    s_cmp_ge_u32 s76, 98304
    s_cselect_b32 s76, 0, s76
    v_add_u32 v26, s29, v24
    v_add_u32 v27, s29, v25
    v_mfma_f32_32x32x16_bf16 v[96:111], a[104:107], a[72:75], v[96:111]
    v_fma_f32 v188, v76, s36, -v50
    v_fma_f32 v189, v77, s36, -v50
    v_exp_f32 v186, v186
    v_exp_f32 v187, v187
    ds_read_b64_tr_b16 a[128:129], v26 offset:0
    ds_read_b64_tr_b16 a[130:131], v27 offset:0
    ds_read_b128 a[140:143], v29 offset:0
    v_mfma_f32_32x32x16_bf16 v[96:111], a[108:111], a[76:79], v[96:111]
    v_add_f32 v56, v56, v184
    v_add_f32 v56, v56, v185
    v_cvt_pk_bf16_f32 v164, v184, v185
    v_fma_f32 v190, v78, s36, -v50
    v_fma_f32 v191, v79, s36, -v50
    ds_read_b128 a[144:147], v29 offset:1024
    ds_read_b128 a[148:151], v29 offset:2048
    ds_read_b64_tr_b16 a[132:133], v26 offset:4096
    v_mfma_f32_32x32x16_bf16 v[96:111], a[112:115], a[80:83], v[96:111]
    v_exp_f32 v188, v188
    v_exp_f32 v189, v189
    v_add_f32 v56, v56, v186
    ds_read_b64_tr_b16 a[134:135], v27 offset:4096
    ds_read_b128 a[152:155], v29 offset:3072
    ds_read_b128 a[156:159], v29 offset:4096
    v_mfma_f32_32x32x16_bf16 v[96:111], a[116:119], a[84:87], v[96:111]
    v_add_f32 v56, v56, v187
    v_cvt_pk_bf16_f32 v165, v186, v187
    v_exp_f32 v190, v190
    v_exp_f32 v191, v191
    ds_read_b128 a[160:163], v29 offset:5120
    ds_read_b64_tr_b16 a[136:137], v26 offset:8192
    ds_read_b64_tr_b16 a[138:139], v27 offset:8192
    v_mfma_f32_32x32x16_bf16 v[96:111], a[120:123], a[88:91], v[96:111]
    v_add_f32 v56, v56, v188
    v_add_f32 v56, v56, v189
    v_cvt_pk_bf16_f32 v166, v188, v189
    v_add_f32 v56, v56, v190
    v_add_f32 v56, v56, v191
    ds_read_b128 a[164:167], v29 offset:6144
    ds_read_b128 a[168:171], v29 offset:7168
    ds_read_b128 a[172:175], v29 offset:8192
    v_mfma_f32_32x32x16_bf16 v[96:111], a[124:127], a[92:95], v[96:111]
    v_cvt_pk_bf16_f32 v167, v190, v191
    s_add_u32 s28, s28, 1
    s_cmp_lt_u32 s28, 4
    s_cbranch_scc1 Lloop_32
    s_waitcnt lgkmcnt(10)
    v_mfma_f32_32x32x16_bf16 v[112:127], a[128:131], a[140:143], v[112:127]
    v_cmp_lt_f32 vcc, s37, v56
    s_nop 0
    s_mov_b64 s[72:73], vcc
    v_fma_f32 v192, v80, s36, -v51
    v_fma_f32 v193, v81, s36, -v51
    v_fma_f32 v194, v82, s36, -v51
    v_fma_f32 v195, v83, s36, -v51
    v_mfma_f32_32x32x16_bf16 v[128:143], a[128:131], a[144:147], v[128:143]
    v_exp_f32 v192, v192
    v_exp_f32 v193, v193
    v_fma_f32 v196, v84, s36, -v51
    v_fma_f32 v197, v85, s36, -v51
    v_mfma_f32_32x32x16_bf16 v[144:159], a[128:131], a[148:151], v[144:159]
    v_exp_f32 v194, v194
    v_exp_f32 v195, v195
    v_add_f32 v57, v192, v193
    v_cvt_pk_bf16_f32 v168, v192, v193
    s_waitcnt lgkmcnt(5)
    v_mfma_f32_32x32x16_bf16 v[112:127], a[132:135], a[152:155], v[112:127]
    ds_read_b64_tr_b16 a[128:129], v26 offset:12288
    ds_read_b64_tr_b16 a[130:131], v27 offset:12288
    v_fma_f32 v198, v86, s36, -v51
    v_fma_f32 v199, v87, s36, -v51
    v_exp_f32 v196, v196
    v_exp_f32 v197, v197
    v_mfma_f32_32x32x16_bf16 v[128:143], a[132:135], a[156:159], v[128:143]
    ds_read_b128 a[140:143], v29 offset:9216
    ds_read_b128 a[144:147], v29 offset:10240
    v_add_f32 v57, v57, v194
    v_add_f32 v57, v57, v195
    v_cvt_pk_bf16_f32 v169, v194, v195
    v_fma_f32 v192, v88, s36, -v51
    v_fma_f32 v193, v89, s36, -v51
    v_exp_f32 v198, v198
    v_mfma_f32_32x32x16_bf16 v[144:159], a[132:135], a[160:163], v[144:159]
    ds_read_b128 a[148:151], v29 offset:11264
    v_exp_f32 v199, v199
    v_add_f32 v57, v57, v196
    v_add_f32 v57, v57, v197
    v_cvt_pk_bf16_f32 v170, v196, v197
    v_fma_f32 v194, v90, s36, -v51
    s_waitcnt lgkmcnt(5)
    v_mfma_f32_32x32x16_bf16 v[112:127], a[136:139], a[164:167], v[112:127]
    ds_read_b64_tr_b16 a[132:133], v26 offset:16384
    ds_read_b64_tr_b16 a[134:135], v27 offset:16384
    v_fma_f32 v195, v91, s36, -v51
    v_exp_f32 v192, v192
    v_exp_f32 v193, v193
    v_add_f32 v57, v57, v198
    v_mfma_f32_32x32x16_bf16 v[128:143], a[136:139], a[168:171], v[128:143]
    ds_read_b128 a[152:155], v29 offset:12288
    ds_read_b128 a[156:159], v29 offset:13312
    v_add_f32 v57, v57, v199
    v_cvt_pk_bf16_f32 v171, v198, v199
    v_fma_f32 v196, v92, s36, -v51
    v_fma_f32 v197, v93, s36, -v51
    v_exp_f32 v194, v194
    v_mfma_f32_32x32x16_bf16 v[144:159], a[136:139], a[172:175], v[144:159]
    ds_read_b128 a[160:163], v29 offset:14336
    v_exp_f32 v195, v195
    v_add_f32 v57, v57, v192
    v_add_f32 v57, v57, v193
    v_cvt_pk_bf16_f32 v172, v192, v193
    v_fma_f32 v198, v94, s36, -v51
    s_waitcnt lgkmcnt(5)
    v_mfma_f32_32x32x16_bf16 v[112:127], a[128:131], a[140:143], v[112:127]
    ds_read_b64_tr_b16 a[136:137], v26 offset:20480
    ds_read_b64_tr_b16 a[138:139], v27 offset:20480
    v_fma_f32 v199, v95, s36, -v51
    v_exp_f32 v196, v196
    v_exp_f32 v197, v197
    v_add_f32 v57, v57, v194
    v_mfma_f32_32x32x16_bf16 v[128:143], a[128:131], a[144:147], v[128:143]
    ds_read_b128 a[164:167], v29 offset:15360
    ds_read_b128 a[168:171], v29 offset:16384
    v_add_f32 v57, v57, v195
    v_cvt_pk_bf16_f32 v173, v194, v195
    v_exp_f32 v198, v198
    v_exp_f32 v199, v199
    v_mfma_f32_32x32x16_bf16 v[144:159], a[128:131], a[148:151], v[144:159]
    ds_read_b128 a[172:175], v29 offset:17408
    v_add_f32 v57, v57, v196
    v_add_f32 v57, v57, v197
    v_cvt_pk_bf16_f32 v174, v196, v197
    v_add_f32 v57, v57, v198
    v_add_f32 v57, v57, v199
    v_cvt_pk_bf16_f32 v175, v198, v199
    s_waitcnt lgkmcnt(5)
    v_mfma_f32_32x32x16_bf16 v[112:127], a[132:135], a[152:155], v[112:127]
    ds_read_b64_tr_b16 a[128:129], v26 offset:24576
    ds_read_b64_tr_b16 a[130:131], v27 offset:24576
    v_cmp_lt_f32 vcc, s37, v57
    s_nop 0
    s_or_b64 s[72:73], s[72:73], vcc
    v_fma_f32 v184, v96, s36, -v52
    v_fma_f32 v185, v97, s36, -v52
    v_fma_f32 v186, v98, s36, -v52
    v_fma_f32 v187, v99, s36, -v52
    v_mfma_f32_32x32x16_bf16 v[128:143], a[132:135], a[156:159], v[128:143]
    ds_read_b128 a[140:143], v29 offset:18432
    ds_read_b128 a[144:147], v29 offset:19456
    v_exp_f32 v184, v184
    v_exp_f32 v185, v185
    v_fma_f32 v188, v100, s36, -v52
    v_fma_f32 v189, v101, s36, -v52
    v_mfma_f32_32x32x16_bf16 v[144:159], a[132:135], a[160:163], v[144:159]
    ds_read_b128 a[148:151], v29 offset:20480
    v_exp_f32 v186, v186
    v_exp_f32 v187, v187
    v_add_f32 v58, v184, v185
    v_cvt_pk_bf16_f32 v176, v184, v185
    s_waitcnt lgkmcnt(5)
    v_mfma_f32_32x32x16_bf16 v[112:127], a[136:139], a[164:167], v[112:127]
    ds_read_b64_tr_b16 a[132:133], v26 offset:28672
    ds_read_b64_tr_b16 a[134:135], v27 offset:28672
    v_fma_f32 v190, v102, s36, -v52
    v_fma_f32 v191, v103, s36, -v52
    v_exp_f32 v188, v188
    v_exp_f32 v189, v189
    v_mfma_f32_32x32x16_bf16 v[128:143], a[136:139], a[168:171], v[128:143]
    ds_read_b128 a[152:155], v29 offset:21504
    ds_read_b128 a[156:159], v29 offset:22528
    v_add_f32 v58, v58, v186
    v_add_f32 v58, v58, v187
    v_cvt_pk_bf16_f32 v177, v186, v187
    v_fma_f32 v184, v104, s36, -v52
    v_fma_f32 v185, v105, s36, -v52
    v_exp_f32 v190, v190
    v_mfma_f32_32x32x16_bf16 v[144:159], a[136:139], a[172:175], v[144:159]
    ds_read_b128 a[160:163], v29 offset:23552
    v_exp_f32 v191, v191
    v_add_f32 v58, v58, v188
    v_add_f32 v58, v58, v189
    v_cvt_pk_bf16_f32 v178, v188, v189
    v_fma_f32 v186, v106, s36, -v52
    s_waitcnt lgkmcnt(5)
    v_mfma_f32_32x32x16_bf16 v[112:127], a[128:131], a[140:143], v[112:127]
    v_fma_f32 v187, v107, s36, -v52
    v_exp_f32 v184, v184
    v_exp_f32 v185, v185
    v_add_f32 v58, v58, v190
    v_mfma_f32_32x32x16_bf16 v[128:143], a[128:131], a[144:147], v[128:143]
    v_add_f32 v58, v58, v191
    v_cvt_pk_bf16_f32 v179, v190, v191
    v_fma_f32 v188, v108, s36, -v52
    v_fma_f32 v189, v109, s36, -v52
    v_exp_f32 v186, v186
    v_mfma_f32_32x32x16_bf16 v[144:159], a[128:131], a[148:151], v[144:159]
    v_exp_f32 v187, v187
    v_add_f32 v58, v58, v184
    v_add_f32 v58, v58, v185
    v_cvt_pk_bf16_f32 v180, v184, v185
    v_fma_f32 v190, v110, s36, -v52
    s_waitcnt lgkmcnt(0)
    v_mfma_f32_32x32x16_bf16 v[112:127], a[132:135], a[152:155], v[112:127]
    v_fma_f32 v191, v111, s36, -v52
    v_exp_f32 v188, v188
    v_exp_f32 v189, v189
    v_add_f32 v58, v58, v186
    v_mfma_f32_32x32x16_bf16 v[128:143], a[132:135], a[156:159], v[128:143]
    v_add_f32 v58, v58, v187
    v_cvt_pk_bf16_f32 v181, v186, v187
    v_exp_f32 v190, v190
    v_exp_f32 v191, v191
    v_mfma_f32_32x32x16_bf16 v[144:159], a[132:135], a[160:163], v[144:159]
    v_add_f32 v58, v58, v188
    v_add_f32 v58, v58, v189
    v_cvt_pk_bf16_f32 v182, v188, v189
    v_add_f32 v58, v58, v190
    v_add_f32 v58, v58, v191
    v_cvt_pk_bf16_f32 v183, v190, v191
    v_cmp_lt_f32 vcc, s37, v58
    s_nop 0
    s_or_b64 s[72:73], s[72:73], vcc
    s_cmp_eq_u64 s[72:73], 0
    s_cbranch_scc1 Lnf_36
    v_mov_b32 v59, 1
    ds_write_b32 v6, v59
Lnf_36:
    s_waitcnt lgkmcnt(0)
    s_barrier
    ds_read_b32 v59, v6
    s_mov_b32 s71, s76
    s_add_u32 s76, s76, 32768
    s_cmp_ge_u32 s76, 98304
    s_cselect_b32 s76, 0, s76
    s_waitcnt vmcnt(8)
    v_add_u32 v16, s71, v8
    v_add_u32 v17, s71, v9
    v_add_u32 v18, s71, v10
    v_add_u32 v19, s71, v11
    v_add_u32 v20, s71, v12
    v_add_u32 v21, s71, v13
    v_add_u32 v22, s71, v14
    v_add_u32 v23, s71, v15
    ds_read_b128 a[96:99], v16
    ds_read_b128 a[100:103], v17
    ds_read_b128 a[104:107], v18
    ds_read_b128 a[108:111], v19
    ds_read_b128 a[112:115], v20
    ds_read_b128 a[116:119], v21
    ds_read_b128 a[120:123], v22
    ds_read_b128 a[124:127], v23
    s_add_u32 s74, s98, 0x2000000
    s_add_u32 m0, s29, s35
    s_add_u32 s33, s74, 4096
    buffer_load_dwordx4 v2, s[12:15], s74 offen offset:0 nt lds
    ds_write_b128 v28, v[160:163] offset:0
    ds_write_b128 v28, v[164:167] offset:3072
    ds_write_b128 v28, v[168:171] offset:1024
    ds_write_b128 v28, v[172:175] offset:4096
    ds_write_b128 v28, v[176:179] offset:2048
    ds_write_b128 v28, v[180:183] offset:5120
    buffer_load_dwordx4 v3, s[12:15], s74 offen offset:1024 nt lds
    buffer_load_dwordx4 v4, s[12:15], s74 offen offset:2048 nt lds
    buffer_load_dwordx4 v5, s[12:15], s74 offen offset:3072 nt lds
    s_waitcnt lgkmcnt(14)
    v_readfirstlane_b32 s31, v59
    s_nop 0
    s_cmp_lg_u32 s31, 0
    s_cbranch_scc1 Lslow_38
Lpost_37:
    v_add_f32 v53, v53, v56
    v_add_f32 v54, v54, v57
    v_add_f32 v55, v55, v58
    s_waitcnt lgkmcnt(13)
    v_mfma_f32_32x32x16_bf16 v[64:79], a[96:99], a[0:3], 0
    s_add_u32 m0, m0, 4096
    s_add_u32 s74, s74, 32768
    buffer_load_dwordx4 v2, s[12:15], s33 offen offset:0 nt lds
    s_waitcnt lgkmcnt(12)
    v_mfma_f32_32x32x16_bf16 v[64:79], a[100:103], a[4:7], v[64:79]
    buffer_load_dwordx4 v3, s[12:15], s33 offen offset:1024 nt lds
    s_waitcnt lgkmcnt(11)
    v_mfma_f32_32x32x16_bf16 v[64:79], a[104:107], a[8:11], v[64:79]
    buffer_load_dwordx4 v4, s[12:15], s33 offen offset:2048 nt lds
    s_waitcnt lgkmcnt(10)
    v_mfma_f32_32x32x16_bf16 v[64:79], a[108:111], a[12:15], v[64:79]
    buffer_load_dwordx4 v5, s[12:15], s33 offen offset:3072 nt lds
    s_waitcnt lgkmcnt(9)
    v_mfma_f32_32x32x16_bf16 v[64:79], a[112:115], a[16:19], v[64:79]
    s_waitcnt lgkmcnt(8)
    v_mfma_f32_32x32x16_bf16 v[64:79], a[116:119], a[20:23], v[64:79]
    s_waitcnt lgkmcnt(7)
    v_mfma_f32_32x32x16_bf16 v[64:79], a[120:123], a[24:27], v[64:79]
    s_waitcnt lgkmcnt(6)
    v_mfma_f32_32x32x16_bf16 v[64:79], a[124:127], a[28:31], v[64:79]
    v_mfma_f32_32x32x16_bf16 v[80:95], a[96:99], a[32:35], 0
    s_add_u32 m0, s71, s35
    s_add_u32 s33, s75, 4096
    buffer_load_dwordx4 v2, s[16:19], s75 offen offset:0 nt lds
    v_mfma_f32_32x32x16_bf16 v[80:95], a[100:103], a[36:39], v[80:95]
    buffer_load_dwordx4 v3, s[16:19], s75 offen offset:1024 nt lds
    s_waitcnt lgkmcnt(0)
    v_mfma_f32_32x32x16_bf16 v[80:95], a[104:107], a[40:43], v[80:95]
    s_nop 3
    v_fma_f32 v184, v64, s36, -v50
    v_fma_f32 v185, v65, s36, -v50
    v_fma_f32 v186, v66, s36, -v50
    v_fma_f32 v187, v67, s36, -v50
    v_exp_f32 v184, v184
    buffer_load_dwordx4 v4, s[16:19], s75 offen offset:2048 nt lds
    v_mfma_f32_32x32x16_bf16 v[80:95], a[108:111], a[44:47], v[80:95]
    v_exp_f32 v185, v185
    v_fma_f32 v188, v68, s36, -v50
    v_fma_f32 v189, v69, s36, -v50
    v_exp_f32 v186, v186
    buffer_load_dwordx4 v5, s[16:19], s75 offen offset:3072 nt lds
    v_mfma_f32_32x32x16_bf16 v[80:95], a[112:115], a[48:51], v[80:95]
    v_exp_f32 v187, v187
    v_add_f32 v56, v184, v185
    v_cvt_pk_bf16_f32 v160, v184, v185
    v_fma_f32 v190, v70, s36, -v50
    s_add_u32 m0, m0, 4096
    s_add_u32 s75, s75, 32768
    buffer_load_dwordx4 v2, s[16:19], s33 offen offset:0 nt lds
    v_mfma_f32_32x32x16_bf16 v[80:95], a[116:119], a[52:55], v[80:95]
    v_fma_f32 v191, v71, s36, -v50
    v_exp_f32 v188, v188
    v_exp_f32 v189, v189
    buffer_load_dwordx4 v3, s[16:19], s33 offen offset:1024 nt lds
    v_mfma_f32_32x32x16_bf16 v[80:95], a[120:123], a[56:59], v[80:95]
    v_add_f32 v56, v56, v186
    v_add_f32 v56, v56, v187
    v_cvt_pk_bf16_f32 v161, v186, v187
    v_fma_f32 v184, v72, s36, -v50
    v_fma_f32 v185, v73, s36, -v50
    buffer_load_dwordx4 v4, s[16:19], s33 offen offset:2048 nt lds
    v_mfma_f32_32x32x16_bf16 v[80:95], a[124:127], a[60:63], v[80:95]
    v_exp_f32 v190, v190
    v_exp_f32 v191, v191
    v_add_f32 v56, v56, v188
    buffer_load_dwordx4 v5, s[16:19], s33 offen offset:3072 nt lds
    v_mfma_f32_32x32x16_bf16 v[96:111], a[96:99], a[64:67], 0
    v_add_f32 v56, v56, v189
    v_cvt_pk_bf16_f32 v162, v188, v189
    v_fma_f32 v186, v74, s36, -v50
    v_fma_f32 v187, v75, s36, -v50
    v_exp_f32 v184, v184
    v_mfma_f32_32x32x16_bf16 v[96:111], a[100:103], a[68:71], v[96:111]
    v_exp_f32 v185, v185
    v_add_f32 v56, v56, v190
    v_add_f32 v56, v56, v191
    v_cvt_pk_bf16_f32 v163, v190, v191
    s_waitcnt vmcnt(16)
    s_waitcnt lgkmcnt(0)
    s_barrier
    s_mov_b32 s29, s76
    s_add_u32 s76, s76, 32768
    s_cmp_ge_u32 s76, 98304
    s_cselect_b32 s76, 0, s76
    v_add_u32 v26, s29, v24
    v_add_u32 v27, s29, v25
    v_mfma_f32_32x32x16_bf16 v[96:111], a[104:107], a[72:75], v[96:111]
    v_fma_f32 v188, v76, s36, -v50
    v_fma_f32 v189, v77, s36, -v50
    v_exp_f32 v186, v186
    v_exp_f32 v187, v187
    ds_read_b64_tr_b16 a[128:129], v26 offset:0
    ds_read_b64_tr_b16 a[130:131], v27 offset:0
    ds_read_b128 a[140:143], v29 offset:0
    v_mfma_f32_32x32x16_bf16 v[96:111], a[108:111], a[76:79], v[96:111]
    v_add_f32 v56, v56, v184
    v_add_f32 v56, v56, v185
    v_cvt_pk_bf16_f32 v164, v184, v185
    v_fma_f32 v190, v78, s36, -v50
    v_fma_f32 v191, v79, s36, -v50
    ds_read_b128 a[144:147], v29 offset:1024
    ds_read_b128 a[148:151], v29 offset:2048
    ds_read_b64_tr_b16 a[132:133], v26 offset:4096
    v_mfma_f32_32x32x16_bf16 v[96:111], a[112:115], a[80:83], v[96:111]
    v_exp_f32 v188, v188
    v_exp_f32 v189, v189
    v_add_f32 v56, v56, v186
    ds_read_b64_tr_b16 a[134:135], v27 offset:4096
    ds_read_b128 a[152:155], v29 offset:3072
    ds_read_b128 a[156:159], v29 offset:4096
    v_mfma_f32_32x32x16_bf16 v[96:111], a[116:119], a[84:87], v[96:111]
    v_add_f32 v56, v56, v187
    v_cvt_pk_bf16_f32 v165, v186, v187
    v_exp_f32 v190, v190
    v_exp_f32 v191, v191
    ds_read_b128 a[160:163], v29 offset:5120
    ds_read_b64_tr_b16 a[136:137], v26 offset:8192
    ds_read_b64_tr_b16 a[138:139], v27 offset:8192
    v_mfma_f32_32x32x16_bf16 v[96:111], a[120:123], a[88:91], v[96:111]
    v_add_f32 v56, v56, v188
    v_add_f32 v56, v56, v189
    v_cvt_pk_bf16_f32 v166, v188, v189
    v_add_f32 v56, v56, v190
    v_add_f32 v56, v56, v191
    ds_read_b128 a[164:167], v29 offset:6144
    ds_read_b128 a[168:171], v29 offset:7168
    ds_read_b128 a[172:175], v29 offset:8192
    v_mfma_f32_32x32x16_bf16 v[96:111], a[124:127], a[92:95], v[96:111]
    v_cvt_pk_bf16_f32 v167, v190, v191
    s_waitcnt lgkmcnt(10)
    v_mfma_f32_32x32x16_bf16 v[112:127], a[128:131], a[140:143], v[112:127]
    v_cmp_lt_f32 vcc, s37, v56
    s_nop 0
    s_mov_b64 s[72:73], vcc
    v_fma_f32 v192, v80, s36, -v51
    v_fma_f32 v193, v81, s36, -v51
    v_fma_f32 v194, v82, s36, -v51
    v_fma_f32 v195, v83, s36, -v51
    v_mfma_f32_32x32x16_bf16 v[128:143], a[128:131], a[144:147], v[128:143]
    v_exp_f32 v192, v192
    v_exp_f32 v193, v193
    v_fma_f32 v196, v84, s36, -v51
    v_fma_f32 v197, v85, s36, -v51
    v_mfma_f32_32x32x16_bf16 v[144:159], a[128:131], a[148:151], v[144:159]
    v_exp_f32 v194, v194
    v_exp_f32 v195, v195
    v_add_f32 v57, v192, v193
    v_cvt_pk_bf16_f32 v168, v192, v193
    s_waitcnt lgkmcnt(5)
    v_mfma_f32_32x32x16_bf16 v[112:127], a[132:135], a[152:155], v[112:127]
    ds_read_b64_tr_b16 a[128:129], v26 offset:12288
    ds_read_b64_tr_b16 a[130:131], v27 offset:12288
    v_fma_f32 v198, v86, s36, -v51
    v_fma_f32 v199, v87, s36, -v51
    v_exp_f32 v196, v196
    v_exp_f32 v197, v197
    v_mfma_f32_32x32x16_bf16 v[128:143], a[132:135], a[156:159], v[128:143]
    ds_read_b128 a[140:143], v29 offset:9216
    ds_read_b128 a[144:147], v29 offset:10240
    v_add_f32 v57, v57, v194
    v_add_f32 v57, v57, v195
    v_cvt_pk_bf16_f32 v169, v194, v195
    v_fma_f32 v192, v88, s36, -v51
    v_fma_f32 v193, v89, s36, -v51
    v_exp_f32 v198, v198
    v_mfma_f32_32x32x16_bf16 v[144:159], a[132:135], a[160:163], v[144:159]
    ds_read_b128 a[148:151], v29 offset:11264
    v_exp_f32 v199, v199
    v_add_f32 v57, v57, v196
    v_add_f32 v57, v57, v197
    v_cvt_pk_bf16_f32 v170, v196, v197
    v_fma_f32 v194, v90, s36, -v51
    s_waitcnt lgkmcnt(5)
    v_mfma_f32_32x32x16_bf16 v[112:127], a[136:139], a[164:167], v[112:127]
    ds_read_b64_tr_b16 a[132:133], v26 offset:16384
    ds_read_b64_tr_b16 a[134:135], v27 offset:16384
    v_fma_f32 v195, v91, s36, -v51
    v_exp_f32 v192, v192
    v_exp_f32 v193, v193
    v_add_f32 v57, v57, v198
    v_mfma_f32_32x32x16_bf16 v[128:143], a[136:139], a[168:171], v[128:143]
    ds_read_b128 a[152:155], v29 offset:12288
    ds_read_b128 a[156:159], v29 offset:13312
    v_add_f32 v57, v57, v199
    v_cvt_pk_bf16_f32 v171, v198, v199
    v_fma_f32 v196, v92, s36, -v51
    v_fma_f32 v197, v93, s36, -v51
    v_exp_f32 v194, v194
    v_mfma_f32_32x32x16_bf16 v[144:159], a[136:139], a[172:175], v[144:159]
    ds_read_b128 a[160:163], v29 offset:14336
    v_exp_f32 v195, v195
    v_add_f32 v57, v57, v192
    v_add_f32 v57, v57, v193
    v_cvt_pk_bf16_f32 v172, v192, v193
    v_fma_f32 v198, v94, s36, -v51
    s_waitcnt lgkmcnt(5)
    v_mfma_f32_32x32x16_bf16 v[112:127], a[128:131], a[140:143], v[112:127]
    ds_read_b64_tr_b16 a[136:137], v26 offset:20480
    ds_read_b64_tr_b16 a[138:139], v27 offset:20480
    v_fma_f32 v199, v95, s36, -v51
    v_exp_f32 v196, v196
    v_exp_f32 v197, v197
    v_add_f32 v57, v57, v194
    v_mfma_f32_32x32x16_bf16 v[128:143], a[128:131], a[144:147], v[128:143]
    ds_read_b128 a[164:167], v29 offset:15360
    ds_read_b128 a[168:171], v29 offset:16384
    v_add_f32 v57, v57, v195
    v_cvt_pk_bf16_f32 v173, v194, v195
    v_exp_f32 v198, v198
    v_exp_f32 v199, v199
    v_mfma_f32_32x32x16_bf16 v[144:159], a[128:131], a[148:151], v[144:159]
    ds_read_b128 a[172:175], v29 offset:17408
    v_add_f32 v57, v57, v196
    v_add_f32 v57, v57, v197
    v_cvt_pk_bf16_f32 v174, v196, v197
    v_add_f32 v57, v57, v198
    v_add_f32 v57, v57, v199
    v_cvt_pk_bf16_f32 v175, v198, v199
    s_waitcnt lgkmcnt(5)
    v_mfma_f32_32x32x16_bf16 v[112:127], a[132:135], a[152:155], v[112:127]
    ds_read_b64_tr_b16 a[128:129], v26 offset:24576
    ds_read_b64_tr_b16 a[130:131], v27 offset:24576
    v_cmp_lt_f32 vcc, s37, v57
    s_nop 0
    s_or_b64 s[72:73], s[72:73], vcc
    v_fma_f32 v184, v96, s36, -v52
    v_fma_f32 v185, v97, s36, -v52
    v_fma_f32 v186, v98, s36, -v52
    v_fma_f32 v187, v99, s36, -v52
    v_mfma_f32_32x32x16_bf16 v[128:143], a[132:135], a[156:159], v[128:143]
    ds_read_b128 a[140:143], v29 offset:18432
    ds_read_b128 a[144:147], v29 offset:19456
    v_exp_f32 v184, v184
    v_exp_f32 v185, v185
    v_fma_f32 v188, v100, s36, -v52
    v_fma_f32 v189, v101, s36, -v52
    v_mfma_f32_32x32x16_bf16 v[144:159], a[132:135], a[160:163], v[144:159]
    ds_read_b128 a[148:151], v29 offset:20480
    v_exp_f32 v186, v186
    v_exp_f32 v187, v187
    v_add_f32 v58, v184, v185
    v_cvt_pk_bf16_f32 v176, v184, v185
    s_waitcnt lgkmcnt(5)
    v_mfma_f32_32x32x16_bf16 v[112:127], a[136:139], a[164:167], v[112:127]
    ds_read_b64_tr_b16 a[132:133], v26 offset:28672
    ds_read_b64_tr_b16 a[134:135], v27 offset:28672
    v_fma_f32 v190, v102, s36, -v52
    v_fma_f32 v191, v103, s36, -v52
    v_exp_f32 v188, v188
    v_exp_f32 v189, v189
    v_mfma_f32_32x32x16_bf16 v[128:143], a[136:139], a[168:171], v[128:143]
    ds_read_b128 a[152:155], v29 offset:21504
    ds_read_b128 a[156:159], v29 offset:22528
    v_add_f32 v58, v58, v186
    v_add_f32 v58, v58, v187
    v_cvt_pk_bf16_f32 v177, v186, v187
    v_fma_f32 v184, v104, s36, -v52
    v_fma_f32 v185, v105, s36, -v52
    v_exp_f32 v190, v190
    v_mfma_f32_32x32x16_bf16 v[144:159], a[136:139], a[172:175], v[144:159]
    ds_read_b128 a[160:163], v29 offset:23552
    v_exp_f32 v191, v191
    v_add_f32 v58, v58, v188
    v_add_f32 v58, v58, v189
    v_cvt_pk_bf16_f32 v178, v188, v189
    v_fma_f32 v186, v106, s36, -v52
    s_waitcnt lgkmcnt(5)
    v_mfma_f32_32x32x16_bf16 v[112:127], a[128:131], a[140:143], v[112:127]
    v_fma_f32 v187, v107, s36, -v52
    v_exp_f32 v184, v184
    v_exp_f32 v185, v185
    v_add_f32 v58, v58, v190
    v_mfma_f32_32x32x16_bf16 v[128:143], a[128:131], a[144:147], v[128:143]
    v_add_f32 v58, v58, v191
    v_cvt_pk_bf16_f32 v179, v190, v191
    v_fma_f32 v188, v108, s36, -v52
    v_fma_f32 v189, v109, s36, -v52
    v_exp_f32 v186, v186
    v_mfma_f32_32x32x16_bf16 v[144:159], a[128:131], a[148:151], v[144:159]
    v_exp_f32 v187, v187
    v_add_f32 v58, v58, v184
    v_add_f32 v58, v58, v185
    v_cvt_pk_bf16_f32 v180, v184, v185
    v_fma_f32 v190, v110, s36, -v52
    s_waitcnt lgkmcnt(0)
    v_mfma_f32_32x32x16_bf16 v[112:127], a[132:135], a[152:155], v[112:127]
    v_fma_f32 v191, v111, s36, -v52
    v_exp_f32 v188, v188
    v_exp_f32 v189, v189
    v_add_f32 v58, v58, v186
    v_mfma_f32_32x32x16_bf16 v[128:143], a[132:135], a[156:159], v[128:143]
    v_add_f32 v58, v58, v187
    v_cvt_pk_bf16_f32 v181, v186, v187
    v_exp_f32 v190, v190
    v_exp_f32 v191, v191
    v_mfma_f32_32x32x16_bf16 v[144:159], a[132:135], a[160:163], v[144:159]
    v_add_f32 v58, v58, v188
    v_add_f32 v58, v58, v189
    v_cvt_pk_bf16_f32 v182, v188, v189
    v_add_f32 v58, v58, v190
    v_add_f32 v58, v58, v191
    v_cvt_pk_bf16_f32 v183, v190, v191
    v_cmp_lt_f32 vcc, s37, v58
    s_nop 0
    s_or_b64 s[72:73], s[72:73], vcc
    s_cmp_eq_u64 s[72:73], 0
    s_cbranch_scc1 Lnf_39
    v_mov_b32 v59, 1
    ds_write_b32 v6, v59
Lnf_39:
    s_waitcnt lgkmcnt(0)
    s_barrier
    ds_read_b32 v59, v6
    s_mov_b32 s71, s76
    s_add_u32 s76, s76, 32768
    s_cmp_ge_u32 s76, 98304
    s_cselect_b32 s76, 0, s76
    s_waitcnt vmcnt(8)
    v_add_u32 v16, s71, v8
    v_add_u32 v17, s71, v9
    v_add_u32 v18, s71, v10
    v_add_u32 v19, s71, v11
    v_add_u32 v20, s71, v12
    v_add_u32 v21, s71, v13
    v_add_u32 v22, s71, v14
    v_add_u32 v23, s71, v15
    ds_read_b128 a[96:99], v16
    ds_read_b128 a[100:103], v17
    ds_read_b128 a[104:107], v18
    ds_read_b128 a[108:111], v19
    ds_read_b128 a[112:115], v20
    ds_read_b128 a[116:119], v21
    ds_read_b128 a[120:123], v22
    ds_read_b128 a[124:127], v23
    s_add_u32 m0, s29, s35
    s_add_u32 s33, s74, 4096
    buffer_load_dwordx4 v2, s[12:15], s74 offen offset:0 nt lds
    ds_write_b128 v28, v[160:163] offset:0
    ds_write_b128 v28, v[164:167] offset:3072
    ds_write_b128 v28, v[168:171] offset:1024
    ds_write_b128 v28, v[172:175] offset:4096
    ds_write_b128 v28, v[176:179] offset:2048
    ds_write_b128 v28, v[180:183] offset:5120
    buffer_load_dwordx4 v3, s[12:15], s74 offen offset:1024 nt lds
    buffer_load_dwordx4 v4, s[12:15], s74 offen offset:2048 nt lds
    buffer_load_dwordx4 v5, s[12:15], s74 offen offset:3072 nt lds
    s_waitcnt lgkmcnt(14)
    v_readfirstlane_b32 s31, v59
    s_nop 0
    s_cmp_lg_u32 s31, 0
    s_cbranch_scc1 Lslow_41
Lpost_40:
    v_add_f32 v53, v53, v56
    v_add_f32 v54, v54, v57
    v_add_f32 v55, v55, v58
    v_mov_b32 v252, v53
    v_mov_b32 v53, 0
    v_mov_b32 v50, 0
    v_mov_b32 v253, v54
    v_mov_b32 v54, 0
    v_mov_b32 v51, 0
    v_mov_b32 v254, v55
    v_mov_b32 v55, 0
    v_mov_b32 v52, 0
    ds_read_b128 a[0:3], v29 offset:24576
    ds_read_b128 a[4:7], v29 offset:27648
    ds_read_b128 a[8:11], v29 offset:30720
    ds_read_b128 a[12:15], v29 offset:33792
    ds_read_b128 a[16:19], v29 offset:36864
    ds_read_b128 a[20:23], v29 offset:39936
    ds_read_b128 a[24:27], v29 offset:43008
    ds_read_b128 a[28:31], v29 offset:46080
    ds_read_b128 a[32:35], v29 offset:25600
    ds_read_b128 a[36:39], v29 offset:28672
    ds_read_b128 a[40:43], v29 offset:31744
    ds_read_b128 a[44:47], v29 offset:34816
    ds_read_b128 a[48:51], v29 offset:37888
    ds_read_b128 a[52:55], v29 offset:40960
    ds_read_b128 a[56:59], v29 offset:44032
    ds_read_b128 a[60:63], v29 offset:47104
    ds_read_b128 a[64:67], v29 offset:26624
    ds_read_b128 a[68:71], v29 offset:29696
    ds_read_b128 a[72:75], v29 offset:32768
    ds_read_b128 a[76:79], v29 offset:35840
    ds_read_b128 a[80:83], v29 offset:38912
    ds_read_b128 a[84:87], v29 offset:41984
    ds_read_b128 a[88:91], v29 offset:45056
    ds_read_b128 a[92:95], v29 offset:48128
    s_waitcnt lgkmcnt(0)
    s_waitcnt lgkmcnt(15)
    v_mfma_f32_32x32x16_bf16 v[64:79], a[96:99], a[0:3], 0
    s_add_u32 m0, m0, 4096
    s_add_u32 s74, s74, 32768
    buffer_load_dwordx4 v2, s[12:15], s33 offen offset:0 nt lds
    s_waitcnt lgkmcnt(15)
    v_mfma_f32_32x32x16_bf16 v[64:79], a[100:103], a[4:7], v[64:79]
    buffer_load_dwordx4 v3, s[12:15], s33 offen offset:1024 nt lds
    s_waitcnt lgkmcnt(15)
    v_mfma_f32_32x32x16_bf16 v[64:79], a[104:107], a[8:11], v[64:79]
    buffer_load_dwordx4 v4, s[12:15], s33 offen offset:2048 nt lds
    s_waitcnt lgkmcnt(15)
    v_mfma_f32_32x32x16_bf16 v[64:79], a[108:111], a[12:15], v[64:79]
    buffer_load_dwordx4 v5, s[12:15], s33 offen offset:3072 nt lds
    s_waitcnt lgkmcnt(15)
    v_mfma_f32_32x32x16_bf16 v[64:79], a[112:115], a[16:19], v[64:79]
    s_waitcnt lgkmcnt(15)
    v_mfma_f32_32x32x16_bf16 v[64:79], a[116:119], a[20:23], v[64:79]
    s_waitcnt lgkmcnt(15)
    v_mfma_f32_32x32x16_bf16 v[64:79], a[120:123], a[24:27], v[64:79]
    s_waitcnt lgkmcnt(15)
    v_mfma_f32_32x32x16_bf16 v[64:79], a[124:127], a[28:31], v[64:79]
    v_mfma_f32_32x32x16_bf16 v[80:95], a[96:99], a[32:35], 0
    s_add_u32 s75, s98, 0x2000000
    s_add_u32 m0, s71, s35
    s_add_u32 s33, s75, 4096
    buffer_load_dwordx4 v2, s[16:19], s75 offen offset:0 nt lds
    v_mfma_f32_32x32x16_bf16 v[80:95], a[100:103], a[36:39], v[80:95]
    buffer_load_dwordx4 v3, s[16:19], s75 offen offset:1024 nt lds
    s_waitcnt lgkmcnt(15)
    v_mfma_f32_32x32x16_bf16 v[80:95], a[104:107], a[40:43], v[80:95]
    s_nop 2
    v_fma_f32 v184, v64, s36, -v50
    v_fma_f32 v185, v65, s36, -v50
    v_fma_f32 v186, v66, s36, -v50
    v_fma_f32 v187, v67, s36, -v50
    v_exp_f32 v184, v184
    buffer_load_dwordx4 v4, s[16:19], s75 offen offset:2048 nt lds
    v_mfma_f32_32x32x16_bf16 v[80:95], a[108:111], a[44:47], v[80:95]
    v_exp_f32 v185, v185
    v_fma_f32 v188, v68, s36, -v50
    v_fma_f32 v189, v69, s36, -v50
    v_exp_f32 v186, v186
    buffer_load_dwordx4 v5, s[16:19], s75 offen offset:3072 nt lds
    v_mfma_f32_32x32x16_bf16 v[80:95], a[112:115], a[48:51], v[80:95]
    v_exp_f32 v187, v187
    v_add_f32 v56, v184, v185
    v_cvt_pk_bf16_f32 v160, v184, v185
    v_fma_f32 v190, v70, s36, -v50
    s_add_u32 m0, m0, 4096
    s_add_u32 s75, s75, 32768
    buffer_load_dwordx4 v2, s[16:19], s33 offen offset:0 nt lds
    v_mfma_f32_32x32x16_bf16 v[80:95], a[116:119], a[52:55], v[80:95]
    v_fma_f32 v191, v71, s36, -v50
    v_exp_f32 v188, v188
    v_exp_f32 v189, v189
    buffer_load_dwordx4 v3, s[16:19], s33 offen offset:1024 nt lds
    v_mfma_f32_32x32x16_bf16 v[80:95], a[120:123], a[56:59], v[80:95]
    v_add_f32 v56, v56, v186
    v_add_f32 v56, v56, v187
    v_cvt_pk_bf16_f32 v161, v186, v187
    v_fma_f32 v184, v72, s36, -v50
    v_fma_f32 v185, v73, s36, -v50
    buffer_load_dwordx4 v4, s[16:19], s33 offen offset:2048 nt lds
    v_mfma_f32_32x32x16_bf16 v[80:95], a[124:127], a[60:63], v[80:95]
    v_exp_f32 v190, v190
    v_exp_f32 v191, v191
    v_add_f32 v56, v56, v188
    buffer_load_dwordx4 v5, s[16:19], s33 offen offset:3072 nt lds
    v_mfma_f32_32x32x16_bf16 v[96:111], a[96:99], a[64:67], 0
    v_add_f32 v56, v56, v189
    v_cvt_pk_bf16_f32 v162, v188, v189
    v_fma_f32 v186, v74, s36, -v50
    v_fma_f32 v187, v75, s36, -v50
    v_exp_f32 v184, v184
    v_mfma_f32_32x32x16_bf16 v[96:111], a[100:103], a[68:71], v[96:111]
    v_exp_f32 v185, v185
    v_add_f32 v56, v56, v190
    v_add_f32 v56, v56, v191
    v_cvt_pk_bf16_f32 v163, v190, v191
    s_waitcnt vmcnt(16)
    s_waitcnt lgkmcnt(0)
    s_barrier
    s_mov_b32 s29, s76
    s_add_u32 s76, s76, 32768
    s_cmp_ge_u32 s76, 98304
    s_cselect_b32 s76, 0, s76
    v_add_u32 v26, s29, v24
    v_add_u32 v27, s29, v25
    v_mfma_f32_32x32x16_bf16 v[96:111], a[104:107], a[72:75], v[96:111]
    v_fma_f32 v188, v76, s36, -v50
    v_fma_f32 v189, v77, s36, -v50
    v_exp_f32 v186, v186
    v_exp_f32 v187, v187
    ds_read_b64_tr_b16 a[128:129], v26 offset:0
    ds_read_b64_tr_b16 a[130:131], v27 offset:0
    ds_read_b128 a[140:143], v29 offset:0
    v_mfma_f32_32x32x16_bf16 v[96:111], a[108:111], a[76:79], v[96:111]
    v_add_f32 v56, v56, v184
    v_add_f32 v56, v56, v185
    v_cvt_pk_bf16_f32 v164, v184, v185
    v_fma_f32 v190, v78, s36, -v50
    v_fma_f32 v191, v79, s36, -v50
    ds_read_b128 a[144:147], v29 offset:1024
    ds_read_b128 a[148:151], v29 offset:2048
    ds_read_b64_tr_b16 a[132:133], v26 offset:4096
    v_mfma_f32_32x32x16_bf16 v[96:111], a[112:115], a[80:83], v[96:111]
    v_exp_f32 v188, v188
    v_exp_f32 v189, v189
    v_add_f32 v56, v56, v186
    ds_read_b64_tr_b16 a[134:135], v27 offset:4096
    ds_read_b128 a[152:155], v29 offset:3072
    ds_read_b128 a[156:159], v29 offset:4096
    v_mfma_f32_32x32x16_bf16 v[96:111], a[116:119], a[84:87], v[96:111]
    v_add_f32 v56, v56, v187
    v_cvt_pk_bf16_f32 v165, v186, v187
    v_exp_f32 v190, v190
    v_exp_f32 v191, v191
    ds_read_b128 a[160:163], v29 offset:5120
    ds_read_b64_tr_b16 a[136:137], v26 offset:8192
    ds_read_b64_tr_b16 a[138:139], v27 offset:8192
    v_mfma_f32_32x32x16_bf16 v[96:111], a[120:123], a[88:91], v[96:111]
    v_add_f32 v56, v56, v188
    v_add_f32 v56, v56, v189
    v_cvt_pk_bf16_f32 v166, v188, v189
    v_add_f32 v56, v56, v190
    v_add_f32 v56, v56, v191
    ds_read_b128 a[164:167], v29 offset:6144
    ds_read_b128 a[168:171], v29 offset:7168
    ds_read_b128 a[172:175], v29 offset:8192
    v_mfma_f32_32x32x16_bf16 v[96:111], a[124:127], a[92:95], v[96:111]
    v_cvt_pk_bf16_f32 v167, v190, v191
    s_waitcnt lgkmcnt(10)
    v_mfma_f32_32x32x16_bf16 v[112:127], a[128:131], a[140:143], v[112:127]
    v_cmp_lt_f32 vcc, s37, v56
    s_nop 0
    s_mov_b64 s[72:73], vcc
    v_cmp_gt_f32 vcc, 0x33800000, v56
    s_nop 0
    s_or_b64 s[72:73], s[72:73], vcc
    v_fma_f32 v192, v80, s36, -v51
    v_fma_f32 v193, v81, s36, -v51
    v_mfma_f32_32x32x16_bf16 v[128:143], a[128:131], a[144:147], v[128:143]
    v_fma_f32 v194, v82, s36, -v51
    v_fma_f32 v195, v83, s36, -v51
    v_exp_f32 v192, v192
    v_exp_f32 v193, v193
    v_mfma_f32_32x32x16_bf16 v[144:159], a[128:131], a[148:151], v[144:159]
    v_fma_f32 v196, v84, s36, -v51
    v_fma_f32 v197, v85, s36, -v51
    v_exp_f32 v194, v194
    v_exp_f32 v195, v195
    s_waitcnt lgkmcnt(5)
    v_mfma_f32_32x32x16_bf16 v[112:127], a[132:135], a[152:155], v[112:127]
    ds_read_b64_tr_b16 a[128:129], v26 offset:12288
    ds_read_b64_tr_b16 a[130:131], v27 offset:12288
    v_add_f32 v57, v192, v193
    v_cvt_pk_bf16_f32 v168, v192, v193
    v_fma_f32 v198, v86, s36, -v51
    v_fma_f32 v199, v87, s36, -v51
    v_exp_f32 v196, v196
    v_mfma_f32_32x32x16_bf16 v[128:143], a[132:135], a[156:159], v[128:143]
    ds_read_b128 a[140:143], v29 offset:9216
    ds_read_b128 a[144:147], v29 offset:10240
    v_exp_f32 v197, v197
    v_add_f32 v57, v57, v194
    v_add_f32 v57, v57, v195
    v_cvt_pk_bf16_f32 v169, v194, v195
    v_fma_f32 v192, v88, s36, -v51
    v_mfma_f32_32x32x16_bf16 v[144:159], a[132:135], a[160:163], v[144:159]
    ds_read_b128 a[148:151], v29 offset:11264
    v_fma_f32 v193, v89, s36, -v51
    v_exp_f32 v198, v198
    v_exp_f32 v199, v199
    v_add_f32 v57, v57, v196
    s_waitcnt lgkmcnt(5)
    v_mfma_f32_32x32x16_bf16 v[112:127], a[136:139], a[164:167], v[112:127]
    ds_read_b64_tr_b16 a[132:133], v26 offset:16384
    ds_read_b64_tr_b16 a[134:135], v27 offset:16384
    v_add_f32 v57, v57, v197
    v_cvt_pk_bf16_f32 v170, v196, v197
    v_fma_f32 v194, v90, s36, -v51
    v_fma_f32 v195, v91, s36, -v51
    v_exp_f32 v192, v192
    v_mfma_f32_32x32x16_bf16 v[128:143], a[136:139], a[168:171], v[128:143]
    ds_read_b128 a[152:155], v29 offset:12288
    ds_read_b128 a[156:159], v29 offset:13312
    v_exp_f32 v193, v193
    v_add_f32 v57, v57, v198
    v_add_f32 v57, v57, v199
    v_cvt_pk_bf16_f32 v171, v198, v199
    v_fma_f32 v196, v92, s36, -v51
    v_mfma_f32_32x32x16_bf16 v[144:159], a[136:139], a[172:175], v[144:159]
    ds_read_b128 a[160:163], v29 offset:14336
    v_fma_f32 v197, v93, s36, -v51
    v_exp_f32 v194, v194
    v_exp_f32 v195, v195
    v_add_f32 v57, v57, v192
    s_waitcnt lgkmcnt(5)
    v_mfma_f32_32x32x16_bf16 v[112:127], a[128:131], a[140:143], v[112:127]
    ds_read_b64_tr_b16 a[136:137], v26 offset:20480
    ds_read_b64_tr_b16 a[138:139], v27 offset:20480
    v_add_f32 v57, v57, v193
    v_cvt_pk_bf16_f32 v172, v192, v193
    v_fma_f32 v198, v94, s36, -v51
    v_fma_f32 v199, v95, s36, -v51
    v_exp_f32 v196, v196
    v_mfma_f32_32x32x16_bf16 v[128:143], a[128:131], a[144:147], v[128:143]
    ds_read_b128 a[164:167], v29 offset:15360
    ds_read_b128 a[168:171], v29 offset:16384
    v_exp_f32 v197, v197
    v_add_f32 v57, v57, v194
    v_add_f32 v57, v57, v195
    v_cvt_pk_bf16_f32 v173, v194, v195
    v_exp_f32 v198, v198
    v_mfma_f32_32x32x16_bf16 v[144:159], a[128:131], a[148:151], v[144:159]
    ds_read_b128 a[172:175], v29 offset:17408
    v_exp_f32 v199, v199
    v_add_f32 v57, v57, v196
    v_add_f32 v57, v57, v197
    v_cvt_pk_bf16_f32 v174, v196, v197
    v_add_f32 v57, v57, v198
    s_waitcnt lgkmcnt(5)
    v_mfma_f32_32x32x16_bf16 v[112:127], a[132:135], a[152:155], v[112:127]
    ds_read_b64_tr_b16 a[128:129], v26 offset:24576
    ds_read_b64_tr_b16 a[130:131], v27 offset:24576
    v_add_f32 v57, v57, v199
    v_cvt_pk_bf16_f32 v175, v198, v199
    v_cmp_lt_f32 vcc, s37, v57
    s_nop 0
    s_or_b64 s[72:73], s[72:73], vcc
    v_cmp_gt_f32 vcc, 0x33800000, v57
    s_nop 0
    s_or_b64 s[72:73], s[72:73], vcc
    v_mfma_f32_32x32x16_bf16 v[128:143], a[132:135], a[156:159], v[128:143]
    ds_read_b128 a[140:143], v29 offset:18432
    ds_read_b128 a[144:147], v29 offset:19456
    v_fma_f32 v184, v96, s36, -v52
    v_fma_f32 v185, v97, s36, -v52
    v_fma_f32 v186, v98, s36, -v52
    v_fma_f32 v187, v99, s36, -v52
    v_exp_f32 v184, v184
    v_mfma_f32_32x32x16_bf16 v[144:159], a[132:135], a[160:163], v[144:159]
    ds_read_b128 a[148:151], v29 offset:20480
    v_exp_f32 v185, v185
    v_fma_f32 v188, v100, s36, -v52
    v_fma_f32 v189, v101, s36, -v52
    v_exp_f32 v186, v186
    s_waitcnt lgkmcnt(5)
    v_mfma_f32_32x32x16_bf16 v[112:127], a[136:139], a[164:167], v[112:127]
    ds_read_b64_tr_b16 a[132:133], v26 offset:28672
    ds_read_b64_tr_b16 a[134:135], v27 offset:28672
    v_exp_f32 v187, v187
    v_add_f32 v58, v184, v185
    v_cvt_pk_bf16_f32 v176, v184, v185
    v_fma_f32 v190, v102, s36, -v52
    v_fma_f32 v191, v103, s36, -v52
    v_mfma_f32_32x32x16_bf16 v[128:143], a[136:139], a[168:171], v[128:143]
    ds_read_b128 a[152:155], v29 offset:21504
    ds_read_b128 a[156:159], v29 offset:22528
    v_exp_f32 v188, v188
    v_exp_f32 v189, v189
    v_add_f32 v58, v58, v186
    v_add_f32 v58, v58, v187
    v_mfma_f32_32x32x16_bf16 v[144:159], a[136:139], a[172:175], v[144:159]
    ds_read_b128 a[160:163], v29 offset:23552
    v_cvt_pk_bf16_f32 v177, v186, v187
    v_fma_f32 v184, v104, s36, -v52
    v_fma_f32 v185, v105, s36, -v52
    v_exp_f32 v190, v190
    v_exp_f32 v191, v191
    s_waitcnt lgkmcnt(5)
    v_mfma_f32_32x32x16_bf16 v[112:127], a[128:131], a[140:143], v[112:127]
    v_add_f32 v58, v58, v188
    v_add_f32 v58, v58, v189
    v_cvt_pk_bf16_f32 v178, v188, v189
    v_fma_f32 v186, v106, s36, -v52
    v_fma_f32 v187, v107, s36, -v52
    v_exp_f32 v184, v184
    v_mfma_f32_32x32x16_bf16 v[128:143], a[128:131], a[144:147], v[128:143]
    v_exp_f32 v185, v185
    v_add_f32 v58, v58, v190
    v_add_f32 v58, v58, v191
    v_cvt_pk_bf16_f32 v179, v190, v191
    v_fma_f32 v188, v108, s36, -v52
    v_mfma_f32_32x32x16_bf16 v[144:159], a[128:131], a[148:151], v[144:159]
    v_fma_f32 v189, v109, s36, -v52
    v_exp_f32 v186, v186
    v_exp_f32 v187, v187
    v_add_f32 v58, v58, v184
    s_waitcnt lgkmcnt(0)
    v_mfma_f32_32x32x16_bf16 v[112:127], a[132:135], a[152:155], v[112:127]
    v_add_f32 v58, v58, v185
    v_cvt_pk_bf16_f32 v180, v184, v185
    v_fma_f32 v190, v110, s36, -v52
    v_fma_f32 v191, v111, s36, -v52
    v_exp_f32 v188, v188
    v_mfma_f32_32x32x16_bf16 v[128:143], a[132:135], a[156:159], v[128:143]
    v_exp_f32 v189, v189
    v_add_f32 v58, v58, v186
    v_add_f32 v58, v58, v187
    v_cvt_pk_bf16_f32 v181, v186, v187
    v_exp_f32 v190, v190
    v_mfma_f32_32x32x16_bf16 v[144:159], a[132:135], a[160:163], v[144:159]
    v_exp_f32 v191, v191
    v_add_f32 v58, v58, v188
    v_add_f32 v58, v58, v189
    v_cvt_pk_bf16_f32 v182, v188, v189
    v_add_f32 v58, v58, v190
    v_add_f32 v58, v58, v191
    v_cvt_pk_bf16_f32 v183, v190, v191
    v_cmp_lt_f32 vcc, s37, v58
    s_nop 0
    s_or_b64 s[72:73], s[72:73], vcc
    v_cmp_gt_f32 vcc, 0x33800000, v58
    s_nop 0
    s_or_b64 s[72:73], s[72:73], vcc
    s_cmp_eq_u64 s[72:73], 0
    s_cbranch_scc1 Lnf_42
    v_mov_b32 v59, 1
    ds_write_b32 v6, v59
Lnf_42:
    s_waitcnt lgkmcnt(0)
    s_barrier
    ds_read_b32 v59, v6
    s_mov_b32 s71, s76
    s_add_u32 s76, s76, 32768
    s_cmp_ge_u32 s76, 98304
    s_cselect_b32 s76, 0, s76
    s_waitcnt vmcnt(8)
    v_add_u32 v16, s71, v8
    v_add_u32 v17, s71, v9
    v_add_u32 v18, s71, v10
    v_add_u32 v19, s71, v11
    v_add_u32 v20, s71, v12
    v_add_u32 v21, s71, v13
    v_add_u32 v22, s71, v14
    v_add_u32 v23, s71, v15
    ds_read_b128 a[96:99], v16
    ds_read_b128 a[100:103], v17
    ds_read_b128 a[104:107], v18
    ds_read_b128 a[108:111], v19
    ds_read_b128 a[112:115], v20
    ds_read_b128 a[116:119], v21
    ds_read_b128 a[120:123], v22
    ds_read_b128 a[124:127], v23
    s_add_u32 m0, s29, s35
    s_add_u32 s33, s74, 4096
    buffer_load_dwordx4 v2, s[12:15], s74 offen offset:0 nt lds
    ds_write_b128 v28, v[160:163] offset:0
    ds_write_b128 v28, v[164:167] offset:3072
    ds_write_b128 v28, v[168:171] offset:1024
    ds_write_b128 v28, v[172:175] offset:4096
    ds_write_b128 v28, v[176:179] offset:2048
    ds_write_b128 v28, v[180:183] offset:5120
    buffer_load_dwordx4 v3, s[12:15], s74 offen offset:1024 nt lds
    buffer_load_dwordx4 v4, s[12:15], s74 offen offset:2048 nt lds
    buffer_load_dwordx4 v5, s[12:15], s74 offen offset:3072 nt lds
    ds_write_b32 v48, v252 offset:4096
    ds_write_b32 v48, v253 offset:5120
    ds_write_b32 v48, v254 offset:6144
    s_waitcnt lgkmcnt(0)
    s_waitcnt lgkmcnt(15)
    v_readfirstlane_b32 s31, v59
    s_nop 0
    s_cmp_lg_u32 s31, 0
    s_cbranch_scc1 Lslow_44
Lpost_43:
    v_add_f32 v53, v53, v56
    v_add_f32 v54, v54, v57
    v_add_f32 v55, v55, v58
    s_barrier
    ds_read_b128 v[192:195], v49 offset:4096
    ds_read_b128 v[196:199], v49 offset:4112
    s_waitcnt lgkmcnt(0)
    v_add_f32 v192, v192, v193
    v_add_f32 v194, v194, v195
    v_add_f32 v196, v196, v197
    v_add_f32 v198, v198, v199
    v_add_f32 v192, v192, v194
    v_add_f32 v196, v196, v198
    v_add_f32 v192, v192, v196
    v_rcp_f32 v252, v192
    ds_read_b128 v[192:195], v49 offset:5120
    ds_read_b128 v[196:199], v49 offset:5136
    s_waitcnt lgkmcnt(0)
    v_add_f32 v192, v192, v193
    v_add_f32 v194, v194, v195
    v_add_f32 v196, v196, v197
    v_add_f32 v198, v198, v199
    v_add_f32 v192, v192, v194
    v_add_f32 v196, v196, v198
    v_add_f32 v192, v192, v196
    v_rcp_f32 v253, v192
    ds_read_b128 v[192:195], v49 offset:6144
    ds_read_b128 v[196:199], v49 offset:6160
    s_waitcnt lgkmcnt(0)
    v_add_f32 v192, v192, v193
    v_add_f32 v194, v194, v195
    v_add_f32 v196, v196, v197
    v_add_f32 v198, v198, v199
    v_add_f32 v192, v192, v194
    v_add_f32 v196, v196, v198
    v_add_f32 v192, v192, v196
    v_rcp_f32 v254, v192
    s_lshl_b32 s97, s99, 3
    s_add_u32 s97, s97, s38
    s_add_u32 s97, s97, 0
    s_lshl_b32 s97, s97, 5
    s_add_u32 s97, s97, s39
    s_mul_i32 s97, s97, 24576
    s_add_u32 s100, s97, 3072
    s_waitcnt lgkmcnt(15)
    v_mfma_f32_32x32x16_bf16 v[64:79], a[96:99], a[0:3], 0
    s_add_u32 m0, m0, 4096
    s_add_u32 s74, s74, 32768
    buffer_load_dwordx4 v2, s[12:15], s33 offen offset:0 nt lds
    v_mul_f32 v112, v112, v252
    v_mul_f32 v113, v113, v252
    v_cvt_pk_bf16_f32 v112, v112, v113
    v_mul_f32 v114, v114, v252
    v_mul_f32 v115, v115, v252
    s_waitcnt lgkmcnt(15)
    v_mfma_f32_32x32x16_bf16 v[64:79], a[100:103], a[4:7], v[64:79]
    buffer_load_dwordx4 v3, s[12:15], s33 offen offset:1024 nt lds
    v_cvt_pk_bf16_f32 v113, v114, v115
    v_mul_f32 v116, v116, v252
    v_mul_f32 v117, v117, v252
    v_cvt_pk_bf16_f32 v114, v116, v117
    v_mul_f32 v118, v118, v252
    s_waitcnt lgkmcnt(15)
    v_mfma_f32_32x32x16_bf16 v[64:79], a[104:107], a[8:11], v[64:79]
    buffer_load_dwordx4 v4, s[12:15], s33 offen offset:2048 nt lds
    v_mul_f32 v119, v119, v252
    v_cvt_pk_bf16_f32 v115, v118, v119
    v_mul_f32 v120, v120, v252
    v_mul_f32 v121, v121, v252
    v_cvt_pk_bf16_f32 v116, v120, v121
    s_waitcnt lgkmcnt(15)
    v_mfma_f32_32x32x16_bf16 v[64:79], a[108:111], a[12:15], v[64:79]
    buffer_load_dwordx4 v5, s[12:15], s33 offen offset:3072 nt lds
    v_mul_f32 v122, v122, v252
    v_mul_f32 v123, v123, v252
    v_cvt_pk_bf16_f32 v117, v122, v123
    v_mul_f32 v124, v124, v252
    v_mul_f32 v125, v125, v252
    s_waitcnt lgkmcnt(15)
    v_mfma_f32_32x32x16_bf16 v[64:79], a[112:115], a[16:19], v[64:79]
    v_cvt_pk_bf16_f32 v118, v124, v125
    v_mul_f32 v126, v126, v252
    v_mul_f32 v127, v127, v252
    v_cvt_pk_bf16_f32 v119, v126, v127
    buffer_store_dwordx4 v[112:115], v46, s[20:23], s97 offen offset:0 sc1
    s_waitcnt lgkmcnt(15)
    v_mfma_f32_32x32x16_bf16 v[64:79], a[116:119], a[20:23], v[64:79]
    buffer_store_dwordx4 v[116:119], v46, s[20:23], s100 offen offset:0 sc1
    v_mul_f32 v128, v128, v253
    v_mul_f32 v129, v129, v253
    v_cvt_pk_bf16_f32 v128, v128, v129
    v_mul_f32 v130, v130, v253
    s_waitcnt lgkmcnt(15)
    v_mfma_f32_32x32x16_bf16 v[64:79], a[120:123], a[24:27], v[64:79]
    v_mul_f32 v131, v131, v253
    v_cvt_pk_bf16_f32 v129, v130, v131
    v_mul_f32 v132, v132, v253
    v_mul_f32 v133, v133, v253
    v_cvt_pk_bf16_f32 v130, v132, v133
    s_waitcnt lgkmcnt(15)
    v_mfma_f32_32x32x16_bf16 v[64:79], a[124:127], a[28:31], v[64:79]
    v_mul_f32 v134, v134, v253
    v_mul_f32 v135, v135, v253
    v_cvt_pk_bf16_f32 v131, v134, v135
    v_mul_f32 v136, v136, v253
    v_mul_f32 v137, v137, v253
    v_mfma_f32_32x32x16_bf16 v[80:95], a[96:99], a[32:35], 0
    v_cvt_pk_bf16_f32 v132, v136, v137
    v_mul_f32 v138, v138, v253
    v_mul_f32 v139, v139, v253
    v_cvt_pk_bf16_f32 v133, v138, v139
    v_mul_f32 v140, v140, v253
    s_add_u32 m0, s71, s35
    s_add_u32 s33, s75, 4096
    buffer_load_dwordx4 v2, s[16:19], s75 offen offset:0 nt lds
    v_mfma_f32_32x32x16_bf16 v[80:95], a[100:103], a[36:39], v[80:95]
    v_mul_f32 v141, v141, v253
    v_cvt_pk_bf16_f32 v134, v140, v141
    v_mul_f32 v142, v142, v253
    v_mul_f32 v143, v143, v253
    v_cvt_pk_bf16_f32 v135, v142, v143
    buffer_load_dwordx4 v3, s[16:19], s75 offen offset:1024 nt lds
    s_waitcnt lgkmcnt(15)
    v_mfma_f32_32x32x16_bf16 v[80:95], a[104:107], a[40:43], v[80:95]
    buffer_store_dwordx4 v[128:131], v46, s[20:23], s97 offen offset:1024 sc1
    buffer_store_dwordx4 v[132:135], v46, s[20:23], s100 offen offset:1024 sc1
    v_mul_f32 v144, v144, v254
    v_mul_f32 v145, v145, v254
    v_cvt_pk_bf16_f32 v144, v144, v145
    v_fma_f32 v184, v64, s36, -v50
    v_fma_f32 v185, v65, s36, -v50
    v_fma_f32 v186, v66, s36, -v50
    v_fma_f32 v187, v67, s36, -v50
    v_exp_f32 v184, v184
    buffer_load_dwordx4 v4, s[16:19], s75 offen offset:2048 nt lds
    v_mfma_f32_32x32x16_bf16 v[80:95], a[108:111], a[44:47], v[80:95]
    v_mul_f32 v146, v146, v254
    v_mul_f32 v147, v147, v254
    v_cvt_pk_bf16_f32 v145, v146, v147
    v_mul_f32 v148, v148, v254
    v_mul_f32 v149, v149, v254
    v_exp_f32 v185, v185
    v_fma_f32 v188, v68, s36, -v50
    v_fma_f32 v189, v69, s36, -v50
    v_exp_f32 v186, v186
    buffer_load_dwordx4 v5, s[16:19], s75 offen offset:3072 nt lds
    v_mfma_f32_32x32x16_bf16 v[80:95], a[112:115], a[48:51], v[80:95]
    v_cvt_pk_bf16_f32 v146, v148, v149
    v_mul_f32 v150, v150, v254
    v_mul_f32 v151, v151, v254
    v_cvt_pk_bf16_f32 v147, v150, v151
    v_mul_f32 v152, v152, v254
    v_exp_f32 v187, v187
    v_add_f32 v56, v184, v185
    v_cvt_pk_bf16_f32 v160, v184, v185
    v_fma_f32 v190, v70, s36, -v50
    s_add_u32 m0, m0, 4096
    s_add_u32 s75, s75, 32768
    buffer_load_dwordx4 v2, s[16:19], s33 offen offset:0 nt lds
    v_mfma_f32_32x32x16_bf16 v[80:95], a[116:119], a[52:55], v[80:95]
    v_mul_f32 v153, v153, v254
    v_cvt_pk_bf16_f32 v148, v152, v153
    v_mul_f32 v154, v154, v254
    v_mul_f32 v155, v155, v254
    v_cvt_pk_bf16_f32 v149, v154, v155
    v_fma_f32 v191, v71, s36, -v50
    v_exp_f32 v188, v188
    v_exp_f32 v189, v189
    buffer_load_dwordx4 v3, s[16:19], s33 offen offset:1024 nt lds
    v_mfma_f32_32x32x16_bf16 v[80:95], a[120:123], a[56:59], v[80:95]
    v_mul_f32 v156, v156, v254
    v_mul_f32 v157, v157, v254
    v_cvt_pk_bf16_f32 v150, v156, v157
    v_mul_f32 v158, v158, v254
    v_mul_f32 v159, v159, v254
    v_add_f32 v56, v56, v186
    v_add_f32 v56, v56, v187
    v_cvt_pk_bf16_f32 v161, v186, v187
    v_fma_f32 v184, v72, s36, -v50
    v_fma_f32 v185, v73, s36, -v50
    buffer_load_dwordx4 v4, s[16:19], s33 offen offset:2048 nt lds
    v_mfma_f32_32x32x16_bf16 v[80:95], a[124:127], a[60:63], v[80:95]
    v_cvt_pk_bf16_f32 v151, v158, v159
    buffer_store_dwordx4 v[144:147], v46, s[20:23], s97 offen offset:2048 sc1
    buffer_store_dwordx4 v[148:151], v46, s[20:23], s100 offen offset:2048 sc1
    v_exp_f32 v190, v190
    v_exp_f32 v191, v191
    v_add_f32 v56, v56, v188
    buffer_load_dwordx4 v5, s[16:19], s33 offen offset:3072 nt lds
    v_mfma_f32_32x32x16_bf16 v[96:111], a[96:99], a[64:67], 0
    v_add_f32 v56, v56, v189
    v_cvt_pk_bf16_f32 v162, v188, v189
    v_fma_f32 v186, v74, s36, -v50
    v_fma_f32 v187, v75, s36, -v50
    v_exp_f32 v184, v184
    v_mfma_f32_32x32x16_bf16 v[96:111], a[100:103], a[68:71], v[96:111]
    v_exp_f32 v185, v185
    v_add_f32 v56, v56, v190
    v_add_f32 v56, v56, v191
    v_cvt_pk_bf16_f32 v163, v190, v191
    s_waitcnt vmcnt(22)
    s_waitcnt lgkmcnt(0)
    s_barrier
    s_mov_b32 s29, s76
    s_add_u32 s76, s76, 32768
    s_cmp_ge_u32 s76, 98304
    s_cselect_b32 s76, 0, s76
    v_add_u32 v26, s29, v24
    v_add_u32 v27, s29, v25
    v_mfma_f32_32x32x16_bf16 v[96:111], a[104:107], a[72:75], v[96:111]
    v_fma_f32 v188, v76, s36, -v50
    v_fma_f32 v189, v77, s36, -v50
    v_exp_f32 v186, v186
    v_exp_f32 v187, v187
    ds_read_b64_tr_b16 a[128:129], v26 offset:0
    ds_read_b64_tr_b16 a[130:131], v27 offset:0
    ds_read_b128 a[140:143], v29 offset:0
    v_mfma_f32_32x32x16_bf16 v[96:111], a[108:111], a[76:79], v[96:111]
    v_add_f32 v56, v56, v184
    v_add_f32 v56, v56, v185
    v_cvt_pk_bf16_f32 v164, v184, v185
    v_fma_f32 v190, v78, s36, -v50
    v_fma_f32 v191, v79, s36, -v50
    ds_read_b128 a[144:147], v29 offset:1024
    ds_read_b128 a[148:151], v29 offset:2048
    ds_read_b64_tr_b16 a[132:133], v26 offset:4096
    v_mfma_f32_32x32x16_bf16 v[96:111], a[112:115], a[80:83], v[96:111]
    v_exp_f32 v188, v188
    v_exp_f32 v189, v189
    v_add_f32 v56, v56, v186
    ds_read_b64_tr_b16 a[134:135], v27 offset:4096
    ds_read_b128 a[152:155], v29 offset:3072
    ds_read_b128 a[156:159], v29 offset:4096
    v_mfma_f32_32x32x16_bf16 v[96:111], a[116:119], a[84:87], v[96:111]
    v_add_f32 v56, v56, v187
    v_cvt_pk_bf16_f32 v165, v186, v187
    v_exp_f32 v190, v190
    v_exp_f32 v191, v191
    ds_read_b128 a[160:163], v29 offset:5120
    ds_read_b64_tr_b16 a[136:137], v26 offset:8192
    ds_read_b64_tr_b16 a[138:139], v27 offset:8192
    v_mfma_f32_32x32x16_bf16 v[96:111], a[120:123], a[88:91], v[96:111]
    v_add_f32 v56, v56, v188
    v_add_f32 v56, v56, v189
    v_cvt_pk_bf16_f32 v166, v188, v189
    v_add_f32 v56, v56, v190
    v_add_f32 v56, v56, v191
    ds_read_b128 a[164:167], v29 offset:6144
    ds_read_b128 a[168:171], v29 offset:7168
    ds_read_b128 a[172:175], v29 offset:8192
    v_mfma_f32_32x32x16_bf16 v[96:111], a[124:127], a[92:95], v[96:111]
    v_cvt_pk_bf16_f32 v167, v190, v191
    s_waitcnt lgkmcnt(10)
    v_mfma_f32_32x32x16_bf16 v[112:127], a[128:131], a[140:143], 0
    v_cmp_lt_f32 vcc, s37, v56
    s_nop 0
    s_mov_b64 s[72:73], vcc
    v_fma_f32 v192, v80, s36, -v51
    v_fma_f32 v193, v81, s36, -v51
    v_fma_f32 v194, v82, s36, -v51
    v_fma_f32 v195, v83, s36, -v51
    v_mfma_f32_32x32x16_bf16 v[128:143], a[128:131], a[144:147], 0
    v_exp_f32 v192, v192
    v_exp_f32 v193, v193
    v_fma_f32 v196, v84, s36, -v51
    v_fma_f32 v197, v85, s36, -v51
    v_mfma_f32_32x32x16_bf16 v[144:159], a[128:131], a[148:151], 0
    v_exp_f32 v194, v194
    v_exp_f32 v195, v195
    v_add_f32 v57, v192, v193
    v_cvt_pk_bf16_f32 v168, v192, v193
    s_waitcnt lgkmcnt(5)
    v_mfma_f32_32x32x16_bf16 v[112:127], a[132:135], a[152:155], v[112:127]
    ds_read_b64_tr_b16 a[128:129], v26 offset:12288
    ds_read_b64_tr_b16 a[130:131], v27 offset:12288
    v_fma_f32 v198, v86, s36, -v51
    v_fma_f32 v199, v87, s36, -v51
    v_exp_f32 v196, v196
    v_exp_f32 v197, v197
    v_mfma_f32_32x32x16_bf16 v[128:143], a[132:135], a[156:159], v[128:143]
    ds_read_b128 a[140:143], v29 offset:9216
    ds_read_b128 a[144:147], v29 offset:10240
    v_add_f32 v57, v57, v194
    v_add_f32 v57, v57, v195
    v_cvt_pk_bf16_f32 v169, v194, v195
    v_fma_f32 v192, v88, s36, -v51
    v_fma_f32 v193, v89, s36, -v51
    v_exp_f32 v198, v198
    v_mfma_f32_32x32x16_bf16 v[144:159], a[132:135], a[160:163], v[144:159]
    ds_read_b128 a[148:151], v29 offset:11264
    v_exp_f32 v199, v199
    v_add_f32 v57, v57, v196
    v_add_f32 v57, v57, v197
    v_cvt_pk_bf16_f32 v170, v196, v197
    v_fma_f32 v194, v90, s36, -v51
    s_waitcnt lgkmcnt(5)
    v_mfma_f32_32x32x16_bf16 v[112:127], a[136:139], a[164:167], v[112:127]
    ds_read_b64_tr_b16 a[132:133], v26 offset:16384
    ds_read_b64_tr_b16 a[134:135], v27 offset:16384
    v_fma_f32 v195, v91, s36, -v51
    v_exp_f32 v192, v192
    v_exp_f32 v193, v193
    v_add_f32 v57, v57, v198
    v_mfma_f32_32x32x16_bf16 v[128:143], a[136:139], a[168:171], v[128:143]
    ds_read_b128 a[152:155], v29 offset:12288
    ds_read_b128 a[156:159], v29 offset:13312
    v_add_f32 v57, v57, v199
    v_cvt_pk_bf16_f32 v171, v198, v199
    v_fma_f32 v196, v92, s36, -v51
    v_fma_f32 v197, v93, s36, -v51
    v_exp_f32 v194, v194
    v_mfma_f32_32x32x16_bf16 v[144:159], a[136:139], a[172:175], v[144:159]
    ds_read_b128 a[160:163], v29 offset:14336
    v_exp_f32 v195, v195
    v_add_f32 v57, v57, v192
    v_add_f32 v57, v57, v193
    v_cvt_pk_bf16_f32 v172, v192, v193
    v_fma_f32 v198, v94, s36, -v51
    s_waitcnt lgkmcnt(5)
    v_mfma_f32_32x32x16_bf16 v[112:127], a[128:131], a[140:143], v[112:127]
    ds_read_b64_tr_b16 a[136:137], v26 offset:20480
    ds_read_b64_tr_b16 a[138:139], v27 offset:20480
    v_fma_f32 v199, v95, s36, -v51
    v_exp_f32 v196, v196
    v_exp_f32 v197, v197
    v_add_f32 v57, v57, v194
    v_mfma_f32_32x32x16_bf16 v[128:143], a[128:131], a[144:147], v[128:143]
    ds_read_b128 a[164:167], v29 offset:15360
    ds_read_b128 a[168:171], v29 offset:16384
    v_add_f32 v57, v57, v195
    v_cvt_pk_bf16_f32 v173, v194, v195
    v_exp_f32 v198, v198
    v_exp_f32 v199, v199
    v_mfma_f32_32x32x16_bf16 v[144:159], a[128:131], a[148:151], v[144:159]
    ds_read_b128 a[172:175], v29 offset:17408
    v_add_f32 v57, v57, v196
    v_add_f32 v57, v57, v197
    v_cvt_pk_bf16_f32 v174, v196, v197
    v_add_f32 v57, v57, v198
    v_add_f32 v57, v57, v199
    v_cvt_pk_bf16_f32 v175, v198, v199
    s_waitcnt lgkmcnt(5)
    v_mfma_f32_32x32x16_bf16 v[112:127], a[132:135], a[152:155], v[112:127]
    ds_read_b64_tr_b16 a[128:129], v26 offset:24576
    ds_read_b64_tr_b16 a[130:131], v27 offset:24576
    v_cmp_lt_f32 vcc, s37, v57
    s_nop 0
    s_or_b64 s[72:73], s[72:73], vcc
    v_fma_f32 v184, v96, s36, -v52
    v_fma_f32 v185, v97, s36, -v52
    v_fma_f32 v186, v98, s36, -v52
    v_fma_f32 v187, v99, s36, -v52
    v_mfma_f32_32x32x16_bf16 v[128:143], a[132:135], a[156:159], v[128:143]
    ds_read_b128 a[140:143], v29 offset:18432
    ds_read_b128 a[144:147], v29 offset:19456
    v_exp_f32 v184, v184
    v_exp_f32 v185, v185
    v_fma_f32 v188, v100, s36, -v52
    v_fma_f32 v189, v101, s36, -v52
    v_mfma_f32_32x32x16_bf16 v[144:159], a[132:135], a[160:163], v[144:159]
    ds_read_b128 a[148:151], v29 offset:20480
    v_exp_f32 v186, v186
    v_exp_f32 v187, v187
    v_add_f32 v58, v184, v185
    v_cvt_pk_bf16_f32 v176, v184, v185
    s_waitcnt lgkmcnt(5)
    v_mfma_f32_32x32x16_bf16 v[112:127], a[136:139], a[164:167], v[112:127]
    ds_read_b64_tr_b16 a[132:133], v26 offset:28672
    ds_read_b64_tr_b16 a[134:135], v27 offset:28672
    v_fma_f32 v190, v102, s36, -v52
    v_fma_f32 v191, v103, s36, -v52
    v_exp_f32 v188, v188
    v_exp_f32 v189, v189
    v_mfma_f32_32x32x16_bf16 v[128:143], a[136:139], a[168:171], v[128:143]
    ds_read_b128 a[152:155], v29 offset:21504
    ds_read_b128 a[156:159], v29 offset:22528
    v_add_f32 v58, v58, v186
    v_add_f32 v58, v58, v187
    v_cvt_pk_bf16_f32 v177, v186, v187
    v_fma_f32 v184, v104, s36, -v52
    v_fma_f32 v185, v105, s36, -v52
    v_exp_f32 v190, v190
    v_mfma_f32_32x32x16_bf16 v[144:159], a[136:139], a[172:175], v[144:159]
    ds_read_b128 a[160:163], v29 offset:23552
    v_exp_f32 v191, v191
    v_add_f32 v58, v58, v188
    v_add_f32 v58, v58, v189
    v_cvt_pk_bf16_f32 v178, v188, v189
    v_fma_f32 v186, v106, s36, -v52
    s_waitcnt lgkmcnt(5)
    v_mfma_f32_32x32x16_bf16 v[112:127], a[128:131], a[140:143], v[112:127]
    v_fma_f32 v187, v107, s36, -v52
    v_exp_f32 v184, v184
    v_exp_f32 v185, v185
    v_add_f32 v58, v58, v190
    v_mfma_f32_32x32x16_bf16 v[128:143], a[128:131], a[144:147], v[128:143]
    v_add_f32 v58, v58, v191
    v_cvt_pk_bf16_f32 v179, v190, v191
    v_fma_f32 v188, v108, s36, -v52
    v_fma_f32 v189, v109, s36, -v52
    v_exp_f32 v186, v186
    v_mfma_f32_32x32x16_bf16 v[144:159], a[128:131], a[148:151], v[144:159]
    v_exp_f32 v187, v187
    v_add_f32 v58, v58, v184
    v_add_f32 v58, v58, v185
    v_cvt_pk_bf16_f32 v180, v184, v185
    v_fma_f32 v190, v110, s36, -v52
    s_waitcnt lgkmcnt(0)
    v_mfma_f32_32x32x16_bf16 v[112:127], a[132:135], a[152:155], v[112:127]
    v_fma_f32 v191, v111, s36, -v52
    v_exp_f32 v188, v188
    v_exp_f32 v189, v189
    v_add_f32 v58, v58, v186
    v_mfma_f32_32x32x16_bf16 v[128:143], a[132:135], a[156:159], v[128:143]
    v_add_f32 v58, v58, v187
    v_cvt_pk_bf16_f32 v181, v186, v187
    v_exp_f32 v190, v190
    v_exp_f32 v191, v191
    v_mfma_f32_32x32x16_bf16 v[144:159], a[132:135], a[160:163], v[144:159]
    v_add_f32 v58, v58, v188
    v_add_f32 v58, v58, v189
    v_cvt_pk_bf16_f32 v182, v188, v189
    v_add_f32 v58, v58, v190
    v_add_f32 v58, v58, v191
    v_cvt_pk_bf16_f32 v183, v190, v191
    v_cmp_lt_f32 vcc, s37, v58
    s_nop 0
    s_or_b64 s[72:73], s[72:73], vcc
    s_cmp_eq_u64 s[72:73], 0
    s_cbranch_scc1 Lnf_45
    v_mov_b32 v59, 1
    ds_write_b32 v6, v59
Lnf_45:
    s_waitcnt lgkmcnt(0)
    s_barrier
    ds_read_b32 v59, v6
    s_mov_b32 s71, s76
    s_add_u32 s76, s76, 32768
    s_cmp_ge_u32 s76, 98304
    s_cselect_b32 s76, 0, s76
    s_waitcnt vmcnt(14)
    v_add_u32 v16, s71, v8
    v_add_u32 v17, s71, v9
    v_add_u32 v18, s71, v10
    v_add_u32 v19, s71, v11
    v_add_u32 v20, s71, v12
    v_add_u32 v21, s71, v13
    v_add_u32 v22, s71, v14
    v_add_u32 v23, s71, v15
    ds_read_b128 a[96:99], v16
    ds_read_b128 a[100:103], v17
    ds_read_b128 a[104:107], v18
    ds_read_b128 a[108:111], v19
    ds_read_b128 a[112:115], v20
    ds_read_b128 a[116:119], v21
    ds_read_b128 a[120:123], v22
    ds_read_b128 a[124:127], v23
    s_add_u32 m0, s29, s35
    s_add_u32 s33, s74, 4096
    buffer_load_dwordx4 v2, s[12:15], s74 offen offset:0 nt lds
    ds_write_b128 v28, v[160:163] offset:0
    ds_write_b128 v28, v[164:167] offset:3072
    ds_write_b128 v28, v[168:171] offset:1024
    ds_write_b128 v28, v[172:175] offset:4096
    ds_write_b128 v28, v[176:179] offset:2048
    ds_write_b128 v28, v[180:183] offset:5120
    buffer_load_dwordx4 v3, s[12:15], s74 offen offset:1024 nt lds
    buffer_load_dwordx4 v4, s[12:15], s74 offen offset:2048 nt lds
    buffer_load_dwordx4 v5, s[12:15], s74 offen offset:3072 nt lds
    s_waitcnt lgkmcnt(14)
    v_readfirstlane_b32 s31, v59
    s_nop 0
    s_cmp_lg_u32 s31, 0
    s_cbranch_scc1 Lslow_47
Lpost_46:
    v_add_f32 v53, v53, v56
    v_add_f32 v54, v54, v57
    v_add_f32 v55, v55, v58
    s_waitcnt lgkmcnt(13)
    v_mfma_f32_32x32x16_bf16 v[64:79], a[96:99], a[0:3], 0
    s_add_u32 m0, m0, 4096
    s_add_u32 s74, s74, 32768
    buffer_load_dwordx4 v2, s[12:15], s33 offen offset:0 nt lds
    s_waitcnt lgkmcnt(12)
    v_mfma_f32_32x32x16_bf16 v[64:79], a[100:103], a[4:7], v[64:79]
    buffer_load_dwordx4 v3, s[12:15], s33 offen offset:1024 nt lds
    s_waitcnt lgkmcnt(11)
    v_mfma_f32_32x32x16_bf16 v[64:79], a[104:107], a[8:11], v[64:79]
    buffer_load_dwordx4 v4, s[12:15], s33 offen offset:2048 nt lds
    s_waitcnt lgkmcnt(10)
    v_mfma_f32_32x32x16_bf16 v[64:79], a[108:111], a[12:15], v[64:79]
    buffer_load_dwordx4 v5, s[12:15], s33 offen offset:3072 nt lds
    s_waitcnt lgkmcnt(9)
    v_mfma_f32_32x32x16_bf16 v[64:79], a[112:115], a[16:19], v[64:79]
    s_waitcnt lgkmcnt(8)
    v_mfma_f32_32x32x16_bf16 v[64:79], a[116:119], a[20:23], v[64:79]
    s_waitcnt lgkmcnt(7)
    v_mfma_f32_32x32x16_bf16 v[64:79], a[120:123], a[24:27], v[64:79]
    s_waitcnt lgkmcnt(6)
    v_mfma_f32_32x32x16_bf16 v[64:79], a[124:127], a[28:31], v[64:79]
    v_mfma_f32_32x32x16_bf16 v[80:95], a[96:99], a[32:35], 0
    s_add_u32 m0, s71, s35
    s_add_u32 s33, s75, 4096
    buffer_load_dwordx4 v2, s[16:19], s75 offen offset:0 nt lds
    v_mfma_f32_32x32x16_bf16 v[80:95], a[100:103], a[36:39], v[80:95]
    buffer_load_dwordx4 v3, s[16:19], s75 offen offset:1024 nt lds
    s_waitcnt lgkmcnt(0)
    v_mfma_f32_32x32x16_bf16 v[80:95], a[104:107], a[40:43], v[80:95]
    s_nop 3
    v_fma_f32 v184, v64, s36, -v50
    v_fma_f32 v185, v65, s36, -v50
    v_fma_f32 v186, v66, s36, -v50
    v_fma_f32 v187, v67, s36, -v50
    v_exp_f32 v184, v184
    buffer_load_dwordx4 v4, s[16:19], s75 offen offset:2048 nt lds
    v_mfma_f32_32x32x16_bf16 v[80:95], a[108:111], a[44:47], v[80:95]
    v_exp_f32 v185, v185
    v_fma_f32 v188, v68, s36, -v50
    v_fma_f32 v189, v69, s36, -v50
    v_exp_f32 v186, v186
    buffer_load_dwordx4 v5, s[16:19], s75 offen offset:3072 nt lds
    v_mfma_f32_32x32x16_bf16 v[80:95], a[112:115], a[48:51], v[80:95]
    v_exp_f32 v187, v187
    v_add_f32 v56, v184, v185
    v_cvt_pk_bf16_f32 v160, v184, v185
    v_fma_f32 v190, v70, s36, -v50
    s_add_u32 m0, m0, 4096
    s_add_u32 s75, s75, 32768
    buffer_load_dwordx4 v2, s[16:19], s33 offen offset:0 nt lds
    v_mfma_f32_32x32x16_bf16 v[80:95], a[116:119], a[52:55], v[80:95]
    v_fma_f32 v191, v71, s36, -v50
    v_exp_f32 v188, v188
    v_exp_f32 v189, v189
    buffer_load_dwordx4 v3, s[16:19], s33 offen offset:1024 nt lds
    v_mfma_f32_32x32x16_bf16 v[80:95], a[120:123], a[56:59], v[80:95]
    v_add_f32 v56, v56, v186
    v_add_f32 v56, v56, v187
    v_cvt_pk_bf16_f32 v161, v186, v187
    v_fma_f32 v184, v72, s36, -v50
    v_fma_f32 v185, v73, s36, -v50
    buffer_load_dwordx4 v4, s[16:19], s33 offen offset:2048 nt lds
    v_mfma_f32_32x32x16_bf16 v[80:95], a[124:127], a[60:63], v[80:95]
    v_exp_f32 v190, v190
    v_exp_f32 v191, v191
    v_add_f32 v56, v56, v188
    buffer_load_dwordx4 v5, s[16:19], s33 offen offset:3072 nt lds
    v_mfma_f32_32x32x16_bf16 v[96:111], a[96:99], a[64:67], 0
    v_add_f32 v56, v56, v189
    v_cvt_pk_bf16_f32 v162, v188, v189
    v_fma_f32 v186, v74, s36, -v50
    v_fma_f32 v187, v75, s36, -v50
    v_exp_f32 v184, v184
    v_mfma_f32_32x32x16_bf16 v[96:111], a[100:103], a[68:71], v[96:111]
    v_exp_f32 v185, v185
    v_add_f32 v56, v56, v190
    v_add_f32 v56, v56, v191
    v_cvt_pk_bf16_f32 v163, v190, v191
    s_waitcnt vmcnt(16)
    s_waitcnt lgkmcnt(0)
    s_barrier
    s_mov_b32 s29, s76
    s_add_u32 s76, s76, 32768
    s_cmp_ge_u32 s76, 98304
    s_cselect_b32 s76, 0, s76
    v_add_u32 v26, s29, v24
    v_add_u32 v27, s29, v25
    v_mfma_f32_32x32x16_bf16 v[96:111], a[104:107], a[72:75], v[96:111]
    v_fma_f32 v188, v76, s36, -v50
    v_fma_f32 v189, v77, s36, -v50
    v_exp_f32 v186, v186
    v_exp_f32 v187, v187
    ds_read_b64_tr_b16 a[128:129], v26 offset:0
    ds_read_b64_tr_b16 a[130:131], v27 offset:0
    ds_read_b128 a[140:143], v29 offset:0
    v_mfma_f32_32x32x16_bf16 v[96:111], a[108:111], a[76:79], v[96:111]
    v_add_f32 v56, v56, v184
    v_add_f32 v56, v56, v185
    v_cvt_pk_bf16_f32 v164, v184, v185
    v_fma_f32 v190, v78, s36, -v50
    v_fma_f32 v191, v79, s36, -v50
    ds_read_b128 a[144:147], v29 offset:1024
    ds_read_b128 a[148:151], v29 offset:2048
    ds_read_b64_tr_b16 a[132:133], v26 offset:4096
    v_mfma_f32_32x32x16_bf16 v[96:111], a[112:115], a[80:83], v[96:111]
    v_exp_f32 v188, v188
    v_exp_f32 v189, v189
    v_add_f32 v56, v56, v186
    ds_read_b64_tr_b16 a[134:135], v27 offset:4096
    ds_read_b128 a[152:155], v29 offset:3072
    ds_read_b128 a[156:159], v29 offset:4096
    v_mfma_f32_32x32x16_bf16 v[96:111], a[116:119], a[84:87], v[96:111]
    v_add_f32 v56, v56, v187
    v_cvt_pk_bf16_f32 v165, v186, v187
    v_exp_f32 v190, v190
    v_exp_f32 v191, v191
    ds_read_b128 a[160:163], v29 offset:5120
    ds_read_b64_tr_b16 a[136:137], v26 offset:8192
    ds_read_b64_tr_b16 a[138:139], v27 offset:8192
    v_mfma_f32_32x32x16_bf16 v[96:111], a[120:123], a[88:91], v[96:111]
    v_add_f32 v56, v56, v188
    v_add_f32 v56, v56, v189
    v_cvt_pk_bf16_f32 v166, v188, v189
    v_add_f32 v56, v56, v190
    v_add_f32 v56, v56, v191
    ds_read_b128 a[164:167], v29 offset:6144
    ds_read_b128 a[168:171], v29 offset:7168
    ds_read_b128 a[172:175], v29 offset:8192
    v_mfma_f32_32x32x16_bf16 v[96:111], a[124:127], a[92:95], v[96:111]
    v_cvt_pk_bf16_f32 v167, v190, v191
    s_waitcnt lgkmcnt(10)
    v_mfma_f32_32x32x16_bf16 v[112:127], a[128:131], a[140:143], v[112:127]
    v_cmp_lt_f32 vcc, s37, v56
    s_nop 0
    s_mov_b64 s[72:73], vcc
    v_fma_f32 v192, v80, s36, -v51
    v_fma_f32 v193, v81, s36, -v51
    v_fma_f32 v194, v82, s36, -v51
    v_fma_f32 v195, v83, s36, -v51
    v_mfma_f32_32x32x16_bf16 v[128:143], a[128:131], a[144:147], v[128:143]
    v_exp_f32 v192, v192
    v_exp_f32 v193, v193
    v_fma_f32 v196, v84, s36, -v51
    v_fma_f32 v197, v85, s36, -v51
    v_mfma_f32_32x32x16_bf16 v[144:159], a[128:131], a[148:151], v[144:159]
    v_exp_f32 v194, v194
    v_exp_f32 v195, v195
    v_add_f32 v57, v192, v193
    v_cvt_pk_bf16_f32 v168, v192, v193
    s_waitcnt lgkmcnt(5)
    v_mfma_f32_32x32x16_bf16 v[112:127], a[132:135], a[152:155], v[112:127]
    ds_read_b64_tr_b16 a[128:129], v26 offset:12288
    ds_read_b64_tr_b16 a[130:131], v27 offset:12288
    v_fma_f32 v198, v86, s36, -v51
    v_fma_f32 v199, v87, s36, -v51
    v_exp_f32 v196, v196
    v_exp_f32 v197, v197
    v_mfma_f32_32x32x16_bf16 v[128:143], a[132:135], a[156:159], v[128:143]
    ds_read_b128 a[140:143], v29 offset:9216
    ds_read_b128 a[144:147], v29 offset:10240
    v_add_f32 v57, v57, v194
    v_add_f32 v57, v57, v195
    v_cvt_pk_bf16_f32 v169, v194, v195
    v_fma_f32 v192, v88, s36, -v51
    v_fma_f32 v193, v89, s36, -v51
    v_exp_f32 v198, v198
    v_mfma_f32_32x32x16_bf16 v[144:159], a[132:135], a[160:163], v[144:159]
    ds_read_b128 a[148:151], v29 offset:11264
    v_exp_f32 v199, v199
    v_add_f32 v57, v57, v196
    v_add_f32 v57, v57, v197
    v_cvt_pk_bf16_f32 v170, v196, v197
    v_fma_f32 v194, v90, s36, -v51
    s_waitcnt lgkmcnt(5)
    v_mfma_f32_32x32x16_bf16 v[112:127], a[136:139], a[164:167], v[112:127]
    ds_read_b64_tr_b16 a[132:133], v26 offset:16384
    ds_read_b64_tr_b16 a[134:135], v27 offset:16384
    v_fma_f32 v195, v91, s36, -v51
    v_exp_f32 v192, v192
    v_exp_f32 v193, v193
    v_add_f32 v57, v57, v198
    v_mfma_f32_32x32x16_bf16 v[128:143], a[136:139], a[168:171], v[128:143]
    ds_read_b128 a[152:155], v29 offset:12288
    ds_read_b128 a[156:159], v29 offset:13312
    v_add_f32 v57, v57, v199
    v_cvt_pk_bf16_f32 v171, v198, v199
    v_fma_f32 v196, v92, s36, -v51
    v_fma_f32 v197, v93, s36, -v51
    v_exp_f32 v194, v194
    v_mfma_f32_32x32x16_bf16 v[144:159], a[136:139], a[172:175], v[144:159]
    ds_read_b128 a[160:163], v29 offset:14336
    v_exp_f32 v195, v195
    v_add_f32 v57, v57, v192
    v_add_f32 v57, v57, v193
    v_cvt_pk_bf16_f32 v172, v192, v193
    v_fma_f32 v198, v94, s36, -v51
    s_waitcnt lgkmcnt(5)
    v_mfma_f32_32x32x16_bf16 v[112:127], a[128:131], a[140:143], v[112:127]
    ds_read_b64_tr_b16 a[136:137], v26 offset:20480
    ds_read_b64_tr_b16 a[138:139], v27 offset:20480
    v_fma_f32 v199, v95, s36, -v51
    v_exp_f32 v196, v196
    v_exp_f32 v197, v197
    v_add_f32 v57, v57, v194
    v_mfma_f32_32x32x16_bf16 v[128:143], a[128:131], a[144:147], v[128:143]
    ds_read_b128 a[164:167], v29 offset:15360
    ds_read_b128 a[168:171], v29 offset:16384
    v_add_f32 v57, v57, v195
    v_cvt_pk_bf16_f32 v173, v194, v195
    v_exp_f32 v198, v198
    v_exp_f32 v199, v199
    v_mfma_f32_32x32x16_bf16 v[144:159], a[128:131], a[148:151], v[144:159]
    ds_read_b128 a[172:175], v29 offset:17408
    v_add_f32 v57, v57, v196
    v_add_f32 v57, v57, v197
    v_cvt_pk_bf16_f32 v174, v196, v197
    v_add_f32 v57, v57, v198
    v_add_f32 v57, v57, v199
    v_cvt_pk_bf16_f32 v175, v198, v199
    s_waitcnt lgkmcnt(5)
    v_mfma_f32_32x32x16_bf16 v[112:127], a[132:135], a[152:155], v[112:127]
    ds_read_b64_tr_b16 a[128:129], v26 offset:24576
    ds_read_b64_tr_b16 a[130:131], v27 offset:24576
    v_cmp_lt_f32 vcc, s37, v57
    s_nop 0
    s_or_b64 s[72:73], s[72:73], vcc
    v_fma_f32 v184, v96, s36, -v52
    v_fma_f32 v185, v97, s36, -v52
    v_fma_f32 v186, v98, s36, -v52
    v_fma_f32 v187, v99, s36, -v52
    v_mfma_f32_32x32x16_bf16 v[128:143], a[132:135], a[156:159], v[128:143]
    ds_read_b128 a[140:143], v29 offset:18432
    ds_read_b128 a[144:147], v29 offset:19456
    v_exp_f32 v184, v184
    v_exp_f32 v185, v185
    v_fma_f32 v188, v100, s36, -v52
    v_fma_f32 v189, v101, s36, -v52
    v_mfma_f32_32x32x16_bf16 v[144:159], a[132:135], a[160:163], v[144:159]
    ds_read_b128 a[148:151], v29 offset:20480
    v_exp_f32 v186, v186
    v_exp_f32 v187, v187
    v_add_f32 v58, v184, v185
    v_cvt_pk_bf16_f32 v176, v184, v185
    s_waitcnt lgkmcnt(5)
    v_mfma_f32_32x32x16_bf16 v[112:127], a[136:139], a[164:167], v[112:127]
    ds_read_b64_tr_b16 a[132:133], v26 offset:28672
    ds_read_b64_tr_b16 a[134:135], v27 offset:28672
    v_fma_f32 v190, v102, s36, -v52
    v_fma_f32 v191, v103, s36, -v52
    v_exp_f32 v188, v188
    v_exp_f32 v189, v189
    v_mfma_f32_32x32x16_bf16 v[128:143], a[136:139], a[168:171], v[128:143]
    ds_read_b128 a[152:155], v29 offset:21504
    ds_read_b128 a[156:159], v29 offset:22528
    v_add_f32 v58, v58, v186
    v_add_f32 v58, v58, v187
    v_cvt_pk_bf16_f32 v177, v186, v187
    v_fma_f32 v184, v104, s36, -v52
    v_fma_f32 v185, v105, s36, -v52
    v_exp_f32 v190, v190
    v_mfma_f32_32x32x16_bf16 v[144:159], a[136:139], a[172:175], v[144:159]
    ds_read_b128 a[160:163], v29 offset:23552
    v_exp_f32 v191, v191
    v_add_f32 v58, v58, v188
    v_add_f32 v58, v58, v189
    v_cvt_pk_bf16_f32 v178, v188, v189
    v_fma_f32 v186, v106, s36, -v52
    s_waitcnt lgkmcnt(5)
    v_mfma_f32_32x32x16_bf16 v[112:127], a[128:131], a[140:143], v[112:127]
    v_fma_f32 v187, v107, s36, -v52
    v_exp_f32 v184, v184
    v_exp_f32 v185, v185
    v_add_f32 v58, v58, v190
    v_mfma_f32_32x32x16_bf16 v[128:143], a[128:131], a[144:147], v[128:143]
    v_add_f32 v58, v58, v191
    v_cvt_pk_bf16_f32 v179, v190, v191
    v_fma_f32 v188, v108, s36, -v52
    v_fma_f32 v189, v109, s36, -v52
    v_exp_f32 v186, v186
    v_mfma_f32_32x32x16_bf16 v[144:159], a[128:131], a[148:151], v[144:159]
    v_exp_f32 v187, v187
    v_add_f32 v58, v58, v184
    v_add_f32 v58, v58, v185
    v_cvt_pk_bf16_f32 v180, v184, v185
    v_fma_f32 v190, v110, s36, -v52
    s_waitcnt lgkmcnt(0)
    v_mfma_f32_32x32x16_bf16 v[112:127], a[132:135], a[152:155], v[112:127]
    v_fma_f32 v191, v111, s36, -v52
    v_exp_f32 v188, v188
    v_exp_f32 v189, v189
    v_add_f32 v58, v58, v186
    v_mfma_f32_32x32x16_bf16 v[128:143], a[132:135], a[156:159], v[128:143]
    v_add_f32 v58, v58, v187
    v_cvt_pk_bf16_f32 v181, v186, v187
    v_exp_f32 v190, v190
    v_exp_f32 v191, v191
    v_mfma_f32_32x32x16_bf16 v[144:159], a[132:135], a[160:163], v[144:159]
    v_add_f32 v58, v58, v188
    v_add_f32 v58, v58, v189
    v_cvt_pk_bf16_f32 v182, v188, v189
    v_add_f32 v58, v58, v190
    v_add_f32 v58, v58, v191
    v_cvt_pk_bf16_f32 v183, v190, v191
    v_cmp_lt_f32 vcc, s37, v58
    s_nop 0
    s_or_b64 s[72:73], s[72:73], vcc
    s_cmp_eq_u64 s[72:73], 0
    s_cbranch_scc1 Lnf_48
    v_mov_b32 v59, 1
    ds_write_b32 v6, v59
Lnf_48:
    s_waitcnt lgkmcnt(0)
    s_barrier
    ds_read_b32 v59, v6
    s_mov_b32 s71, s76
    s_add_u32 s76, s76, 32768
    s_cmp_ge_u32 s76, 98304
    s_cselect_b32 s76, 0, s76
    s_waitcnt vmcnt(8)
    v_add_u32 v16, s71, v8
    v_add_u32 v17, s71, v9
    v_add_u32 v18, s71, v10
    v_add_u32 v19, s71, v11
    v_add_u32 v20, s71, v12
    v_add_u32 v21, s71, v13
    v_add_u32 v22, s71, v14
    v_add_u32 v23, s71, v15
    ds_read_b128 a[96:99], v16
    ds_read_b128 a[100:103], v17
    ds_read_b128 a[104:107], v18
    ds_read_b128 a[108:111], v19
    ds_read_b128 a[112:115], v20
    ds_read_b128 a[116:119], v21
    ds_read_b128 a[120:123], v22
    ds_read_b128 a[124:127], v23
    s_add_u32 m0, s29, s35
    s_add_u32 s33, s74, 4096
    buffer_load_dwordx4 v2, s[12:15], s74 offen offset:0 nt lds
    ds_write_b128 v28, v[160:163] offset:0
    ds_write_b128 v28, v[164:167] offset:3072
    ds_write_b128 v28, v[168:171] offset:1024
    ds_write_b128 v28, v[172:175] offset:4096
    ds_write_b128 v28, v[176:179] offset:2048
    ds_write_b128 v28, v[180:183] offset:5120
    buffer_load_dwordx4 v3, s[12:15], s74 offen offset:1024 nt lds
    buffer_load_dwordx4 v4, s[12:15], s74 offen offset:2048 nt lds
    buffer_load_dwordx4 v5, s[12:15], s74 offen offset:3072 nt lds
    s_waitcnt lgkmcnt(14)
    v_readfirstlane_b32 s31, v59
    s_nop 0
    s_cmp_lg_u32 s31, 0
    s_cbranch_scc1 Lslow_50
Lpost_49:
    v_add_f32 v53, v53, v56
    v_add_f32 v54, v54, v57
    v_add_f32 v55, v55, v58
    s_waitcnt lgkmcnt(13)
    v_mfma_f32_32x32x16_bf16 v[64:79], a[96:99], a[0:3], 0
    s_add_u32 m0, m0, 4096
    s_add_u32 s74, s74, 32768
    buffer_load_dwordx4 v2, s[12:15], s33 offen offset:0 nt lds
    s_waitcnt lgkmcnt(12)
    v_mfma_f32_32x32x16_bf16 v[64:79], a[100:103], a[4:7], v[64:79]
    buffer_load_dwordx4 v3, s[12:15], s33 offen offset:1024 nt lds
    s_waitcnt lgkmcnt(11)
    v_mfma_f32_32x32x16_bf16 v[64:79], a[104:107], a[8:11], v[64:79]
    buffer_load_dwordx4 v4, s[12:15], s33 offen offset:2048 nt lds
    s_waitcnt lgkmcnt(10)
    v_mfma_f32_32x32x16_bf16 v[64:79], a[108:111], a[12:15], v[64:79]
    buffer_load_dwordx4 v5, s[12:15], s33 offen offset:3072 nt lds
    s_waitcnt lgkmcnt(9)
    v_mfma_f32_32x32x16_bf16 v[64:79], a[112:115], a[16:19], v[64:79]
    s_waitcnt lgkmcnt(8)
    v_mfma_f32_32x32x16_bf16 v[64:79], a[116:119], a[20:23], v[64:79]
    s_waitcnt lgkmcnt(7)
    v_mfma_f32_32x32x16_bf16 v[64:79], a[120:123], a[24:27], v[64:79]
    s_waitcnt lgkmcnt(6)
    v_mfma_f32_32x32x16_bf16 v[64:79], a[124:127], a[28:31], v[64:79]
    v_mfma_f32_32x32x16_bf16 v[80:95], a[96:99], a[32:35], 0
    s_add_u32 m0, s71, s35
    s_add_u32 s33, s75, 4096
    buffer_load_dwordx4 v2, s[16:19], s75 offen offset:0 nt lds
    v_mfma_f32_32x32x16_bf16 v[80:95], a[100:103], a[36:39], v[80:95]
    buffer_load_dwordx4 v3, s[16:19], s75 offen offset:1024 nt lds
    s_waitcnt lgkmcnt(0)
    v_mfma_f32_32x32x16_bf16 v[80:95], a[104:107], a[40:43], v[80:95]
    s_nop 3
    v_fma_f32 v184, v64, s36, -v50
    v_fma_f32 v185, v65, s36, -v50
    v_fma_f32 v186, v66, s36, -v50
    v_fma_f32 v187, v67, s36, -v50
    v_exp_f32 v184, v184
    buffer_load_dwordx4 v4, s[16:19], s75 offen offset:2048 nt lds
    v_mfma_f32_32x32x16_bf16 v[80:95], a[108:111], a[44:47], v[80:95]
    v_exp_f32 v185, v185
    v_fma_f32 v188, v68, s36, -v50
    v_fma_f32 v189, v69, s36, -v50
    v_exp_f32 v186, v186
    buffer_load_dwordx4 v5, s[16:19], s75 offen offset:3072 nt lds
    v_mfma_f32_32x32x16_bf16 v[80:95], a[112:115], a[48:51], v[80:95]
    v_exp_f32 v187, v187
    v_add_f32 v56, v184, v185
    v_cvt_pk_bf16_f32 v160, v184, v185
    v_fma_f32 v190, v70, s36, -v50
    s_add_u32 m0, m0, 4096
    s_add_u32 s75, s75, 32768
    buffer_load_dwordx4 v2, s[16:19], s33 offen offset:0 nt lds
    v_mfma_f32_32x32x16_bf16 v[80:95], a[116:119], a[52:55], v[80:95]
    v_fma_f32 v191, v71, s36, -v50
    v_exp_f32 v188, v188
    v_exp_f32 v189, v189
    buffer_load_dwordx4 v3, s[16:19], s33 offen offset:1024 nt lds
    v_mfma_f32_32x32x16_bf16 v[80:95], a[120:123], a[56:59], v[80:95]
    v_add_f32 v56, v56, v186
    v_add_f32 v56, v56, v187
    v_cvt_pk_bf16_f32 v161, v186, v187
    v_fma_f32 v184, v72, s36, -v50
    v_fma_f32 v185, v73, s36, -v50
    buffer_load_dwordx4 v4, s[16:19], s33 offen offset:2048 nt lds
    v_mfma_f32_32x32x16_bf16 v[80:95], a[124:127], a[60:63], v[80:95]
    v_exp_f32 v190, v190
    v_exp_f32 v191, v191
    v_add_f32 v56, v56, v188
    buffer_load_dwordx4 v5, s[16:19], s33 offen offset:3072 nt lds
    v_mfma_f32_32x32x16_bf16 v[96:111], a[96:99], a[64:67], 0
    v_add_f32 v56, v56, v189
    v_cvt_pk_bf16_f32 v162, v188, v189
    v_fma_f32 v186, v74, s36, -v50
    v_fma_f32 v187, v75, s36, -v50
    v_exp_f32 v184, v184
    v_mfma_f32_32x32x16_bf16 v[96:111], a[100:103], a[68:71], v[96:111]
    v_exp_f32 v185, v185
    v_add_f32 v56, v56, v190
    v_add_f32 v56, v56, v191
    v_cvt_pk_bf16_f32 v163, v190, v191
    s_waitcnt vmcnt(16)
    s_waitcnt lgkmcnt(0)
    s_barrier
    s_mov_b32 s29, s76
    s_add_u32 s76, s76, 32768
    s_cmp_ge_u32 s76, 98304
    s_cselect_b32 s76, 0, s76
    v_add_u32 v26, s29, v24
    v_add_u32 v27, s29, v25
    v_mfma_f32_32x32x16_bf16 v[96:111], a[104:107], a[72:75], v[96:111]
    v_fma_f32 v188, v76, s36, -v50
    v_fma_f32 v189, v77, s36, -v50
    v_exp_f32 v186, v186
    v_exp_f32 v187, v187
    ds_read_b64_tr_b16 a[128:129], v26 offset:0
    ds_read_b64_tr_b16 a[130:131], v27 offset:0
    ds_read_b128 a[140:143], v29 offset:0
    v_mfma_f32_32x32x16_bf16 v[96:111], a[108:111], a[76:79], v[96:111]
    v_add_f32 v56, v56, v184
    v_add_f32 v56, v56, v185
    v_cvt_pk_bf16_f32 v164, v184, v185
    v_fma_f32 v190, v78, s36, -v50
    v_fma_f32 v191, v79, s36, -v50
    ds_read_b128 a[144:147], v29 offset:1024
    ds_read_b128 a[148:151], v29 offset:2048
    ds_read_b64_tr_b16 a[132:133], v26 offset:4096
    v_mfma_f32_32x32x16_bf16 v[96:111], a[112:115], a[80:83], v[96:111]
    v_exp_f32 v188, v188
    v_exp_f32 v189, v189
    v_add_f32 v56, v56, v186
    ds_read_b64_tr_b16 a[134:135], v27 offset:4096
    ds_read_b128 a[152:155], v29 offset:3072
    ds_read_b128 a[156:159], v29 offset:4096
    v_mfma_f32_32x32x16_bf16 v[96:111], a[116:119], a[84:87], v[96:111]
    v_add_f32 v56, v56, v187
    v_cvt_pk_bf16_f32 v165, v186, v187
    v_exp_f32 v190, v190
    v_exp_f32 v191, v191
    ds_read_b128 a[160:163], v29 offset:5120
    ds_read_b64_tr_b16 a[136:137], v26 offset:8192
    ds_read_b64_tr_b16 a[138:139], v27 offset:8192
    v_mfma_f32_32x32x16_bf16 v[96:111], a[120:123], a[88:91], v[96:111]
    v_add_f32 v56, v56, v188
    v_add_f32 v56, v56, v189
    v_cvt_pk_bf16_f32 v166, v188, v189
    v_add_f32 v56, v56, v190
    v_add_f32 v56, v56, v191
    ds_read_b128 a[164:167], v29 offset:6144
    ds_read_b128 a[168:171], v29 offset:7168
    ds_read_b128 a[172:175], v29 offset:8192
    v_mfma_f32_32x32x16_bf16 v[96:111], a[124:127], a[92:95], v[96:111]
    v_cvt_pk_bf16_f32 v167, v190, v191
    s_waitcnt lgkmcnt(10)
    v_mfma_f32_32x32x16_bf16 v[112:127], a[128:131], a[140:143], v[112:127]
    v_cmp_lt_f32 vcc, s37, v56
    s_nop 0
    s_mov_b64 s[72:73], vcc
    v_fma_f32 v192, v80, s36, -v51
    v_fma_f32 v193, v81, s36, -v51
    v_fma_f32 v194, v82, s36, -v51
    v_fma_f32 v195, v83, s36, -v51
    v_mfma_f32_32x32x16_bf16 v[128:143], a[128:131], a[144:147], v[128:143]
    v_exp_f32 v192, v192
    v_exp_f32 v193, v193
    v_fma_f32 v196, v84, s36, -v51
    v_fma_f32 v197, v85, s36, -v51
    v_mfma_f32_32x32x16_bf16 v[144:159], a[128:131], a[148:151], v[144:159]
    v_exp_f32 v194, v194
    v_exp_f32 v195, v195
    v_add_f32 v57, v192, v193
    v_cvt_pk_bf16_f32 v168, v192, v193
    s_waitcnt lgkmcnt(5)
    v_mfma_f32_32x32x16_bf16 v[112:127], a[132:135], a[152:155], v[112:127]
    ds_read_b64_tr_b16 a[128:129], v26 offset:12288
    ds_read_b64_tr_b16 a[130:131], v27 offset:12288
    v_fma_f32 v198, v86, s36, -v51
    v_fma_f32 v199, v87, s36, -v51
    v_exp_f32 v196, v196
    v_exp_f32 v197, v197
    v_mfma_f32_32x32x16_bf16 v[128:143], a[132:135], a[156:159], v[128:143]
    ds_read_b128 a[140:143], v29 offset:9216
    ds_read_b128 a[144:147], v29 offset:10240
    v_add_f32 v57, v57, v194
    v_add_f32 v57, v57, v195
    v_cvt_pk_bf16_f32 v169, v194, v195
    v_fma_f32 v192, v88, s36, -v51
    v_fma_f32 v193, v89, s36, -v51
    v_exp_f32 v198, v198
    v_mfma_f32_32x32x16_bf16 v[144:159], a[132:135], a[160:163], v[144:159]
    ds_read_b128 a[148:151], v29 offset:11264
    v_exp_f32 v199, v199
    v_add_f32 v57, v57, v196
    v_add_f32 v57, v57, v197
    v_cvt_pk_bf16_f32 v170, v196, v197
    v_fma_f32 v194, v90, s36, -v51
    s_waitcnt lgkmcnt(5)
    v_mfma_f32_32x32x16_bf16 v[112:127], a[136:139], a[164:167], v[112:127]
    ds_read_b64_tr_b16 a[132:133], v26 offset:16384
    ds_read_b64_tr_b16 a[134:135], v27 offset:16384
    v_fma_f32 v195, v91, s36, -v51
    v_exp_f32 v192, v192
    v_exp_f32 v193, v193
    v_add_f32 v57, v57, v198
    v_mfma_f32_32x32x16_bf16 v[128:143], a[136:139], a[168:171], v[128:143]
    ds_read_b128 a[152:155], v29 offset:12288
    ds_read_b128 a[156:159], v29 offset:13312
    v_add_f32 v57, v57, v199
    v_cvt_pk_bf16_f32 v171, v198, v199
    v_fma_f32 v196, v92, s36, -v51
    v_fma_f32 v197, v93, s36, -v51
    v_exp_f32 v194, v194
    v_mfma_f32_32x32x16_bf16 v[144:159], a[136:139], a[172:175], v[144:159]
    ds_read_b128 a[160:163], v29 offset:14336
    v_exp_f32 v195, v195
    v_add_f32 v57, v57, v192
    v_add_f32 v57, v57, v193
    v_cvt_pk_bf16_f32 v172, v192, v193
    v_fma_f32 v198, v94, s36, -v51
    s_waitcnt lgkmcnt(5)
    v_mfma_f32_32x32x16_bf16 v[112:127], a[128:131], a[140:143], v[112:127]
    ds_read_b64_tr_b16 a[136:137], v26 offset:20480
    ds_read_b64_tr_b16 a[138:139], v27 offset:20480
    v_fma_f32 v199, v95, s36, -v51
    v_exp_f32 v196, v196
    v_exp_f32 v197, v197
    v_add_f32 v57, v57, v194
    v_mfma_f32_32x32x16_bf16 v[128:143], a[128:131], a[144:147], v[128:143]
    ds_read_b128 a[164:167], v29 offset:15360
    ds_read_b128 a[168:171], v29 offset:16384
    v_add_f32 v57, v57, v195
    v_cvt_pk_bf16_f32 v173, v194, v195
    v_exp_f32 v198, v198
    v_exp_f32 v199, v199
    v_mfma_f32_32x32x16_bf16 v[144:159], a[128:131], a[148:151], v[144:159]
    ds_read_b128 a[172:175], v29 offset:17408
    v_add_f32 v57, v57, v196
    v_add_f32 v57, v57, v197
    v_cvt_pk_bf16_f32 v174, v196, v197
    v_add_f32 v57, v57, v198
    v_add_f32 v57, v57, v199
    v_cvt_pk_bf16_f32 v175, v198, v199
    s_waitcnt lgkmcnt(5)
    v_mfma_f32_32x32x16_bf16 v[112:127], a[132:135], a[152:155], v[112:127]
    ds_read_b64_tr_b16 a[128:129], v26 offset:24576
    ds_read_b64_tr_b16 a[130:131], v27 offset:24576
    v_cmp_lt_f32 vcc, s37, v57
    s_nop 0
    s_or_b64 s[72:73], s[72:73], vcc
    v_fma_f32 v184, v96, s36, -v52
    v_fma_f32 v185, v97, s36, -v52
    v_fma_f32 v186, v98, s36, -v52
    v_fma_f32 v187, v99, s36, -v52
    v_mfma_f32_32x32x16_bf16 v[128:143], a[132:135], a[156:159], v[128:143]
    ds_read_b128 a[140:143], v29 offset:18432
    ds_read_b128 a[144:147], v29 offset:19456
    v_exp_f32 v184, v184
    v_exp_f32 v185, v185
    v_fma_f32 v188, v100, s36, -v52
    v_fma_f32 v189, v101, s36, -v52
    v_mfma_f32_32x32x16_bf16 v[144:159], a[132:135], a[160:163], v[144:159]
    ds_read_b128 a[148:151], v29 offset:20480
    v_exp_f32 v186, v186
    v_exp_f32 v187, v187
    v_add_f32 v58, v184, v185
    v_cvt_pk_bf16_f32 v176, v184, v185
    s_waitcnt lgkmcnt(5)
    v_mfma_f32_32x32x16_bf16 v[112:127], a[136:139], a[164:167], v[112:127]
    ds_read_b64_tr_b16 a[132:133], v26 offset:28672
    ds_read_b64_tr_b16 a[134:135], v27 offset:28672
    v_fma_f32 v190, v102, s36, -v52
    v_fma_f32 v191, v103, s36, -v52
    v_exp_f32 v188, v188
    v_exp_f32 v189, v189
    v_mfma_f32_32x32x16_bf16 v[128:143], a[136:139], a[168:171], v[128:143]
    ds_read_b128 a[152:155], v29 offset:21504
    ds_read_b128 a[156:159], v29 offset:22528
    v_add_f32 v58, v58, v186
    v_add_f32 v58, v58, v187
    v_cvt_pk_bf16_f32 v177, v186, v187
    v_fma_f32 v184, v104, s36, -v52
    v_fma_f32 v185, v105, s36, -v52
    v_exp_f32 v190, v190
    v_mfma_f32_32x32x16_bf16 v[144:159], a[136:139], a[172:175], v[144:159]
    ds_read_b128 a[160:163], v29 offset:23552
    v_exp_f32 v191, v191
    v_add_f32 v58, v58, v188
    v_add_f32 v58, v58, v189
    v_cvt_pk_bf16_f32 v178, v188, v189
    v_fma_f32 v186, v106, s36, -v52
    s_waitcnt lgkmcnt(5)
    v_mfma_f32_32x32x16_bf16 v[112:127], a[128:131], a[140:143], v[112:127]
    v_fma_f32 v187, v107, s36, -v52
    v_exp_f32 v184, v184
    v_exp_f32 v185, v185
    v_add_f32 v58, v58, v190
    v_mfma_f32_32x32x16_bf16 v[128:143], a[128:131], a[144:147], v[128:143]
    v_add_f32 v58, v58, v191
    v_cvt_pk_bf16_f32 v179, v190, v191
    v_fma_f32 v188, v108, s36, -v52
    v_fma_f32 v189, v109, s36, -v52
    v_exp_f32 v186, v186
    v_mfma_f32_32x32x16_bf16 v[144:159], a[128:131], a[148:151], v[144:159]
    v_exp_f32 v187, v187
    v_add_f32 v58, v58, v184
    v_add_f32 v58, v58, v185
    v_cvt_pk_bf16_f32 v180, v184, v185
    v_fma_f32 v190, v110, s36, -v52
    s_waitcnt lgkmcnt(0)
    v_mfma_f32_32x32x16_bf16 v[112:127], a[132:135], a[152:155], v[112:127]
    v_fma_f32 v191, v111, s36, -v52
    v_exp_f32 v188, v188
    v_exp_f32 v189, v189
    v_add_f32 v58, v58, v186
    v_mfma_f32_32x32x16_bf16 v[128:143], a[132:135], a[156:159], v[128:143]
    v_add_f32 v58, v58, v187
    v_cvt_pk_bf16_f32 v181, v186, v187
    v_exp_f32 v190, v190
    v_exp_f32 v191, v191
    v_mfma_f32_32x32x16_bf16 v[144:159], a[132:135], a[160:163], v[144:159]
    v_add_f32 v58, v58, v188
    v_add_f32 v58, v58, v189
    v_cvt_pk_bf16_f32 v182, v188, v189
    v_add_f32 v58, v58, v190
    v_add_f32 v58, v58, v191
    v_cvt_pk_bf16_f32 v183, v190, v191
    v_cmp_lt_f32 vcc, s37, v58
    s_nop 0
    s_or_b64 s[72:73], s[72:73], vcc
    s_cmp_eq_u64 s[72:73], 0
    s_cbranch_scc1 Lnf_51
    v_mov_b32 v59, 1
    ds_write_b32 v6, v59
Lnf_51:
    s_waitcnt lgkmcnt(0)
    s_barrier
    ds_read_b32 v59, v6
    s_mov_b32 s71, s76
    s_add_u32 s76, s76, 32768
    s_cmp_ge_u32 s76, 98304
    s_cselect_b32 s76, 0, s76
    s_waitcnt vmcnt(8)
    v_add_u32 v16, s71, v8
    v_add_u32 v17, s71, v9
    v_add_u32 v18, s71, v10
    v_add_u32 v19, s71, v11
    v_add_u32 v20, s71, v12
    v_add_u32 v21, s71, v13
    v_add_u32 v22, s71, v14
    v_add_u32 v23, s71, v15
    ds_read_b128 a[96:99], v16
    ds_read_b128 a[100:103], v17
    ds_read_b128 a[104:107], v18
    ds_read_b128 a[108:111], v19
    ds_read_b128 a[112:115], v20
    ds_read_b128 a[116:119], v21
    ds_read_b128 a[120:123], v22
    ds_read_b128 a[124:127], v23
    s_add_u32 m0, s29, s35
    s_add_u32 s33, s74, 4096
    buffer_load_dwordx4 v2, s[12:15], s74 offen offset:0 nt lds
    ds_write_b128 v28, v[160:163] offset:0
    ds_write_b128 v28, v[164:167] offset:3072
    ds_write_b128 v28, v[168:171] offset:1024
    ds_write_b128 v28, v[172:175] offset:4096
    ds_write_b128 v28, v[176:179] offset:2048
    ds_write_b128 v28, v[180:183] offset:5120
    buffer_load_dwordx4 v3, s[12:15], s74 offen offset:1024 nt lds
    buffer_load_dwordx4 v4, s[12:15], s74 offen offset:2048 nt lds
    buffer_load_dwordx4 v5, s[12:15], s74 offen offset:3072 nt lds
    s_waitcnt lgkmcnt(14)
    v_readfirstlane_b32 s31, v59
    s_nop 0
    s_cmp_lg_u32 s31, 0
    s_cbranch_scc1 Lslow_53
Lpost_52:
    v_add_f32 v53, v53, v56
    v_add_f32 v54, v54, v57
    v_add_f32 v55, v55, v58
    s_waitcnt lgkmcnt(13)
    v_mfma_f32_32x32x16_bf16 v[64:79], a[96:99], a[0:3], 0
    s_add_u32 m0, m0, 4096
    s_add_u32 s74, s74, 32768
    buffer_load_dwordx4 v2, s[12:15], s33 offen offset:0 nt lds
    s_waitcnt lgkmcnt(12)
    v_mfma_f32_32x32x16_bf16 v[64:79], a[100:103], a[4:7], v[64:79]
    buffer_load_dwordx4 v3, s[12:15], s33 offen offset:1024 nt lds
    s_waitcnt lgkmcnt(11)
    v_mfma_f32_32x32x16_bf16 v[64:79], a[104:107], a[8:11], v[64:79]
    buffer_load_dwordx4 v4, s[12:15], s33 offen offset:2048 nt lds
    s_waitcnt lgkmcnt(10)
    v_mfma_f32_32x32x16_bf16 v[64:79], a[108:111], a[12:15], v[64:79]
    buffer_load_dwordx4 v5, s[12:15], s33 offen offset:3072 nt lds
    s_waitcnt lgkmcnt(9)
    v_mfma_f32_32x32x16_bf16 v[64:79], a[112:115], a[16:19], v[64:79]
    s_waitcnt lgkmcnt(8)
    v_mfma_f32_32x32x16_bf16 v[64:79], a[116:119], a[20:23], v[64:79]
    s_waitcnt lgkmcnt(7)
    v_mfma_f32_32x32x16_bf16 v[64:79], a[120:123], a[24:27], v[64:79]
    s_waitcnt lgkmcnt(6)
    v_mfma_f32_32x32x16_bf16 v[64:79], a[124:127], a[28:31], v[64:79]
    v_mfma_f32_32x32x16_bf16 v[80:95], a[96:99], a[32:35], 0
    s_add_u32 m0, s71, s35
    s_add_u32 s33, s75, 4096
    buffer_load_dwordx4 v2, s[16:19], s75 offen offset:0 nt lds
    v_mfma_f32_32x32x16_bf16 v[80:95], a[100:103], a[36:39], v[80:95]
    buffer_load_dwordx4 v3, s[16:19], s75 offen offset:1024 nt lds
    s_waitcnt lgkmcnt(0)
    v_mfma_f32_32x32x16_bf16 v[80:95], a[104:107], a[40:43], v[80:95]
    s_nop 3
    v_fma_f32 v184, v64, s36, -v50
    v_fma_f32 v185, v65, s36, -v50
    v_fma_f32 v186, v66, s36, -v50
    v_fma_f32 v187, v67, s36, -v50
    v_exp_f32 v184, v184
    buffer_load_dwordx4 v4, s[16:19], s75 offen offset:2048 nt lds
    v_mfma_f32_32x32x16_bf16 v[80:95], a[108:111], a[44:47], v[80:95]
    v_exp_f32 v185, v185
    v_fma_f32 v188, v68, s36, -v50
    v_fma_f32 v189, v69, s36, -v50
    v_exp_f32 v186, v186
    buffer_load_dwordx4 v5, s[16:19], s75 offen offset:3072 nt lds
    v_mfma_f32_32x32x16_bf16 v[80:95], a[112:115], a[48:51], v[80:95]
    v_exp_f32 v187, v187
    v_add_f32 v56, v184, v185
    v_cvt_pk_bf16_f32 v160, v184, v185
    v_fma_f32 v190, v70, s36, -v50
    s_add_u32 m0, m0, 4096
    s_add_u32 s75, s75, 32768
    buffer_load_dwordx4 v2, s[16:19], s33 offen offset:0 nt lds
    v_mfma_f32_32x32x16_bf16 v[80:95], a[116:119], a[52:55], v[80:95]
    v_fma_f32 v191, v71, s36, -v50
    v_exp_f32 v188, v188
    v_exp_f32 v189, v189
    buffer_load_dwordx4 v3, s[16:19], s33 offen offset:1024 nt lds
    v_mfma_f32_32x32x16_bf16 v[80:95], a[120:123], a[56:59], v[80:95]
    v_add_f32 v56, v56, v186
    v_add_f32 v56, v56, v187
    v_cvt_pk_bf16_f32 v161, v186, v187
    v_fma_f32 v184, v72, s36, -v50
    v_fma_f32 v185, v73, s36, -v50
    buffer_load_dwordx4 v4, s[16:19], s33 offen offset:2048 nt lds
    v_mfma_f32_32x32x16_bf16 v[80:95], a[124:127], a[60:63], v[80:95]
    v_exp_f32 v190, v190
    v_exp_f32 v191, v191
    v_add_f32 v56, v56, v188
    buffer_load_dwordx4 v5, s[16:19], s33 offen offset:3072 nt lds
    v_mfma_f32_32x32x16_bf16 v[96:111], a[96:99], a[64:67], 0
    v_add_f32 v56, v56, v189
    v_cvt_pk_bf16_f32 v162, v188, v189
    v_fma_f32 v186, v74, s36, -v50
    v_fma_f32 v187, v75, s36, -v50
    v_exp_f32 v184, v184
    v_mfma_f32_32x32x16_bf16 v[96:111], a[100:103], a[68:71], v[96:111]
    v_exp_f32 v185, v185
    v_add_f32 v56, v56, v190
    v_add_f32 v56, v56, v191
    v_cvt_pk_bf16_f32 v163, v190, v191
    s_waitcnt vmcnt(16)
    s_waitcnt vmcnt(63)
    s_waitcnt lgkmcnt(0)
    s_barrier
Ltg_54:
    v_readfirstlane_b32 s96, v45
    s_nop 0
    s_cmp_lg_u32 s96, 0
    s_cbranch_scc1 Ltd_55
    s_sleep 8
    global_load_dword v45, v7, s[62:63] sc1
    s_waitcnt vmcnt(0)
    s_branch Ltg_54
Ltd_55:
    s_cmp_lg_u32 s3, 0
    s_cbranch_scc1 Lsig_56
    s_lshl_b32 s78, s99, 3
    s_add_u32 s78, s78, s30
    s_lshl_b32 s78, s78, 3
    s_add_u32 s78, s78, s38
    s_add_u32 s78, s78, 0
    s_and_b32 s79, s39, 3
    s_lshl_b32 s78, s78, 8
    s_add_u32 s78, s78, 50331648
    s_lshl_b32 s79, s79, 2
    s_add_u32 s78, s78, s79
    v_mov_b32 v60, s78
    v_mov_b32 v61, s96
    s_mov_b64 exec, 1
    global_store_dword v60, v61, s[64:65] sc1
    s_mov_b64 exec, -1
Lsig_56:
    s_mov_b32 s29, s76
    s_add_u32 s76, s76, 32768
    s_cmp_ge_u32 s76, 98304
    s_cselect_b32 s76, 0, s76
    v_add_u32 v26, s29, v24
    v_add_u32 v27, s29, v25
    v_mfma_f32_32x32x16_bf16 v[96:111], a[104:107], a[72:75], v[96:111]
    v_fma_f32 v188, v76, s36, -v50
    v_fma_f32 v189, v77, s36, -v50
    v_exp_f32 v186, v186
    v_exp_f32 v187, v187
    ds_read_b64_tr_b16 a[128:129], v26 offset:0
    ds_read_b64_tr_b16 a[130:131], v27 offset:0
    ds_read_b128 a[140:143], v29 offset:0
    v_mfma_f32_32x32x16_bf16 v[96:111], a[108:111], a[76:79], v[96:111]
    v_add_f32 v56, v56, v184
    v_add_f32 v56, v56, v185
    v_cvt_pk_bf16_f32 v164, v184, v185
    v_fma_f32 v190, v78, s36, -v50
    v_fma_f32 v191, v79, s36, -v50
    ds_read_b128 a[144:147], v29 offset:1024
    ds_read_b128 a[148:151], v29 offset:2048
    ds_read_b64_tr_b16 a[132:133], v26 offset:4096
    v_mfma_f32_32x32x16_bf16 v[96:111], a[112:115], a[80:83], v[96:111]
    v_exp_f32 v188, v188
    v_exp_f32 v189, v189
    v_add_f32 v56, v56, v186
    ds_read_b64_tr_b16 a[134:135], v27 offset:4096
    ds_read_b128 a[152:155], v29 offset:3072
    ds_read_b128 a[156:159], v29 offset:4096
    v_mfma_f32_32x32x16_bf16 v[96:111], a[116:119], a[84:87], v[96:111]
    v_add_f32 v56, v56, v187
    v_cvt_pk_bf16_f32 v165, v186, v187
    v_exp_f32 v190, v190
    v_exp_f32 v191, v191
    ds_read_b128 a[160:163], v29 offset:5120
    ds_read_b64_tr_b16 a[136:137], v26 offset:8192
    ds_read_b64_tr_b16 a[138:139], v27 offset:8192
    v_mfma_f32_32x32x16_bf16 v[96:111], a[120:123], a[88:91], v[96:111]
    v_add_f32 v56, v56, v188
    v_add_f32 v56, v56, v189
    v_cvt_pk_bf16_f32 v166, v188, v189
    v_add_f32 v56, v56, v190
    v_add_f32 v56, v56, v191
    ds_read_b128 a[164:167], v29 offset:6144
    ds_read_b128 a[168:171], v29 offset:7168
    ds_read_b128 a[172:175], v29 offset:8192
    v_mfma_f32_32x32x16_bf16 v[96:111], a[124:127], a[92:95], v[96:111]
    v_cvt_pk_bf16_f32 v167, v190, v191
    s_mov_b32 s28, 0
Lloop_69:
    s_waitcnt lgkmcnt(10)
    v_mfma_f32_32x32x16_bf16 v[112:127], a[128:131], a[140:143], v[112:127]
    v_cmp_lt_f32 vcc, s37, v56
    s_nop 0
    s_mov_b64 s[72:73], vcc
    v_fma_f32 v192, v80, s36, -v51
    v_fma_f32 v193, v81, s36, -v51
    v_fma_f32 v194, v82, s36, -v51
    v_fma_f32 v195, v83, s36, -v51
    v_mfma_f32_32x32x16_bf16 v[128:143], a[128:131], a[144:147], v[128:143]
    v_exp_f32 v192, v192
    v_exp_f32 v193, v193
    v_fma_f32 v196, v84, s36, -v51
    v_fma_f32 v197, v85, s36, -v51
    v_mfma_f32_32x32x16_bf16 v[144:159], a[128:131], a[148:151], v[144:159]
    v_exp_f32 v194, v194
    v_exp_f32 v195, v195
    v_add_f32 v57, v192, v193
    v_cvt_pk_bf16_f32 v168, v192, v193
    s_waitcnt lgkmcnt(5)
    v_mfma_f32_32x32x16_bf16 v[112:127], a[132:135], a[152:155], v[112:127]
    ds_read_b64_tr_b16 a[128:129], v26 offset:12288
    ds_read_b64_tr_b16 a[130:131], v27 offset:12288
    v_fma_f32 v198, v86, s36, -v51
    v_fma_f32 v199, v87, s36, -v51
    v_exp_f32 v196, v196
    v_exp_f32 v197, v197
    v_mfma_f32_32x32x16_bf16 v[128:143], a[132:135], a[156:159], v[128:143]
    ds_read_b128 a[140:143], v29 offset:9216
    ds_read_b128 a[144:147], v29 offset:10240
    v_add_f32 v57, v57, v194
    v_add_f32 v57, v57, v195
    v_cvt_pk_bf16_f32 v169, v194, v195
    v_fma_f32 v192, v88, s36, -v51
    v_fma_f32 v193, v89, s36, -v51
    v_exp_f32 v198, v198
    v_mfma_f32_32x32x16_bf16 v[144:159], a[132:135], a[160:163], v[144:159]
    ds_read_b128 a[148:151], v29 offset:11264
    v_exp_f32 v199, v199
    v_add_f32 v57, v57, v196
    v_add_f32 v57, v57, v197
    v_cvt_pk_bf16_f32 v170, v196, v197
    v_fma_f32 v194, v90, s36, -v51
    s_waitcnt lgkmcnt(5)
    v_mfma_f32_32x32x16_bf16 v[112:127], a[136:139], a[164:167], v[112:127]
    ds_read_b64_tr_b16 a[132:133], v26 offset:16384
    ds_read_b64_tr_b16 a[134:135], v27 offset:16384
    v_fma_f32 v195, v91, s36, -v51
    v_exp_f32 v192, v192
    v_exp_f32 v193, v193
    v_add_f32 v57, v57, v198
    v_mfma_f32_32x32x16_bf16 v[128:143], a[136:139], a[168:171], v[128:143]
    ds_read_b128 a[152:155], v29 offset:12288
    ds_read_b128 a[156:159], v29 offset:13312
    v_add_f32 v57, v57, v199
    v_cvt_pk_bf16_f32 v171, v198, v199
    v_fma_f32 v196, v92, s36, -v51
    v_fma_f32 v197, v93, s36, -v51
    v_exp_f32 v194, v194
    v_mfma_f32_32x32x16_bf16 v[144:159], a[136:139], a[172:175], v[144:159]
    ds_read_b128 a[160:163], v29 offset:14336
    v_exp_f32 v195, v195
    v_add_f32 v57, v57, v192
    v_add_f32 v57, v57, v193
    v_cvt_pk_bf16_f32 v172, v192, v193
    v_fma_f32 v198, v94, s36, -v51
    s_waitcnt lgkmcnt(5)
    v_mfma_f32_32x32x16_bf16 v[112:127], a[128:131], a[140:143], v[112:127]
    ds_read_b64_tr_b16 a[136:137], v26 offset:20480
    ds_read_b64_tr_b16 a[138:139], v27 offset:20480
    v_fma_f32 v199, v95, s36, -v51
    v_exp_f32 v196, v196
    v_exp_f32 v197, v197
    v_add_f32 v57, v57, v194
    v_mfma_f32_32x32x16_bf16 v[128:143], a[128:131], a[144:147], v[128:143]
    ds_read_b128 a[164:167], v29 offset:15360
    ds_read_b128 a[168:171], v29 offset:16384
    v_add_f32 v57, v57, v195
    v_cvt_pk_bf16_f32 v173, v194, v195
    v_exp_f32 v198, v198
    v_exp_f32 v199, v199
    v_mfma_f32_32x32x16_bf16 v[144:159], a[128:131], a[148:151], v[144:159]
    ds_read_b128 a[172:175], v29 offset:17408
    v_add_f32 v57, v57, v196
    v_add_f32 v57, v57, v197
    v_cvt_pk_bf16_f32 v174, v196, v197
    v_add_f32 v57, v57, v198
    v_add_f32 v57, v57, v199
    v_cvt_pk_bf16_f32 v175, v198, v199
    s_waitcnt lgkmcnt(5)
    v_mfma_f32_32x32x16_bf16 v[112:127], a[132:135], a[152:155], v[112:127]
    ds_read_b64_tr_b16 a[128:129], v26 offset:24576
    ds_read_b64_tr_b16 a[130:131], v27 offset:24576
    v_cmp_lt_f32 vcc, s37, v57
    s_nop 0
    s_or_b64 s[72:73], s[72:73], vcc
    v_fma_f32 v184, v96, s36, -v52
    v_fma_f32 v185, v97, s36, -v52
    v_fma_f32 v186, v98, s36, -v52
    v_fma_f32 v187, v99, s36, -v52
    v_mfma_f32_32x32x16_bf16 v[128:143], a[132:135], a[156:159], v[128:143]
    ds_read_b128 a[140:143], v29 offset:18432
    ds_read_b128 a[144:147], v29 offset:19456
    v_exp_f32 v184, v184
    v_exp_f32 v185, v185
    v_fma_f32 v188, v100, s36, -v52
    v_fma_f32 v189, v101, s36, -v52
    v_mfma_f32_32x32x16_bf16 v[144:159], a[132:135], a[160:163], v[144:159]
    ds_read_b128 a[148:151], v29 offset:20480
    v_exp_f32 v186, v186
    v_exp_f32 v187, v187
    v_add_f32 v58, v184, v185
    v_cvt_pk_bf16_f32 v176, v184, v185
    s_waitcnt lgkmcnt(5)
    v_mfma_f32_32x32x16_bf16 v[112:127], a[136:139], a[164:167], v[112:127]
    ds_read_b64_tr_b16 a[132:133], v26 offset:28672
    ds_read_b64_tr_b16 a[134:135], v27 offset:28672
    v_fma_f32 v190, v102, s36, -v52
    v_fma_f32 v191, v103, s36, -v52
    v_exp_f32 v188, v188
    v_exp_f32 v189, v189
    v_mfma_f32_32x32x16_bf16 v[128:143], a[136:139], a[168:171], v[128:143]
    ds_read_b128 a[152:155], v29 offset:21504
    ds_read_b128 a[156:159], v29 offset:22528
    v_add_f32 v58, v58, v186
    v_add_f32 v58, v58, v187
    v_cvt_pk_bf16_f32 v177, v186, v187
    v_fma_f32 v184, v104, s36, -v52
    v_fma_f32 v185, v105, s36, -v52
    v_exp_f32 v190, v190
    v_mfma_f32_32x32x16_bf16 v[144:159], a[136:139], a[172:175], v[144:159]
    ds_read_b128 a[160:163], v29 offset:23552
    v_exp_f32 v191, v191
    v_add_f32 v58, v58, v188
    v_add_f32 v58, v58, v189
    v_cvt_pk_bf16_f32 v178, v188, v189
    v_fma_f32 v186, v106, s36, -v52
    s_waitcnt lgkmcnt(5)
    v_mfma_f32_32x32x16_bf16 v[112:127], a[128:131], a[140:143], v[112:127]
    v_fma_f32 v187, v107, s36, -v52
    v_exp_f32 v184, v184
    v_exp_f32 v185, v185
    v_add_f32 v58, v58, v190
    v_mfma_f32_32x32x16_bf16 v[128:143], a[128:131], a[144:147], v[128:143]
    v_add_f32 v58, v58, v191
    v_cvt_pk_bf16_f32 v179, v190, v191
    v_fma_f32 v188, v108, s36, -v52
    v_fma_f32 v189, v109, s36, -v52
    v_exp_f32 v186, v186
    v_mfma_f32_32x32x16_bf16 v[144:159], a[128:131], a[148:151], v[144:159]
    v_exp_f32 v187, v187
    v_add_f32 v58, v58, v184
    v_add_f32 v58, v58, v185
    v_cvt_pk_bf16_f32 v180, v184, v185
    v_fma_f32 v190, v110, s36, -v52
    s_waitcnt lgkmcnt(0)
    v_mfma_f32_32x32x16_bf16 v[112:127], a[132:135], a[152:155], v[112:127]
    v_fma_f32 v191, v111, s36, -v52
    v_exp_f32 v188, v188
    v_exp_f32 v189, v189
    v_add_f32 v58, v58, v186
    v_mfma_f32_32x32x16_bf16 v[128:143], a[132:135], a[156:159], v[128:143]
    v_add_f32 v58, v58, v187
    v_cvt_pk_bf16_f32 v181, v186, v187
    v_exp_f32 v190, v190
    v_exp_f32 v191, v191
    v_mfma_f32_32x32x16_bf16 v[144:159], a[132:135], a[160:163], v[144:159]
    v_add_f32 v58, v58, v188
    v_add_f32 v58, v58, v189
    v_cvt_pk_bf16_f32 v182, v188, v189
    v_add_f32 v58, v58, v190
    v_add_f32 v58, v58, v191
    v_cvt_pk_bf16_f32 v183, v190, v191
    v_cmp_lt_f32 vcc, s37, v58
    s_nop 0
    s_or_b64 s[72:73], s[72:73], vcc
    s_cmp_eq_u64 s[72:73], 0
    s_cbranch_scc1 Lnf_70
    v_mov_b32 v59, 1
    ds_write_b32 v6, v59
Lnf_70:
    s_waitcnt lgkmcnt(0)
    s_barrier
    ds_read_b32 v59, v6
    s_mov_b32 s71, s76
    s_add_u32 s76, s76, 32768
    s_cmp_ge_u32 s76, 98304
    s_cselect_b32 s76, 0, s76
    s_waitcnt vmcnt(8)
    v_add_u32 v16, s71, v8
    v_add_u32 v17, s71, v9
    v_add_u32 v18, s71, v10
    v_add_u32 v19, s71, v11
    v_add_u32 v20, s71, v12
    v_add_u32 v21, s71, v13
    v_add_u32 v22, s71, v14
    v_add_u32 v23, s71, v15
    ds_read_b128 a[96:99], v16
    ds_read_b128 a[100:103], v17
    ds_read_b128 a[104:107], v18
    ds_read_b128 a[108:111], v19
    ds_read_b128 a[112:115], v20
    ds_read_b128 a[116:119], v21
    ds_read_b128 a[120:123], v22
    ds_read_b128 a[124:127], v23
    s_add_u32 m0, s29, s35
    s_add_u32 s33, s74, 4096
    buffer_load_dwordx4 v2, s[12:15], s74 offen offset:0 nt lds
    ds_write_b128 v28, v[160:163] offset:0
    ds_write_b128 v28, v[164:167] offset:3072
    ds_write_b128 v28, v[168:171] offset:1024
    ds_write_b128 v28, v[172:175] offset:4096
    ds_write_b128 v28, v[176:179] offset:2048
    ds_write_b128 v28, v[180:183] offset:5120
    buffer_load_dwordx4 v3, s[12:15], s74 offen offset:1024 nt lds
    buffer_load_dwordx4 v4, s[12:15], s74 offen offset:2048 nt lds
    buffer_load_dwordx4 v5, s[12:15], s74 offen offset:3072 nt lds
    s_waitcnt lgkmcnt(14)
    v_readfirstlane_b32 s31, v59
    s_nop 0
    s_cmp_lg_u32 s31, 0
    s_cbranch_scc1 Lslow_72
Lpost_71:
    v_add_f32 v53, v53, v56
    v_add_f32 v54, v54, v57
    v_add_f32 v55, v55, v58
    s_waitcnt lgkmcnt(13)
    v_mfma_f32_32x32x16_bf16 v[64:79], a[96:99], a[0:3], 0
    s_add_u32 m0, m0, 4096
    s_add_u32 s74, s74, 32768
    buffer_load_dwordx4 v2, s[12:15], s33 offen offset:0 nt lds
    s_waitcnt lgkmcnt(12)
    v_mfma_f32_32x32x16_bf16 v[64:79], a[100:103], a[4:7], v[64:79]
    buffer_load_dwordx4 v3, s[12:15], s33 offen offset:1024 nt lds
    s_waitcnt lgkmcnt(11)
    v_mfma_f32_32x32x16_bf16 v[64:79], a[104:107], a[8:11], v[64:79]
    buffer_load_dwordx4 v4, s[12:15], s33 offen offset:2048 nt lds
    s_waitcnt lgkmcnt(10)
    v_mfma_f32_32x32x16_bf16 v[64:79], a[108:111], a[12:15], v[64:79]
    buffer_load_dwordx4 v5, s[12:15], s33 offen offset:3072 nt lds
    s_waitcnt lgkmcnt(9)
    v_mfma_f32_32x32x16_bf16 v[64:79], a[112:115], a[16:19], v[64:79]
    s_waitcnt lgkmcnt(8)
    v_mfma_f32_32x32x16_bf16 v[64:79], a[116:119], a[20:23], v[64:79]
    s_waitcnt lgkmcnt(7)
    v_mfma_f32_32x32x16_bf16 v[64:79], a[120:123], a[24:27], v[64:79]
    s_waitcnt lgkmcnt(6)
    v_mfma_f32_32x32x16_bf16 v[64:79], a[124:127], a[28:31], v[64:79]
    v_mfma_f32_32x32x16_bf16 v[80:95], a[96:99], a[32:35], 0
    s_add_u32 m0, s71, s35
    s_add_u32 s33, s75, 4096
    buffer_load_dwordx4 v2, s[16:19], s75 offen offset:0 nt lds
    v_mfma_f32_32x32x16_bf16 v[80:95], a[100:103], a[36:39], v[80:95]
    buffer_load_dwordx4 v3, s[16:19], s75 offen offset:1024 nt lds
    s_waitcnt lgkmcnt(0)
    v_mfma_f32_32x32x16_bf16 v[80:95], a[104:107], a[40:43], v[80:95]
    s_nop 3
    v_fma_f32 v184, v64, s36, -v50
    v_fma_f32 v185, v65, s36, -v50
    v_fma_f32 v186, v66, s36, -v50
    v_fma_f32 v187, v67, s36, -v50
    v_exp_f32 v184, v184
    buffer_load_dwordx4 v4, s[16:19], s75 offen offset:2048 nt lds
    v_mfma_f32_32x32x16_bf16 v[80:95], a[108:111], a[44:47], v[80:95]
    v_exp_f32 v185, v185
    v_fma_f32 v188, v68, s36, -v50
    v_fma_f32 v189, v69, s36, -v50
    v_exp_f32 v186, v186
    buffer_load_dwordx4 v5, s[16:19], s75 offen offset:3072 nt lds
    v_mfma_f32_32x32x16_bf16 v[80:95], a[112:115], a[48:51], v[80:95]
    v_exp_f32 v187, v187
    v_add_f32 v56, v184, v185
    v_cvt_pk_bf16_f32 v160, v184, v185
    v_fma_f32 v190, v70, s36, -v50
    s_add_u32 m0, m0, 4096
    s_add_u32 s75, s75, 32768
    buffer_load_dwordx4 v2, s[16:19], s33 offen offset:0 nt lds
    v_mfma_f32_32x32x16_bf16 v[80:95], a[116:119], a[52:55], v[80:95]
    v_fma_f32 v191, v71, s36, -v50
    v_exp_f32 v188, v188
    v_exp_f32 v189, v189
    buffer_load_dwordx4 v3, s[16:19], s33 offen offset:1024 nt lds
    v_mfma_f32_32x32x16_bf16 v[80:95], a[120:123], a[56:59], v[80:95]
    v_add_f32 v56, v56, v186
    v_add_f32 v56, v56, v187
    v_cvt_pk_bf16_f32 v161, v186, v187
    v_fma_f32 v184, v72, s36, -v50
    v_fma_f32 v185, v73, s36, -v50
    buffer_load_dwordx4 v4, s[16:19], s33 offen offset:2048 nt lds
    v_mfma_f32_32x32x16_bf16 v[80:95], a[124:127], a[60:63], v[80:95]
    v_exp_f32 v190, v190
    v_exp_f32 v191, v191
    v_add_f32 v56, v56, v188
    buffer_load_dwordx4 v5, s[16:19], s33 offen offset:3072 nt lds
    v_mfma_f32_32x32x16_bf16 v[96:111], a[96:99], a[64:67], 0
    v_add_f32 v56, v56, v189
    v_cvt_pk_bf16_f32 v162, v188, v189
    v_fma_f32 v186, v74, s36, -v50
    v_fma_f32 v187, v75, s36, -v50
    v_exp_f32 v184, v184
    v_mfma_f32_32x32x16_bf16 v[96:111], a[100:103], a[68:71], v[96:111]
    v_exp_f32 v185, v185
    v_add_f32 v56, v56, v190
    v_add_f32 v56, v56, v191
    v_cvt_pk_bf16_f32 v163, v190, v191
    s_waitcnt vmcnt(16)
    s_waitcnt lgkmcnt(0)
    s_barrier
    s_mov_b32 s29, s76
    s_add_u32 s76, s76, 32768
    s_cmp_ge_u32 s76, 98304
    s_cselect_b32 s76, 0, s76
    v_add_u32 v26, s29, v24
    v_add_u32 v27, s29, v25
    v_mfma_f32_32x32x16_bf16 v[96:111], a[104:107], a[72:75], v[96:111]
    v_fma_f32 v188, v76, s36, -v50
    v_fma_f32 v189, v77, s36, -v50
    v_exp_f32 v186, v186
    v_exp_f32 v187, v187
    ds_read_b64_tr_b16 a[128:129], v26 offset:0
    ds_read_b64_tr_b16 a[130:131], v27 offset:0
    ds_read_b128 a[140:143], v29 offset:0
    v_mfma_f32_32x32x16_bf16 v[96:111], a[108:111], a[76:79], v[96:111]
    v_add_f32 v56, v56, v184
    v_add_f32 v56, v56, v185
    v_cvt_pk_bf16_f32 v164, v184, v185
    v_fma_f32 v190, v78, s36, -v50
    v_fma_f32 v191, v79, s36, -v50
    ds_read_b128 a[144:147], v29 offset:1024
    ds_read_b128 a[148:151], v29 offset:2048
    ds_read_b64_tr_b16 a[132:133], v26 offset:4096
    v_mfma_f32_32x32x16_bf16 v[96:111], a[112:115], a[80:83], v[96:111]
    v_exp_f32 v188, v188
    v_exp_f32 v189, v189
    v_add_f32 v56, v56, v186
    ds_read_b64_tr_b16 a[134:135], v27 offset:4096
    ds_read_b128 a[152:155], v29 offset:3072
    ds_read_b128 a[156:159], v29 offset:4096
    v_mfma_f32_32x32x16_bf16 v[96:111], a[116:119], a[84:87], v[96:111]
    v_add_f32 v56, v56, v187
    v_cvt_pk_bf16_f32 v165, v186, v187
    v_exp_f32 v190, v190
    v_exp_f32 v191, v191
    ds_read_b128 a[160:163], v29 offset:5120
    ds_read_b64_tr_b16 a[136:137], v26 offset:8192
    ds_read_b64_tr_b16 a[138:139], v27 offset:8192
    v_mfma_f32_32x32x16_bf16 v[96:111], a[120:123], a[88:91], v[96:111]
    v_add_f32 v56, v56, v188
    v_add_f32 v56, v56, v189
    v_cvt_pk_bf16_f32 v166, v188, v189
    v_add_f32 v56, v56, v190
    v_add_f32 v56, v56, v191
    ds_read_b128 a[164:167], v29 offset:6144
    ds_read_b128 a[168:171], v29 offset:7168
    ds_read_b128 a[172:175], v29 offset:8192
    v_mfma_f32_32x32x16_bf16 v[96:111], a[124:127], a[92:95], v[96:111]
    v_cvt_pk_bf16_f32 v167, v190, v191
    s_add_u32 s28, s28, 1
    s_cmp_lt_u32 s28, 2
    s_cbranch_scc1 Lloop_69
    v_lshrrev_b32 v248, 4, v1
    v_mul_u32_u24 v248, 768, v248
    v_add_u32 v30, v2, v248
    v_add_u32 v31, v3, v248
    v_add_u32 v31, 3072, v31
    v_add_u32 v32, v4, v248
    v_add_u32 v32, 6144, v32
    v_add_u32 v33, v5, v248
    v_add_u32 v33, 9216, v33
    s_mov_b32 s12, s48
    s_mov_b32 s13, s49
    s_mov_b32 s14, 0x400000
    s_waitcnt lgkmcnt(10)
    v_mfma_f32_32x32x16_bf16 v[112:127], a[128:131], a[140:143], v[112:127]
    v_cmp_lt_f32 vcc, s37, v56
    s_nop 0
    s_mov_b64 s[72:73], vcc
    v_fma_f32 v192, v80, s36, -v51
    v_fma_f32 v193, v81, s36, -v51
    v_fma_f32 v194, v82, s36, -v51
    v_fma_f32 v195, v83, s36, -v51
    v_mfma_f32_32x32x16_bf16 v[128:143], a[128:131], a[144:147], v[128:143]
    v_exp_f32 v192, v192
    v_exp_f32 v193, v193
    v_fma_f32 v196, v84, s36, -v51
    v_fma_f32 v197, v85, s36, -v51
    v_mfma_f32_32x32x16_bf16 v[144:159], a[128:131], a[148:151], v[144:159]
    v_exp_f32 v194, v194
    v_exp_f32 v195, v195
    v_add_f32 v57, v192, v193
    v_cvt_pk_bf16_f32 v168, v192, v193
    s_waitcnt lgkmcnt(5)
    v_mfma_f32_32x32x16_bf16 v[112:127], a[132:135], a[152:155], v[112:127]
    ds_read_b64_tr_b16 a[128:129], v26 offset:12288
    ds_read_b64_tr_b16 a[130:131], v27 offset:12288
    v_fma_f32 v198, v86, s36, -v51
    v_fma_f32 v199, v87, s36, -v51
    v_exp_f32 v196, v196
    v_exp_f32 v197, v197
    v_mfma_f32_32x32x16_bf16 v[128:143], a[132:135], a[156:159], v[128:143]
    ds_read_b128 a[140:143], v29 offset:9216
    ds_read_b128 a[144:147], v29 offset:10240
    v_add_f32 v57, v57, v194
    v_add_f32 v57, v57, v195
    v_cvt_pk_bf16_f32 v169, v194, v195
    v_fma_f32 v192, v88, s36, -v51
    v_fma_f32 v193, v89, s36, -v51
    v_exp_f32 v198, v198
    v_mfma_f32_32x32x16_bf16 v[144:159], a[132:135], a[160:163], v[144:159]
    ds_read_b128 a[148:151], v29 offset:11264
    v_exp_f32 v199, v199
    v_add_f32 v57, v57, v196
    v_add_f32 v57, v57, v197
    v_cvt_pk_bf16_f32 v170, v196, v197
    v_fma_f32 v194, v90, s36, -v51
    s_waitcnt lgkmcnt(5)
    v_mfma_f32_32x32x16_bf16 v[112:127], a[136:139], a[164:167], v[112:127]
    ds_read_b64_tr_b16 a[132:133], v26 offset:16384
    ds_read_b64_tr_b16 a[134:135], v27 offset:16384
    v_fma_f32 v195, v91, s36, -v51
    v_exp_f32 v192, v192
    v_exp_f32 v193, v193
    v_add_f32 v57, v57, v198
    v_mfma_f32_32x32x16_bf16 v[128:143], a[136:139], a[168:171], v[128:143]
    ds_read_b128 a[152:155], v29 offset:12288
    ds_read_b128 a[156:159], v29 offset:13312
    v_add_f32 v57, v57, v199
    v_cvt_pk_bf16_f32 v171, v198, v199
    v_fma_f32 v196, v92, s36, -v51
    v_fma_f32 v197, v93, s36, -v51
    v_exp_f32 v194, v194
    v_mfma_f32_32x32x16_bf16 v[144:159], a[136:139], a[172:175], v[144:159]
    ds_read_b128 a[160:163], v29 offset:14336
    v_exp_f32 v195, v195
    v_add_f32 v57, v57, v192
    v_add_f32 v57, v57, v193
    v_cvt_pk_bf16_f32 v172, v192, v193
    v_fma_f32 v198, v94, s36, -v51
    s_waitcnt lgkmcnt(5)
    v_mfma_f32_32x32x16_bf16 v[112:127], a[128:131], a[140:143], v[112:127]
    ds_read_b64_tr_b16 a[136:137], v26 offset:20480
    ds_read_b64_tr_b16 a[138:139], v27 offset:20480
    v_fma_f32 v199, v95, s36, -v51
    v_exp_f32 v196, v196
    v_exp_f32 v197, v197
    v_add_f32 v57, v57, v194
    v_mfma_f32_32x32x16_bf16 v[128:143], a[128:131], a[144:147], v[128:143]
    ds_read_b128 a[164:167], v29 offset:15360
    ds_read_b128 a[168:171], v29 offset:16384
    v_add_f32 v57, v57, v195
    v_cvt_pk_bf16_f32 v173, v194, v195
    v_exp_f32 v198, v198
    v_exp_f32 v199, v199
    v_mfma_f32_32x32x16_bf16 v[144:159], a[128:131], a[148:151], v[144:159]
    ds_read_b128 a[172:175], v29 offset:17408
    v_add_f32 v57, v57, v196
    v_add_f32 v57, v57, v197
    v_cvt_pk_bf16_f32 v174, v196, v197
    v_add_f32 v57, v57, v198
    v_add_f32 v57, v57, v199
    v_cvt_pk_bf16_f32 v175, v198, v199
    s_waitcnt lgkmcnt(5)
    v_mfma_f32_32x32x16_bf16 v[112:127], a[132:135], a[152:155], v[112:127]
    ds_read_b64_tr_b16 a[128:129], v26 offset:24576
    ds_read_b64_tr_b16 a[130:131], v27 offset:24576
    v_cmp_lt_f32 vcc, s37, v57
    s_nop 0
    s_or_b64 s[72:73], s[72:73], vcc
    v_fma_f32 v184, v96, s36, -v52
    v_fma_f32 v185, v97, s36, -v52
    v_fma_f32 v186, v98, s36, -v52
    v_fma_f32 v187, v99, s36, -v52
    v_mfma_f32_32x32x16_bf16 v[128:143], a[132:135], a[156:159], v[128:143]
    ds_read_b128 a[140:143], v29 offset:18432
    ds_read_b128 a[144:147], v29 offset:19456
    v_exp_f32 v184, v184
    v_exp_f32 v185, v185
    v_fma_f32 v188, v100, s36, -v52
    v_fma_f32 v189, v101, s36, -v52
    v_mfma_f32_32x32x16_bf16 v[144:159], a[132:135], a[160:163], v[144:159]
    ds_read_b128 a[148:151], v29 offset:20480
    v_exp_f32 v186, v186
    v_exp_f32 v187, v187
    v_add_f32 v58, v184, v185
    v_cvt_pk_bf16_f32 v176, v184, v185
    s_waitcnt lgkmcnt(5)
    v_mfma_f32_32x32x16_bf16 v[112:127], a[136:139], a[164:167], v[112:127]
    ds_read_b64_tr_b16 a[132:133], v26 offset:28672
    ds_read_b64_tr_b16 a[134:135], v27 offset:28672
    v_fma_f32 v190, v102, s36, -v52
    v_fma_f32 v191, v103, s36, -v52
    v_exp_f32 v188, v188
    v_exp_f32 v189, v189
    v_mfma_f32_32x32x16_bf16 v[128:143], a[136:139], a[168:171], v[128:143]
    ds_read_b128 a[152:155], v29 offset:21504
    ds_read_b128 a[156:159], v29 offset:22528
    v_add_f32 v58, v58, v186
    v_add_f32 v58, v58, v187
    v_cvt_pk_bf16_f32 v177, v186, v187
    v_fma_f32 v184, v104, s36, -v52
    v_fma_f32 v185, v105, s36, -v52
    v_exp_f32 v190, v190
    v_mfma_f32_32x32x16_bf16 v[144:159], a[136:139], a[172:175], v[144:159]
    ds_read_b128 a[160:163], v29 offset:23552
    v_exp_f32 v191, v191
    v_add_f32 v58, v58, v188
    v_add_f32 v58, v58, v189
    v_cvt_pk_bf16_f32 v178, v188, v189
    v_fma_f32 v186, v106, s36, -v52
    s_waitcnt lgkmcnt(5)
    v_mfma_f32_32x32x16_bf16 v[112:127], a[128:131], a[140:143], v[112:127]
    v_fma_f32 v187, v107, s36, -v52
    v_exp_f32 v184, v184
    v_exp_f32 v185, v185
    v_add_f32 v58, v58, v190
    v_mfma_f32_32x32x16_bf16 v[128:143], a[128:131], a[144:147], v[128:143]
    v_add_f32 v58, v58, v191
    v_cvt_pk_bf16_f32 v179, v190, v191
    v_fma_f32 v188, v108, s36, -v52
    v_fma_f32 v189, v109, s36, -v52
    v_exp_f32 v186, v186
    v_mfma_f32_32x32x16_bf16 v[144:159], a[128:131], a[148:151], v[144:159]
    v_exp_f32 v187, v187
    v_add_f32 v58, v58, v184
    v_add_f32 v58, v58, v185
    v_cvt_pk_bf16_f32 v180, v184, v185
    v_fma_f32 v190, v110, s36, -v52
    s_waitcnt lgkmcnt(0)
    v_mfma_f32_32x32x16_bf16 v[112:127], a[132:135], a[152:155], v[112:127]
    v_fma_f32 v191, v111, s36, -v52
    v_exp_f32 v188, v188
    v_exp_f32 v189, v189
    v_add_f32 v58, v58, v186
    v_mfma_f32_32x32x16_bf16 v[128:143], a[132:135], a[156:159], v[128:143]
    v_add_f32 v58, v58, v187
    v_cvt_pk_bf16_f32 v181, v186, v187
    v_exp_f32 v190, v190
    v_exp_f32 v191, v191
    v_mfma_f32_32x32x16_bf16 v[144:159], a[132:135], a[160:163], v[144:159]
    v_add_f32 v58, v58, v188
    v_add_f32 v58, v58, v189
    v_cvt_pk_bf16_f32 v182, v188, v189
    v_add_f32 v58, v58, v190
    v_add_f32 v58, v58, v191
    v_cvt_pk_bf16_f32 v183, v190, v191
    v_cmp_lt_f32 vcc, s37, v58
    s_nop 0
    s_or_b64 s[72:73], s[72:73], vcc
    s_cmp_eq_u64 s[72:73], 0
    s_cbranch_scc1 Lnf_73
    v_mov_b32 v59, 1
    ds_write_b32 v6, v59
Lnf_73:
    s_waitcnt lgkmcnt(0)
    s_barrier
    ds_read_b32 v59, v6
    s_mov_b32 s71, s76
    s_add_u32 s76, s76, 32768
    s_cmp_ge_u32 s76, 98304
    s_cselect_b32 s76, 0, s76
    s_waitcnt vmcnt(8)
    v_add_u32 v16, s71, v8
    v_add_u32 v17, s71, v9
    v_add_u32 v18, s71, v10
    v_add_u32 v19, s71, v11
    v_add_u32 v20, s71, v12
    v_add_u32 v21, s71, v13
    v_add_u32 v22, s71, v14
    v_add_u32 v23, s71, v15
    ds_read_b128 a[96:99], v16
    ds_read_b128 a[100:103], v17
    ds_read_b128 a[104:107], v18
    ds_read_b128 a[108:111], v19
    ds_read_b128 a[112:115], v20
    ds_read_b128 a[116:119], v21
    ds_read_b128 a[120:123], v22
    ds_read_b128 a[124:127], v23
    s_mov_b32 s92, s29
    s_and_b32 s78, s39, 3
    s_add_u32 s78, s78, 0
    s_and_b32 s78, s78, 3
    s_lshl_b32 s78, s78, 17
    s_add_u32 s74, s95, s78
    s_add_u32 m0, s29, s35
    s_add_u32 s33, s74, 16384
    buffer_load_dwordx4 v30, s[12:15], s74 offen offset:0 nt lds
    ds_write_b128 v28, v[160:163] offset:0
    ds_write_b128 v28, v[164:167] offset:3072
    ds_write_b128 v28, v[168:171] offset:1024
    ds_write_b128 v28, v[172:175] offset:4096
    ds_write_b128 v28, v[176:179] offset:2048
    ds_write_b128 v28, v[180:183] offset:5120
    buffer_load_dwordx4 v31, s[12:15], s74 offen offset:1024 nt lds
    buffer_load_dwordx4 v32, s[12:15], s74 offen offset:2048 nt lds
    buffer_load_dwordx4 v33, s[12:15], s74 offen offset:3072 nt lds
    s_waitcnt lgkmcnt(14)
    v_readfirstlane_b32 s31, v59
    s_nop 0
    s_cmp_lg_u32 s31, 0
    s_cbranch_scc1 Lslow_75
Lpost_74:
    v_add_f32 v53, v53, v56
    v_add_f32 v54, v54, v57
    v_add_f32 v55, v55, v58
    s_waitcnt lgkmcnt(13)
    v_mfma_f32_32x32x16_bf16 v[64:79], a[96:99], a[0:3], 0
    s_add_u32 m0, m0, 4096
    s_add_u32 s74, s74, 131072
    buffer_load_dwordx4 v30, s[12:15], s33 offen offset:0 nt lds
    s_waitcnt lgkmcnt(12)
    v_mfma_f32_32x32x16_bf16 v[64:79], a[100:103], a[4:7], v[64:79]
    buffer_load_dwordx4 v31, s[12:15], s33 offen offset:1024 nt lds
    s_waitcnt lgkmcnt(11)
    v_mfma_f32_32x32x16_bf16 v[64:79], a[104:107], a[8:11], v[64:79]
    buffer_load_dwordx4 v32, s[12:15], s33 offen offset:2048 nt lds
    s_waitcnt lgkmcnt(10)
    v_mfma_f32_32x32x16_bf16 v[64:79], a[108:111], a[12:15], v[64:79]
    buffer_load_dwordx4 v33, s[12:15], s33 offen offset:3072 nt lds
    s_waitcnt lgkmcnt(9)
    v_mfma_f32_32x32x16_bf16 v[64:79], a[112:115], a[16:19], v[64:79]
    s_waitcnt lgkmcnt(8)
    v_mfma_f32_32x32x16_bf16 v[64:79], a[116:119], a[20:23], v[64:79]
    s_waitcnt lgkmcnt(7)
    v_mfma_f32_32x32x16_bf16 v[64:79], a[120:123], a[24:27], v[64:79]
    s_waitcnt lgkmcnt(6)
    v_mfma_f32_32x32x16_bf16 v[64:79], a[124:127], a[28:31], v[64:79]
    v_mfma_f32_32x32x16_bf16 v[80:95], a[96:99], a[32:35], 0
    s_add_u32 m0, s71, s35
    s_add_u32 s33, s75, 4096
    buffer_load_dwordx4 v2, s[16:19], s75 offen offset:0 nt lds
    v_mfma_f32_32x32x16_bf16 v[80:95], a[100:103], a[36:39], v[80:95]
    buffer_load_dwordx4 v3, s[16:19], s75 offen offset:1024 nt lds
    s_waitcnt lgkmcnt(0)
    v_mfma_f32_32x32x16_bf16 v[80:95], a[104:107], a[40:43], v[80:95]
    s_nop 3
    v_fma_f32 v184, v64, s36, -v50
    v_fma_f32 v185, v65, s36, -v50
    v_fma_f32 v186, v66, s36, -v50
    v_fma_f32 v187, v67, s36, -v50
    v_exp_f32 v184, v184
    buffer_load_dwordx4 v4, s[16:19], s75 offen offset:2048 nt lds
    v_mfma_f32_32x32x16_bf16 v[80:95], a[108:111], a[44:47], v[80:95]
    v_exp_f32 v185, v185
    v_fma_f32 v188, v68, s36, -v50
    v_fma_f32 v189, v69, s36, -v50
    v_exp_f32 v186, v186
    buffer_load_dwordx4 v5, s[16:19], s75 offen offset:3072 nt lds
    v_mfma_f32_32x32x16_bf16 v[80:95], a[112:115], a[48:51], v[80:95]
    v_exp_f32 v187, v187
    v_add_f32 v56, v184, v185
    v_cvt_pk_bf16_f32 v160, v184, v185
    v_fma_f32 v190, v70, s36, -v50
    s_add_u32 m0, m0, 4096
    s_add_u32 s75, s75, 32768
    buffer_load_dwordx4 v2, s[16:19], s33 offen offset:0 nt lds
    v_mfma_f32_32x32x16_bf16 v[80:95], a[116:119], a[52:55], v[80:95]
    v_fma_f32 v191, v71, s36, -v50
    v_exp_f32 v188, v188
    v_exp_f32 v189, v189
    buffer_load_dwordx4 v3, s[16:19], s33 offen offset:1024 nt lds
    v_mfma_f32_32x32x16_bf16 v[80:95], a[120:123], a[56:59], v[80:95]
    v_add_f32 v56, v56, v186
    v_add_f32 v56, v56, v187
    v_cvt_pk_bf16_f32 v161, v186, v187
    v_fma_f32 v184, v72, s36, -v50
    v_fma_f32 v185, v73, s36, -v50
    buffer_load_dwordx4 v4, s[16:19], s33 offen offset:2048 nt lds
    v_mfma_f32_32x32x16_bf16 v[80:95], a[124:127], a[60:63], v[80:95]
    v_exp_f32 v190, v190
    v_exp_f32 v191, v191
    v_add_f32 v56, v56, v188
    buffer_load_dwordx4 v5, s[16:19], s33 offen offset:3072 nt lds
    v_mfma_f32_32x32x16_bf16 v[96:111], a[96:99], a[64:67], 0
    v_add_f32 v56, v56, v189
    v_cvt_pk_bf16_f32 v162, v188, v189
    v_fma_f32 v186, v74, s36, -v50
    v_fma_f32 v187, v75, s36, -v50
    v_exp_f32 v184, v184
    v_mfma_f32_32x32x16_bf16 v[96:111], a[100:103], a[68:71], v[96:111]
    v_exp_f32 v185, v185
    v_add_f32 v56, v56, v190
    v_add_f32 v56, v56, v191
    v_cvt_pk_bf16_f32 v163, v190, v191
    s_waitcnt vmcnt(16)
    s_waitcnt lgkmcnt(0)
    s_barrier
    s_mov_b32 s29, s76
    s_add_u32 s76, s76, 32768
    s_cmp_ge_u32 s76, 98304
    s_cselect_b32 s76, 0, s76
    v_add_u32 v26, s29, v24
    v_add_u32 v27, s29, v25
    v_mfma_f32_32x32x16_bf16 v[96:111], a[104:107], a[72:75], v[96:111]
    v_fma_f32 v188, v76, s36, -v50
    v_fma_f32 v189, v77, s36, -v50
    v_exp_f32 v186, v186
    v_exp_f32 v187, v187
    ds_read_b64_tr_b16 a[128:129], v26 offset:0
    ds_read_b64_tr_b16 a[130:131], v27 offset:0
    ds_read_b128 a[140:143], v29 offset:0
    v_mfma_f32_32x32x16_bf16 v[96:111], a[108:111], a[76:79], v[96:111]
    v_add_f32 v56, v56, v184
    v_add_f32 v56, v56, v185
    v_cvt_pk_bf16_f32 v164, v184, v185
    v_fma_f32 v190, v78, s36, -v50
    v_fma_f32 v191, v79, s36, -v50
    ds_read_b128 a[144:147], v29 offset:1024
    ds_read_b128 a[148:151], v29 offset:2048
    ds_read_b64_tr_b16 a[132:133], v26 offset:4096
    v_mfma_f32_32x32x16_bf16 v[96:111], a[112:115], a[80:83], v[96:111]
    v_exp_f32 v188, v188
    v_exp_f32 v189, v189
    v_add_f32 v56, v56, v186
    ds_read_b64_tr_b16 a[134:135], v27 offset:4096
    ds_read_b128 a[152:155], v29 offset:3072
    ds_read_b128 a[156:159], v29 offset:4096
    v_mfma_f32_32x32x16_bf16 v[96:111], a[116:119], a[84:87], v[96:111]
    v_add_f32 v56, v56, v187
    v_cvt_pk_bf16_f32 v165, v186, v187
    v_exp_f32 v190, v190
    v_exp_f32 v191, v191
    ds_read_b128 a[160:163], v29 offset:5120
    ds_read_b64_tr_b16 a[136:137], v26 offset:8192
    ds_read_b64_tr_b16 a[138:139], v27 offset:8192
    v_mfma_f32_32x32x16_bf16 v[96:111], a[120:123], a[88:91], v[96:111]
    v_add_f32 v56, v56, v188
    v_add_f32 v56, v56, v189
    v_cvt_pk_bf16_f32 v166, v188, v189
    v_add_f32 v56, v56, v190
    v_add_f32 v56, v56, v191
    ds_read_b128 a[164:167], v29 offset:6144
    ds_read_b128 a[168:171], v29 offset:7168
    ds_read_b128 a[172:175], v29 offset:8192
    v_mfma_f32_32x32x16_bf16 v[96:111], a[124:127], a[92:95], v[96:111]
    v_cvt_pk_bf16_f32 v167, v190, v191
    s_waitcnt lgkmcnt(10)
    v_mfma_f32_32x32x16_bf16 v[112:127], a[128:131], a[140:143], v[112:127]
    v_cmp_lt_f32 vcc, s37, v56
    s_nop 0
    s_mov_b64 s[72:73], vcc
    v_fma_f32 v192, v80, s36, -v51
    v_fma_f32 v193, v81, s36, -v51
    v_fma_f32 v194, v82, s36, -v51
    v_fma_f32 v195, v83, s36, -v51
    v_mfma_f32_32x32x16_bf16 v[128:143], a[128:131], a[144:147], v[128:143]
    v_exp_f32 v192, v192
    v_exp_f32 v193, v193
    v_fma_f32 v196, v84, s36, -v51
    v_fma_f32 v197, v85, s36, -v51
    v_mfma_f32_32x32x16_bf16 v[144:159], a[128:131], a[148:151], v[144:159]
    v_exp_f32 v194, v194
    v_exp_f32 v195, v195
    v_add_f32 v57, v192, v193
    v_cvt_pk_bf16_f32 v168, v192, v193
    s_waitcnt lgkmcnt(5)
    v_mfma_f32_32x32x16_bf16 v[112:127], a[132:135], a[152:155], v[112:127]
    ds_read_b64_tr_b16 a[128:129], v26 offset:12288
    ds_read_b64_tr_b16 a[130:131], v27 offset:12288
    v_fma_f32 v198, v86, s36, -v51
    v_fma_f32 v199, v87, s36, -v51
    v_exp_f32 v196, v196
    v_exp_f32 v197, v197
    v_mfma_f32_32x32x16_bf16 v[128:143], a[132:135], a[156:159], v[128:143]
    ds_read_b128 a[140:143], v29 offset:9216
    ds_read_b128 a[144:147], v29 offset:10240
    v_add_f32 v57, v57, v194
    v_add_f32 v57, v57, v195
    v_cvt_pk_bf16_f32 v169, v194, v195
    v_fma_f32 v192, v88, s36, -v51
    v_fma_f32 v193, v89, s36, -v51
    v_exp_f32 v198, v198
    v_mfma_f32_32x32x16_bf16 v[144:159], a[132:135], a[160:163], v[144:159]
    ds_read_b128 a[148:151], v29 offset:11264
    v_exp_f32 v199, v199
    v_add_f32 v57, v57, v196
    v_add_f32 v57, v57, v197
    v_cvt_pk_bf16_f32 v170, v196, v197
    v_fma_f32 v194, v90, s36, -v51
    s_waitcnt lgkmcnt(5)
    v_mfma_f32_32x32x16_bf16 v[112:127], a[136:139], a[164:167], v[112:127]
    ds_read_b64_tr_b16 a[132:133], v26 offset:16384
    ds_read_b64_tr_b16 a[134:135], v27 offset:16384
    v_fma_f32 v195, v91, s36, -v51
    v_exp_f32 v192, v192
    v_exp_f32 v193, v193
    v_add_f32 v57, v57, v198
    v_mfma_f32_32x32x16_bf16 v[128:143], a[136:139], a[168:171], v[128:143]
    ds_read_b128 a[152:155], v29 offset:12288
    ds_read_b128 a[156:159], v29 offset:13312
    v_add_f32 v57, v57, v199
    v_cvt_pk_bf16_f32 v171, v198, v199
    v_fma_f32 v196, v92, s36, -v51
    v_fma_f32 v197, v93, s36, -v51
    v_exp_f32 v194, v194
    v_mfma_f32_32x32x16_bf16 v[144:159], a[136:139], a[172:175], v[144:159]
    ds_read_b128 a[160:163], v29 offset:14336
    v_exp_f32 v195, v195
    v_add_f32 v57, v57, v192
    v_add_f32 v57, v57, v193
    v_cvt_pk_bf16_f32 v172, v192, v193
    v_fma_f32 v198, v94, s36, -v51
    s_waitcnt lgkmcnt(5)
    v_mfma_f32_32x32x16_bf16 v[112:127], a[128:131], a[140:143], v[112:127]
    ds_read_b64_tr_b16 a[136:137], v26 offset:20480
    ds_read_b64_tr_b16 a[138:139], v27 offset:20480
    v_fma_f32 v199, v95, s36, -v51
    v_exp_f32 v196, v196
    v_exp_f32 v197, v197
    v_add_f32 v57, v57, v194
    v_mfma_f32_32x32x16_bf16 v[128:143], a[128:131], a[144:147], v[128:143]
    ds_read_b128 a[164:167], v29 offset:15360
    ds_read_b128 a[168:171], v29 offset:16384
    v_add_f32 v57, v57, v195
    v_cvt_pk_bf16_f32 v173, v194, v195
    v_exp_f32 v198, v198
    v_exp_f32 v199, v199
    v_mfma_f32_32x32x16_bf16 v[144:159], a[128:131], a[148:151], v[144:159]
    ds_read_b128 a[172:175], v29 offset:17408
    v_add_f32 v57, v57, v196
    v_add_f32 v57, v57, v197
    v_cvt_pk_bf16_f32 v174, v196, v197
    v_add_f32 v57, v57, v198
    v_add_f32 v57, v57, v199
    v_cvt_pk_bf16_f32 v175, v198, v199
    s_waitcnt lgkmcnt(5)
    v_mfma_f32_32x32x16_bf16 v[112:127], a[132:135], a[152:155], v[112:127]
    ds_read_b64_tr_b16 a[128:129], v26 offset:24576
    ds_read_b64_tr_b16 a[130:131], v27 offset:24576
    v_cmp_lt_f32 vcc, s37, v57
    s_nop 0
    s_or_b64 s[72:73], s[72:73], vcc
    v_fma_f32 v184, v96, s36, -v52
    v_fma_f32 v185, v97, s36, -v52
    v_fma_f32 v186, v98, s36, -v52
    v_fma_f32 v187, v99, s36, -v52
    v_mfma_f32_32x32x16_bf16 v[128:143], a[132:135], a[156:159], v[128:143]
    ds_read_b128 a[140:143], v29 offset:18432
    ds_read_b128 a[144:147], v29 offset:19456
    v_exp_f32 v184, v184
    v_exp_f32 v185, v185
    v_fma_f32 v188, v100, s36, -v52
    v_fma_f32 v189, v101, s36, -v52
    v_mfma_f32_32x32x16_bf16 v[144:159], a[132:135], a[160:163], v[144:159]
    ds_read_b128 a[148:151], v29 offset:20480
    v_exp_f32 v186, v186
    v_exp_f32 v187, v187
    v_add_f32 v58, v184, v185
    v_cvt_pk_bf16_f32 v176, v184, v185
    s_waitcnt lgkmcnt(5)
    v_mfma_f32_32x32x16_bf16 v[112:127], a[136:139], a[164:167], v[112:127]
    ds_read_b64_tr_b16 a[132:133], v26 offset:28672
    ds_read_b64_tr_b16 a[134:135], v27 offset:28672
    v_fma_f32 v190, v102, s36, -v52
    v_fma_f32 v191, v103, s36, -v52
    v_exp_f32 v188, v188
    v_exp_f32 v189, v189
    v_mfma_f32_32x32x16_bf16 v[128:143], a[136:139], a[168:171], v[128:143]
    ds_read_b128 a[152:155], v29 offset:21504
    ds_read_b128 a[156:159], v29 offset:22528
    v_add_f32 v58, v58, v186
    v_add_f32 v58, v58, v187
    v_cvt_pk_bf16_f32 v177, v186, v187
    v_fma_f32 v184, v104, s36, -v52
    v_fma_f32 v185, v105, s36, -v52
    v_exp_f32 v190, v190
    v_mfma_f32_32x32x16_bf16 v[144:159], a[136:139], a[172:175], v[144:159]
    ds_read_b128 a[160:163], v29 offset:23552
    v_exp_f32 v191, v191
    v_add_f32 v58, v58, v188
    v_add_f32 v58, v58, v189
    v_cvt_pk_bf16_f32 v178, v188, v189
    v_fma_f32 v186, v106, s36, -v52
    s_waitcnt lgkmcnt(5)
    v_mfma_f32_32x32x16_bf16 v[112:127], a[128:131], a[140:143], v[112:127]
    v_fma_f32 v187, v107, s36, -v52
    v_exp_f32 v184, v184
    v_exp_f32 v185, v185
    v_add_f32 v58, v58, v190
    v_mfma_f32_32x32x16_bf16 v[128:143], a[128:131], a[144:147], v[128:143]
    v_add_f32 v58, v58, v191
    v_cvt_pk_bf16_f32 v179, v190, v191
    v_fma_f32 v188, v108, s36, -v52
    v_fma_f32 v189, v109, s36, -v52
    v_exp_f32 v186, v186
    v_mfma_f32_32x32x16_bf16 v[144:159], a[128:131], a[148:151], v[144:159]
    v_exp_f32 v187, v187
    v_add_f32 v58, v58, v184
    v_add_f32 v58, v58, v185
    v_cvt_pk_bf16_f32 v180, v184, v185
    v_fma_f32 v190, v110, s36, -v52
    s_waitcnt lgkmcnt(0)
    v_mfma_f32_32x32x16_bf16 v[112:127], a[132:135], a[152:155], v[112:127]
    v_fma_f32 v191, v111, s36, -v52
    v_exp_f32 v188, v188
    v_exp_f32 v189, v189
    v_add_f32 v58, v58, v186
    v_mfma_f32_32x32x16_bf16 v[128:143], a[132:135], a[156:159], v[128:143]
    v_add_f32 v58, v58, v187
    v_cvt_pk_bf16_f32 v181, v186, v187
    v_exp_f32 v190, v190
    v_exp_f32 v191, v191
    v_mfma_f32_32x32x16_bf16 v[144:159], a[132:135], a[160:163], v[144:159]
    v_add_f32 v58, v58, v188
    v_add_f32 v58, v58, v189
    v_cvt_pk_bf16_f32 v182, v188, v189
    v_add_f32 v58, v58, v190
    v_add_f32 v58, v58, v191
    v_cvt_pk_bf16_f32 v183, v190, v191
    v_cmp_lt_f32 vcc, s37, v58
    s_nop 0
    s_or_b64 s[72:73], s[72:73], vcc
    s_cmp_eq_u64 s[72:73], 0
    s_cbranch_scc1 Lnf_76
    v_mov_b32 v59, 1
    ds_write_b32 v6, v59
Lnf_76:
    s_waitcnt lgkmcnt(0)
    s_barrier
    ds_read_b32 v59, v6
    s_mov_b32 s93, s29
    s_and_b32 s78, s39, 3
    s_add_u32 s78, s78, 1
    s_and_b32 s78, s78, 3
    s_lshl_b32 s78, s78, 17
    s_add_u32 s74, s95, s78
    s_add_u32 m0, s29, s35
    s_add_u32 s33, s74, 16384
    buffer_load_dwordx4 v30, s[12:15], s74 offen offset:0 nt lds
    ds_write_b128 v28, v[160:163] offset:0
    ds_write_b128 v28, v[164:167] offset:3072
    ds_write_b128 v28, v[168:171] offset:1024
    ds_write_b128 v28, v[172:175] offset:4096
    ds_write_b128 v28, v[176:179] offset:2048
    ds_write_b128 v28, v[180:183] offset:5120
    buffer_load_dwordx4 v31, s[12:15], s74 offen offset:1024 nt lds
    buffer_load_dwordx4 v32, s[12:15], s74 offen offset:2048 nt lds
    buffer_load_dwordx4 v33, s[12:15], s74 offen offset:3072 nt lds
    s_waitcnt lgkmcnt(6)
    v_readfirstlane_b32 s31, v59
    s_nop 0
    s_cmp_lg_u32 s31, 0
    s_cbranch_scc1 Lslow_78
Lpost_77:
    v_add_f32 v53, v53, v56
    v_add_f32 v54, v54, v57
    v_add_f32 v55, v55, v58
    s_mov_b32 s71, s76
    s_add_u32 s76, s76, 32768
    s_cmp_ge_u32 s76, 98304
    s_cselect_b32 s76, 0, s76
    s_add_u32 m0, m0, 4096
    s_add_u32 s74, s74, 131072
    buffer_load_dwordx4 v30, s[12:15], s33 offen offset:0 nt lds
    buffer_load_dwordx4 v31, s[12:15], s33 offen offset:1024 nt lds
    buffer_load_dwordx4 v32, s[12:15], s33 offen offset:2048 nt lds
    buffer_load_dwordx4 v33, s[12:15], s33 offen offset:3072 nt lds
    s_waitcnt vmcnt(8)
    s_waitcnt vmcnt(0)
    s_waitcnt lgkmcnt(0)
    s_barrier
    s_cmp_lg_u32 s3, 0
    s_cbranch_scc1 Lskip_79
    s_lshl_b32 s78, s99, 3
    s_add_u32 s78, s78, s30
    s_lshl_b32 s78, s78, 3
    s_add_u32 s78, s78, s38
    s_add_u32 s78, s78, 0
    s_and_b32 s79, s39, 3
    s_lshl_b32 s78, s78, 8
    s_add_u32 s78, s78, 50331648
    v_and_b32 v62, 3, v1
    v_lshlrev_b32 v62, 2, v62
    v_add_u32 v62, s78, v62
Lpoll_80:
    global_load_dword v63, v62, s[64:65] sc1
    s_waitcnt vmcnt(0)
    v_cmp_ne_u32 vcc, s96, v63
    s_nop 0
    s_cmp_eq_u64 vcc, 0
    s_cbranch_scc1 Lskip_79
    s_sleep 4
    s_branch Lpoll_80
Lskip_79:
    s_mov_b32 s29, s76
    s_add_u32 s76, s76, 32768
    s_cmp_ge_u32 s76, 98304
    s_cselect_b32 s76, 0, s76
    v_add_u32 v26, s29, v24
    v_add_u32 v27, s29, v25
    ds_read_b64_tr_b16 a[128:129], v26 offset:0
    ds_read_b64_tr_b16 a[130:131], v27 offset:0
    ds_read_b128 a[140:143], v29 offset:0
    ds_read_b128 a[144:147], v29 offset:1024
    ds_read_b128 a[148:151], v29 offset:2048
    ds_read_b64_tr_b16 a[132:133], v26 offset:4096
    ds_read_b64_tr_b16 a[134:135], v27 offset:4096
    ds_read_b128 a[152:155], v29 offset:3072
    ds_read_b128 a[156:159], v29 offset:4096
    ds_read_b128 a[160:163], v29 offset:5120
    ds_read_b64_tr_b16 a[136:137], v26 offset:8192
    ds_read_b64_tr_b16 a[138:139], v27 offset:8192
    ds_read_b128 a[164:167], v29 offset:6144
    ds_read_b128 a[168:171], v29 offset:7168
    ds_read_b128 a[172:175], v29 offset:8192
    s_waitcnt lgkmcnt(10)
    v_mfma_f32_32x32x16_bf16 v[112:127], a[128:131], a[140:143], v[112:127]
    v_add_u32 v248, s92, v24
    v_add_u32 v249, s92, v25
    ds_read_b64_tr_b16 a[0:1], v248 offset:0
    ds_read_b64_tr_b16 a[2:3], v249 offset:0
    ds_read_b64_tr_b16 a[4:5], v248 offset:4096
    ds_read_b64_tr_b16 a[6:7], v249 offset:4096
    v_mfma_f32_32x32x16_bf16 v[128:143], a[128:131], a[144:147], v[128:143]
    ds_read_b64_tr_b16 a[8:9], v248 offset:8192
    ds_read_b64_tr_b16 a[10:11], v249 offset:8192
    ds_read_b64_tr_b16 a[12:13], v248 offset:12288
    ds_read_b64_tr_b16 a[14:15], v249 offset:12288
    ds_read_b64_tr_b16 a[16:17], v248 offset:16384
    ds_read_b64_tr_b16 a[18:19], v249 offset:16384
    v_mfma_f32_32x32x16_bf16 v[144:159], a[128:131], a[148:151], v[144:159]
    ds_read_b64_tr_b16 a[20:21], v248 offset:20480
    ds_read_b64_tr_b16 a[22:23], v249 offset:20480
    ds_read_b64_tr_b16 a[24:25], v248 offset:24576
    ds_read_b64_tr_b16 a[26:27], v249 offset:24576
    ds_read_b64_tr_b16 a[28:29], v248 offset:28672
    ds_read_b64_tr_b16 a[30:31], v249 offset:28672
    s_waitcnt lgkmcnt(15)
    v_mfma_f32_32x32x16_bf16 v[112:127], a[132:135], a[152:155], v[112:127]
    ds_read_b64_tr_b16 a[128:129], v26 offset:12288
    ds_read_b64_tr_b16 a[130:131], v27 offset:12288
    v_add_u32 v248, s93, v24
    v_add_u32 v249, s93, v25
    ds_read_b64_tr_b16 a[32:33], v248 offset:0
    ds_read_b64_tr_b16 a[34:35], v249 offset:0
    ds_read_b64_tr_b16 a[36:37], v248 offset:4096
    ds_read_b64_tr_b16 a[38:39], v249 offset:4096
    v_mfma_f32_32x32x16_bf16 v[128:143], a[132:135], a[156:159], v[128:143]
    ds_read_b128 a[140:143], v29 offset:9216
    ds_read_b128 a[144:147], v29 offset:10240
    ds_read_b64_tr_b16 a[40:41], v248 offset:8192
    ds_read_b64_tr_b16 a[42:43], v249 offset:8192
    ds_read_b64_tr_b16 a[44:45], v248 offset:12288
    ds_read_b64_tr_b16 a[46:47], v249 offset:12288
    ds_read_b64_tr_b16 a[48:49], v248 offset:16384
    ds_read_b64_tr_b16 a[50:51], v249 offset:16384
    v_mfma_f32_32x32x16_bf16 v[144:159], a[132:135], a[160:163], v[144:159]
    ds_read_b128 a[148:151], v29 offset:11264
    ds_read_b64_tr_b16 a[52:53], v248 offset:20480
    ds_read_b64_tr_b16 a[54:55], v249 offset:20480
    ds_read_b64_tr_b16 a[56:57], v248 offset:24576
    ds_read_b64_tr_b16 a[58:59], v249 offset:24576
    ds_read_b64_tr_b16 a[60:61], v248 offset:28672
    ds_read_b64_tr_b16 a[62:63], v249 offset:28672
    s_waitcnt lgkmcnt(15)
    v_mfma_f32_32x32x16_bf16 v[112:127], a[136:139], a[164:167], v[112:127]
    ds_read_b64_tr_b16 a[132:133], v26 offset:16384
    ds_read_b64_tr_b16 a[134:135], v27 offset:16384
    v_mfma_f32_32x32x16_bf16 v[128:143], a[136:139], a[168:171], v[128:143]
    ds_read_b128 a[152:155], v29 offset:12288
    ds_read_b128 a[156:159], v29 offset:13312
    v_mfma_f32_32x32x16_bf16 v[144:159], a[136:139], a[172:175], v[144:159]
    ds_read_b128 a[160:163], v29 offset:14336
    s_waitcnt lgkmcnt(5)
    v_mfma_f32_32x32x16_bf16 v[112:127], a[128:131], a[140:143], v[112:127]
    ds_read_b64_tr_b16 a[136:137], v26 offset:20480
    ds_read_b64_tr_b16 a[138:139], v27 offset:20480
    v_mfma_f32_32x32x16_bf16 v[128:143], a[128:131], a[144:147], v[128:143]
    ds_read_b128 a[164:167], v29 offset:15360
    ds_read_b128 a[168:171], v29 offset:16384
    v_mfma_f32_32x32x16_bf16 v[144:159], a[128:131], a[148:151], v[144:159]
    ds_read_b128 a[172:175], v29 offset:17408
    s_waitcnt lgkmcnt(5)
    v_mfma_f32_32x32x16_bf16 v[112:127], a[132:135], a[152:155], v[112:127]
    ds_read_b64_tr_b16 a[128:129], v26 offset:24576
    ds_read_b64_tr_b16 a[130:131], v27 offset:24576
    v_mfma_f32_32x32x16_bf16 v[128:143], a[132:135], a[156:159], v[128:143]
    ds_read_b128 a[140:143], v29 offset:18432
    ds_read_b128 a[144:147], v29 offset:19456
    v_mfma_f32_32x32x16_bf16 v[144:159], a[132:135], a[160:163], v[144:159]
    ds_read_b128 a[148:151], v29 offset:20480
    s_waitcnt lgkmcnt(5)
    v_mfma_f32_32x32x16_bf16 v[112:127], a[136:139], a[164:167], v[112:127]
    ds_read_b64_tr_b16 a[132:133], v26 offset:28672
    ds_read_b64_tr_b16 a[134:135], v27 offset:28672
    v_mfma_f32_32x32x16_bf16 v[128:143], a[136:139], a[168:171], v[128:143]
    ds_read_b128 a[152:155], v29 offset:21504
    ds_read_b128 a[156:159], v29 offset:22528
    v_mfma_f32_32x32x16_bf16 v[144:159], a[136:139], a[172:175], v[144:159]
    ds_read_b128 a[160:163], v29 offset:23552
    s_waitcnt lgkmcnt(5)
    v_mfma_f32_32x32x16_bf16 v[112:127], a[128:131], a[140:143], v[112:127]
    v_mfma_f32_32x32x16_bf16 v[128:143], a[128:131], a[144:147], v[128:143]
    v_mfma_f32_32x32x16_bf16 v[144:159], a[128:131], a[148:151], v[144:159]
    s_waitcnt lgkmcnt(0)
    v_mfma_f32_32x32x16_bf16 v[112:127], a[132:135], a[152:155], v[112:127]
    v_mfma_f32_32x32x16_bf16 v[128:143], a[132:135], a[156:159], v[128:143]
    v_mfma_f32_32x32x16_bf16 v[144:159], a[132:135], a[160:163], v[144:159]
    v_mov_b32 v252, v53
    v_mov_b32 v253, v54
    v_mov_b32 v254, v55
    s_waitcnt lgkmcnt(0)
    s_barrier
    v_lshlrev_b32 v250, 4, v1
    s_lshl_b32 s66, s99, 3
    s_add_u32 s66, s66, s38
    s_lshl_b32 s66, s66, 5
    s_lshl_b32 s31, s30, 2
    s_add_u32 s66, s66, s31
    s_mul_i32 s66, s66, 24576
    s_mul_i32 s67, s3, 6144
    s_add_u32 s66, s66, s67
    s_mov_b32 s4, s64
    s_mov_b32 s5, s65
    s_mov_b32 s6, 12582912
    s_mov_b32 s94, s29
    s_mov_b32 s101, 98304
    s_and_b32 s78, s39, 3
    s_add_u32 s78, s78, 0
    s_and_b32 s78, s78, 3
    s_mul_i32 s78, s78, 24576
    s_add_u32 s32, s66, s78
    s_add_u32 s32, s32, 0
    s_add_u32 m0, s67, s92
    s_nop 0
    buffer_load_dwordx4 v250, s[4:7], s32 offen offset:0 sc1 lds
    buffer_load_dwordx4 v250, s[4:7], s32 offen offset:1024 sc1 lds
    buffer_load_dwordx4 v250, s[4:7], s32 offen offset:2048 sc1 lds
    buffer_load_dwordx4 v250, s[4:7], s32 offen offset:3072 sc1 lds
    s_add_u32 m0, m0, 4096
    s_add_u32 s32, s32, 4096
    buffer_load_dwordx4 v250, s[4:7], s32 offen offset:0 sc1 lds
    buffer_load_dwordx4 v250, s[4:7], s32 offen offset:1024 sc1 lds
    s_and_b32 s78, s39, 3
    s_add_u32 s78, s78, 1
    s_and_b32 s78, s78, 3
    s_mul_i32 s78, s78, 24576
    s_add_u32 s32, s66, s78
    s_add_u32 s32, s32, 0
    s_add_u32 m0, s67, s93
    s_nop 0
    buffer_load_dwordx4 v250, s[4:7], s32 offen offset:0 sc1 lds
    buffer_load_dwordx4 v250, s[4:7], s32 offen offset:1024 sc1 lds
    buffer_load_dwordx4 v250, s[4:7], s32 offen offset:2048 sc1 lds
    buffer_load_dwordx4 v250, s[4:7], s32 offen offset:3072 sc1 lds
    s_add_u32 m0, m0, 4096
    s_add_u32 s32, s32, 4096
    buffer_load_dwordx4 v250, s[4:7], s32 offen offset:0 sc1 lds
    buffer_load_dwordx4 v250, s[4:7], s32 offen offset:1024 sc1 lds
    ds_write_b32 v48, v252 offset:0
    ds_write_b32 v48, v253 offset:1024
    ds_write_b32 v48, v254 offset:2048
    s_waitcnt lgkmcnt(0)
    s_barrier
    ds_read_b128 v[192:195], v49 offset:0
    ds_read_b128 v[196:199], v49 offset:16
    s_waitcnt lgkmcnt(0)
    v_add_f32 v192, v192, v193
    v_add_f32 v194, v194, v195
    v_add_f32 v196, v196, v197
    v_add_f32 v198, v198, v199
    v_add_f32 v192, v192, v194
    v_add_f32 v196, v196, v198
    v_add_f32 v192, v192, v196
    v_rcp_f32 v252, v192
    ds_read_b128 v[192:195], v49 offset:1024
    ds_read_b128 v[196:199], v49 offset:1040
    s_waitcnt lgkmcnt(0)
    v_add_f32 v192, v192, v193
    v_add_f32 v194, v194, v195
    v_add_f32 v196, v196, v197
    v_add_f32 v198, v198, v199
    v_add_f32 v192, v192, v194
    v_add_f32 v196, v196, v198
    v_add_f32 v192, v192, v196
    v_rcp_f32 v253, v192
    ds_read_b128 v[192:195], v49 offset:2048
    ds_read_b128 v[196:199], v49 offset:2064
    s_waitcnt lgkmcnt(0)
    v_add_f32 v192, v192, v193
    v_add_f32 v194, v194, v195
    v_add_f32 v196, v196, v197
    v_add_f32 v198, v198, v199
    v_add_f32 v192, v192, v194
    v_add_f32 v196, v196, v198
    v_add_f32 v192, v192, v196
    v_rcp_f32 v254, v192
    s_lshl_b32 s97, s99, 3
    s_add_u32 s97, s97, s38
    s_add_u32 s97, s97, 4
    s_lshl_b32 s97, s97, 5
    s_add_u32 s97, s97, s39
    s_mul_i32 s97, s97, 24576
    s_add_u32 s100, s97, 3072
    v_mul_f32 v112, v112, v252
    v_mul_f32 v113, v113, v252
    v_cvt_pk_bf16_f32 v112, v112, v113
    v_mul_f32 v114, v114, v252
    v_mul_f32 v115, v115, v252
    v_cvt_pk_bf16_f32 v113, v114, v115
    v_mul_f32 v116, v116, v252
    v_mul_f32 v117, v117, v252
    v_cvt_pk_bf16_f32 v114, v116, v117
    v_mul_f32 v118, v118, v252
    v_mul_f32 v119, v119, v252
    v_cvt_pk_bf16_f32 v115, v118, v119
    v_mul_f32 v120, v120, v252
    v_mul_f32 v121, v121, v252
    v_cvt_pk_bf16_f32 v116, v120, v121
    v_mul_f32 v122, v122, v252
    v_mul_f32 v123, v123, v252
    v_cvt_pk_bf16_f32 v117, v122, v123
    v_mul_f32 v124, v124, v252
    v_mul_f32 v125, v125, v252
    v_cvt_pk_bf16_f32 v118, v124, v125
    v_mul_f32 v126, v126, v252
    v_mul_f32 v127, v127, v252
    v_cvt_pk_bf16_f32 v119, v126, v127
    buffer_store_dwordx4 v[112:115], v46, s[20:23], s97 offen offset:0 sc1
    buffer_store_dwordx4 v[116:119], v46, s[20:23], s100 offen offset:0 sc1
    v_mul_f32 v128, v128, v253
    v_mul_f32 v129, v129, v253
    v_cvt_pk_bf16_f32 v128, v128, v129
    v_mul_f32 v130, v130, v253
    v_mul_f32 v131, v131, v253
    v_cvt_pk_bf16_f32 v129, v130, v131
    v_mul_f32 v132, v132, v253
    v_mul_f32 v133, v133, v253
    v_cvt_pk_bf16_f32 v130, v132, v133
    v_mul_f32 v134, v134, v253
    v_mul_f32 v135, v135, v253
    v_cvt_pk_bf16_f32 v131, v134, v135
    v_mul_f32 v136, v136, v253
    v_mul_f32 v137, v137, v253
    v_cvt_pk_bf16_f32 v132, v136, v137
    v_mul_f32 v138, v138, v253
    v_mul_f32 v139, v139, v253
    v_cvt_pk_bf16_f32 v133, v138, v139
    v_mul_f32 v140, v140, v253
    v_mul_f32 v141, v141, v253
    v_cvt_pk_bf16_f32 v134, v140, v141
    v_mul_f32 v142, v142, v253
    v_mul_f32 v143, v143, v253
    v_cvt_pk_bf16_f32 v135, v142, v143
    buffer_store_dwordx4 v[128:131], v46, s[20:23], s97 offen offset:1024 sc1
    buffer_store_dwordx4 v[132:135], v46, s[20:23], s100 offen offset:1024 sc1
    v_mul_f32 v144, v144, v254
    v_mul_f32 v145, v145, v254
    v_cvt_pk_bf16_f32 v144, v144, v145
    v_mul_f32 v146, v146, v254
    v_mul_f32 v147, v147, v254
    v_cvt_pk_bf16_f32 v145, v146, v147
    v_mul_f32 v148, v148, v254
    v_mul_f32 v149, v149, v254
    v_cvt_pk_bf16_f32 v146, v148, v149
    v_mul_f32 v150, v150, v254
    v_mul_f32 v151, v151, v254
    v_cvt_pk_bf16_f32 v147, v150, v151
    v_mul_f32 v152, v152, v254
    v_mul_f32 v153, v153, v254
    v_cvt_pk_bf16_f32 v148, v152, v153
    v_mul_f32 v154, v154, v254
    v_mul_f32 v155, v155, v254
    v_cvt_pk_bf16_f32 v149, v154, v155
    v_mul_f32 v156, v156, v254
    v_mul_f32 v157, v157, v254
    v_cvt_pk_bf16_f32 v150, v156, v157
    v_mul_f32 v158, v158, v254
    v_mul_f32 v159, v159, v254
    v_cvt_pk_bf16_f32 v151, v158, v159
    buffer_store_dwordx4 v[144:147], v46, s[20:23], s97 offen offset:2048 sc1
    buffer_store_dwordx4 v[148:151], v46, s[20:23], s100 offen offset:2048 sc1
    s_and_b32 s78, s39, 3
    s_add_u32 s78, s78, 2
    s_and_b32 s78, s78, 3
    s_lshl_b32 s78, s78, 17
    s_add_u32 s74, s95, s78
    s_add_u32 m0, s94, s35
    s_add_u32 s33, s74, 16384
    buffer_load_dwordx4 v30, s[12:15], s74 offen offset:0 nt lds
    buffer_load_dwordx4 v31, s[12:15], s74 offen offset:1024 nt lds
    buffer_load_dwordx4 v32, s[12:15], s74 offen offset:2048 nt lds
    buffer_load_dwordx4 v33, s[12:15], s74 offen offset:3072 nt lds
    s_add_u32 m0, m0, 4096
    s_add_u32 s74, s74, 131072
    buffer_load_dwordx4 v30, s[12:15], s33 offen offset:0 nt lds
    buffer_load_dwordx4 v31, s[12:15], s33 offen offset:1024 nt lds
    buffer_load_dwordx4 v32, s[12:15], s33 offen offset:2048 nt lds
    buffer_load_dwordx4 v33, s[12:15], s33 offen offset:3072 nt lds
    s_waitcnt vmcnt(8)
    s_barrier
    s_cmp_lg_u32 s3, 0
    s_cbranch_scc1 Lsig_81
    s_lshl_b32 s78, s99, 3
    s_add_u32 s78, s78, s30
    s_lshl_b32 s78, s78, 3
    s_add_u32 s78, s78, s38
    s_add_u32 s78, s78, 4
    s_and_b32 s79, s39, 3
    s_lshl_b32 s78, s78, 8
    s_add_u32 s78, s78, 50331648
    s_lshl_b32 s79, s79, 2
    s_add_u32 s78, s78, s79
    v_mov_b32 v60, s78
    v_mov_b32 v61, s96
    s_mov_b64 exec, 1
    global_store_dword v60, v61, s[64:65] sc1
    s_mov_b64 exec, -1
Lsig_81:
    s_lshl_b32 s31, s3, 13
    s_add_u32 s31, s31, 98304
    s_cmp_eq_u32 s3, 3
    s_cselect_b32 s31, 155648, s31
    s_sub_u32 s71, s31, s35
    s_and_b32 s78, s39, 3
    s_add_u32 s78, s78, 3
    s_and_b32 s78, s78, 3
    s_lshl_b32 s78, s78, 17
    s_add_u32 s74, s95, s78
    s_add_u32 m0, s71, s35
    s_add_u32 s33, s74, 16384
    buffer_load_dwordx4 v30, s[12:15], s74 offen offset:0 nt lds
    buffer_load_dwordx4 v31, s[12:15], s74 offen offset:1024 nt lds
    buffer_load_dwordx4 v32, s[12:15], s74 offen offset:2048 nt lds
    buffer_load_dwordx4 v33, s[12:15], s74 offen offset:3072 nt lds
    s_add_u32 m0, m0, 4096
    s_add_u32 s74, s74, 131072
    buffer_load_dwordx4 v30, s[12:15], s33 offen offset:0 nt lds
    buffer_load_dwordx4 v31, s[12:15], s33 offen offset:1024 nt lds
    buffer_load_dwordx4 v32, s[12:15], s33 offen offset:2048 nt lds
    buffer_load_dwordx4 v33, s[12:15], s33 offen offset:3072 nt lds
    s_waitcnt vmcnt(63)
    s_barrier
    v_add_u32 v16, s92, v250
    ds_read_b128 a[128:131], v16 offset:0
    ds_read_b128 a[132:135], v16 offset:1024
    ds_read_b128 a[136:139], v16 offset:2048
    ds_read_b128 a[140:143], v16 offset:3072
    ds_read_b128 a[144:147], v16 offset:4096
    ds_read_b128 a[148:151], v16 offset:5120
    ds_read_b128 a[152:155], v16 offset:6144
    ds_read_b128 a[156:159], v16 offset:7168
    ds_read_b128 a[160:163], v16 offset:8192
    s_waitcnt lgkmcnt(6)
    v_mfma_f32_32x32x16_bf16 v[200:215], a[0:3], a[128:131], 0
    v_mfma_f32_32x32x16_bf16 v[216:231], a[0:3], a[132:135], 0
    v_mfma_f32_32x32x16_bf16 v[232:247], a[0:3], a[136:139], 0
    ds_read_b128 a[164:167], v16 offset:9216
    ds_read_b128 a[168:171], v16 offset:10240
    ds_read_b128 a[172:175], v16 offset:11264
    s_waitcnt lgkmcnt(6)
    v_mfma_f32_32x32x16_bf16 v[200:215], a[4:7], a[140:143], v[200:215]
    v_mfma_f32_32x32x16_bf16 v[216:231], a[4:7], a[144:147], v[216:231]
    v_mfma_f32_32x32x16_bf16 v[232:247], a[4:7], a[148:151], v[232:247]
    ds_read_b128 a[128:131], v16 offset:12288
    ds_read_b128 a[132:135], v16 offset:13312
    ds_read_b128 a[136:139], v16 offset:14336
    s_waitcnt lgkmcnt(6)
    v_mfma_f32_32x32x16_bf16 v[200:215], a[8:11], a[152:155], v[200:215]
    v_mfma_f32_32x32x16_bf16 v[216:231], a[8:11], a[156:159], v[216:231]
    v_mfma_f32_32x32x16_bf16 v[232:247], a[8:11], a[160:163], v[232:247]
    ds_read_b128 a[140:143], v16 offset:15360
    ds_read_b128 a[144:147], v16 offset:16384
    ds_read_b128 a[148:151], v16 offset:17408
    s_waitcnt lgkmcnt(6)
    v_mfma_f32_32x32x16_bf16 v[200:215], a[12:15], a[164:167], v[200:215]
    v_mfma_f32_32x32x16_bf16 v[216:231], a[12:15], a[168:171], v[216:231]
    v_mfma_f32_32x32x16_bf16 v[232:247], a[12:15], a[172:175], v[232:247]
    ds_read_b128 a[152:155], v16 offset:18432
    ds_read_b128 a[156:159], v16 offset:19456
    ds_read_b128 a[160:163], v16 offset:20480
    s_waitcnt lgkmcnt(6)
    v_mfma_f32_32x32x16_bf16 v[200:215], a[16:19], a[128:131], v[200:215]
    v_mfma_f32_32x32x16_bf16 v[216:231], a[16:19], a[132:135], v[216:231]
    v_mfma_f32_32x32x16_bf16 v[232:247], a[16:19], a[136:139], v[232:247]
    ds_read_b128 a[164:167], v16 offset:21504
    ds_read_b128 a[168:171], v16 offset:22528
    ds_read_b128 a[172:175], v16 offset:23552
    s_waitcnt lgkmcnt(6)
    v_mfma_f32_32x32x16_bf16 v[200:215], a[20:23], a[140:143], v[200:215]
    v_mfma_f32_32x32x16_bf16 v[216:231], a[20:23], a[144:147], v[216:231]
    v_mfma_f32_32x32x16_bf16 v[232:247], a[20:23], a[148:151], v[232:247]
    s_waitcnt lgkmcnt(3)
    v_mfma_f32_32x32x16_bf16 v[200:215], a[24:27], a[152:155], v[200:215]
    v_mfma_f32_32x32x16_bf16 v[216:231], a[24:27], a[156:159], v[216:231]
    v_mfma_f32_32x32x16_bf16 v[232:247], a[24:27], a[160:163], v[232:247]
    s_waitcnt lgkmcnt(0)
    v_mfma_f32_32x32x16_bf16 v[200:215], a[28:31], a[164:167], v[200:215]
    v_mfma_f32_32x32x16_bf16 v[216:231], a[28:31], a[168:171], v[216:231]
    v_mfma_f32_32x32x16_bf16 v[232:247], a[28:31], a[172:175], v[232:247]
    v_add_u32 v16, s93, v250
    ds_read_b128 a[128:131], v16 offset:0
    ds_read_b128 a[132:135], v16 offset:1024
    ds_read_b128 a[136:139], v16 offset:2048
    ds_read_b128 a[140:143], v16 offset:3072
    ds_read_b128 a[144:147], v16 offset:4096
    ds_read_b128 a[148:151], v16 offset:5120
    ds_read_b128 a[152:155], v16 offset:6144
    ds_read_b128 a[156:159], v16 offset:7168
    ds_read_b128 a[160:163], v16 offset:8192
    s_waitcnt lgkmcnt(6)
    v_mfma_f32_32x32x16_bf16 v[200:215], a[32:35], a[128:131], v[200:215]
    v_mfma_f32_32x32x16_bf16 v[216:231], a[32:35], a[132:135], v[216:231]
    v_mfma_f32_32x32x16_bf16 v[232:247], a[32:35], a[136:139], v[232:247]
    ds_read_b128 a[164:167], v16 offset:9216
    ds_read_b128 a[168:171], v16 offset:10240
    ds_read_b128 a[172:175], v16 offset:11264
    s_waitcnt lgkmcnt(6)
    v_mfma_f32_32x32x16_bf16 v[200:215], a[36:39], a[140:143], v[200:215]
    v_mfma_f32_32x32x16_bf16 v[216:231], a[36:39], a[144:147], v[216:231]
    v_mfma_f32_32x32x16_bf16 v[232:247], a[36:39], a[148:151], v[232:247]
    ds_read_b128 a[128:131], v16 offset:12288
    ds_read_b128 a[132:135], v16 offset:13312
    ds_read_b128 a[136:139], v16 offset:14336
    s_waitcnt lgkmcnt(6)
    v_mfma_f32_32x32x16_bf16 v[200:215], a[40:43], a[152:155], v[200:215]
    v_mfma_f32_32x32x16_bf16 v[216:231], a[40:43], a[156:159], v[216:231]
    v_mfma_f32_32x32x16_bf16 v[232:247], a[40:43], a[160:163], v[232:247]
    ds_read_b128 a[140:143], v16 offset:15360
    ds_read_b128 a[144:147], v16 offset:16384
    ds_read_b128 a[148:151], v16 offset:17408
    s_waitcnt lgkmcnt(6)
    v_mfma_f32_32x32x16_bf16 v[200:215], a[44:47], a[164:167], v[200:215]
    v_mfma_f32_32x32x16_bf16 v[216:231], a[44:47], a[168:171], v[216:231]
    v_mfma_f32_32x32x16_bf16 v[232:247], a[44:47], a[172:175], v[232:247]
    ds_read_b128 a[152:155], v16 offset:18432
    ds_read_b128 a[156:159], v16 offset:19456
    ds_read_b128 a[160:163], v16 offset:20480
    s_waitcnt lgkmcnt(6)
    v_mfma_f32_32x32x16_bf16 v[200:215], a[48:51], a[128:131], v[200:215]
    v_mfma_f32_32x32x16_bf16 v[216:231], a[48:51], a[132:135], v[216:231]
    v_mfma_f32_32x32x16_bf16 v[232:247], a[48:51], a[136:139], v[232:247]
    ds_read_b128 a[164:167], v16 offset:21504
    ds_read_b128 a[168:171], v16 offset:22528
    ds_read_b128 a[172:175], v16 offset:23552
    s_waitcnt lgkmcnt(6)
    v_mfma_f32_32x32x16_bf16 v[200:215], a[52:55], a[140:143], v[200:215]
    v_mfma_f32_32x32x16_bf16 v[216:231], a[52:55], a[144:147], v[216:231]
    v_mfma_f32_32x32x16_bf16 v[232:247], a[52:55], a[148:151], v[232:247]
    s_waitcnt lgkmcnt(3)
    v_mfma_f32_32x32x16_bf16 v[200:215], a[56:59], a[152:155], v[200:215]
    v_mfma_f32_32x32x16_bf16 v[216:231], a[56:59], a[156:159], v[216:231]
    v_mfma_f32_32x32x16_bf16 v[232:247], a[56:59], a[160:163], v[232:247]
    s_waitcnt lgkmcnt(0)
    v_mfma_f32_32x32x16_bf16 v[200:215], a[60:63], a[164:167], v[200:215]
    v_mfma_f32_32x32x16_bf16 v[216:231], a[60:63], a[168:171], v[216:231]
    v_mfma_f32_32x32x16_bf16 v[232:247], a[60:63], a[172:175], v[232:247]
    s_waitcnt vmcnt(0)
    s_barrier
    v_add_u32 v17, s92, v46
    ds_write_b128 v17, v[112:115] offset:0
    ds_write_b128 v17, v[116:119] offset:3072
    ds_write_b128 v17, v[128:131] offset:1024
    ds_write_b128 v17, v[132:135] offset:4096
    ds_write_b128 v17, v[144:147] offset:2048
    ds_write_b128 v17, v[148:151] offset:5120
    v_add_u32 v248, s94, v24
    v_add_u32 v249, s94, v25
    ds_read_b64_tr_b16 a[64:65], v248 offset:0
    ds_read_b64_tr_b16 a[66:67], v249 offset:0
    ds_read_b64_tr_b16 a[68:69], v248 offset:4096
    ds_read_b64_tr_b16 a[70:71], v249 offset:4096
    ds_read_b64_tr_b16 a[72:73], v248 offset:8192
    ds_read_b64_tr_b16 a[74:75], v249 offset:8192
    ds_read_b64_tr_b16 a[76:77], v248 offset:12288
    ds_read_b64_tr_b16 a[78:79], v249 offset:12288
    ds_read_b64_tr_b16 a[80:81], v248 offset:16384
    ds_read_b64_tr_b16 a[82:83], v249 offset:16384
    ds_read_b64_tr_b16 a[84:85], v248 offset:20480
    ds_read_b64_tr_b16 a[86:87], v249 offset:20480
    ds_read_b64_tr_b16 a[88:89], v248 offset:24576
    ds_read_b64_tr_b16 a[90:91], v249 offset:24576
    ds_read_b64_tr_b16 a[92:93], v248 offset:28672
    ds_read_b64_tr_b16 a[94:95], v249 offset:28672
    v_add_u32 v248, 98304, v24
    v_add_u32 v249, 98304, v25
    ds_read_b64_tr_b16 a[96:97], v248 offset:0
    ds_read_b64_tr_b16 a[98:99], v249 offset:0
    ds_read_b64_tr_b16 a[100:101], v248 offset:4096
    ds_read_b64_tr_b16 a[102:103], v249 offset:4096
    ds_read_b64_tr_b16 a[104:105], v248 offset:8192
    ds_read_b64_tr_b16 a[106:107], v249 offset:8192
    ds_read_b64_tr_b16 a[108:109], v248 offset:12288
    ds_read_b64_tr_b16 a[110:111], v249 offset:12288
    ds_read_b64_tr_b16 a[112:113], v248 offset:16384
    ds_read_b64_tr_b16 a[114:115], v249 offset:16384
    ds_read_b64_tr_b16 a[116:117], v248 offset:20480
    ds_read_b64_tr_b16 a[118:119], v249 offset:20480
    v_add_u32 v248, 131072, v24
    v_add_u32 v249, 131072, v25
    ds_read_b64_tr_b16 a[120:121], v248 offset:24576
    ds_read_b64_tr_b16 a[122:123], v249 offset:24576
    ds_read_b64_tr_b16 a[124:125], v248 offset:28672
    ds_read_b64_tr_b16 a[126:127], v249 offset:28672
    s_cmp_lg_u32 s3, 0
    s_cbranch_scc1 Lskip_82
    s_lshl_b32 s78, s99, 3
    s_add_u32 s78, s78, s30
    s_lshl_b32 s78, s78, 3
    s_add_u32 s78, s78, s38
    s_add_u32 s78, s78, 4
    s_and_b32 s79, s39, 3
    s_lshl_b32 s78, s78, 8
    s_add_u32 s78, s78, 50331648
    v_and_b32 v62, 3, v1
    v_lshlrev_b32 v62, 2, v62
    v_add_u32 v62, s78, v62
Lpoll_83:
    global_load_dword v63, v62, s[64:65] sc1
    s_waitcnt vmcnt(0)
    v_cmp_ne_u32 vcc, s96, v63
    s_nop 0
    s_cmp_eq_u64 vcc, 0
    s_cbranch_scc1 Lskip_82
    s_sleep 4
    s_branch Lpoll_83
Lskip_82:
    s_waitcnt lgkmcnt(0)
    s_barrier
    s_and_b32 s78, s39, 3
    s_add_u32 s78, s78, 2
    s_and_b32 s78, s78, 3
    s_mul_i32 s78, s78, 24576
    s_add_u32 s32, s66, s78
    s_add_u32 s32, s32, 0
    s_add_u32 m0, s67, s94
    s_nop 0
    buffer_load_dwordx4 v250, s[4:7], s32 offen offset:0 sc1 lds
    buffer_load_dwordx4 v250, s[4:7], s32 offen offset:1024 sc1 lds
    buffer_load_dwordx4 v250, s[4:7], s32 offen offset:2048 sc1 lds
    buffer_load_dwordx4 v250, s[4:7], s32 offen offset:3072 sc1 lds
    s_add_u32 m0, m0, 4096
    s_add_u32 s32, s32, 4096
    buffer_load_dwordx4 v250, s[4:7], s32 offen offset:0 sc1 lds
    buffer_load_dwordx4 v250, s[4:7], s32 offen offset:1024 sc1 lds
    s_and_b32 s78, s39, 3
    s_add_u32 s78, s78, 3
    s_and_b32 s78, s78, 3
    s_mul_i32 s78, s78, 24576
    s_add_u32 s32, s66, s78
    s_add_u32 s32, s32, 0
    s_add_u32 m0, s67, s101
    s_nop 0
    buffer_load_dwordx4 v250, s[4:7], s32 offen offset:0 sc1 lds
    buffer_load_dwordx4 v250, s[4:7], s32 offen offset:1024 sc1 lds
    buffer_load_dwordx4 v250, s[4:7], s32 offen offset:2048 sc1 lds
    buffer_load_dwordx4 v250, s[4:7], s32 offen offset:3072 sc1 lds
    s_add_u32 m0, m0, 4096
    s_add_u32 s32, s32, 4096
    buffer_load_dwordx4 v250, s[4:7], s32 offen offset:0 sc1 lds
    buffer_load_dwordx4 v250, s[4:7], s32 offen offset:1024 sc1 lds
    s_and_b32 s78, s39, 3
    s_add_u32 s78, s78, 1
    s_and_b32 s78, s78, 3
    s_mul_i32 s78, s78, 24576
    s_add_u32 s32, s66, s78
    s_add_u32 s32, s32, 3145728
    s_add_u32 m0, s67, s93
    s_nop 0
    buffer_load_dwordx4 v250, s[4:7], s32 offen offset:0 sc1 lds
    buffer_load_dwordx4 v250, s[4:7], s32 offen offset:1024 sc1 lds
    buffer_load_dwordx4 v250, s[4:7], s32 offen offset:2048 sc1 lds
    buffer_load_dwordx4 v250, s[4:7], s32 offen offset:3072 sc1 lds
    s_add_u32 m0, m0, 4096
    s_add_u32 s32, s32, 4096
    buffer_load_dwordx4 v250, s[4:7], s32 offen offset:0 sc1 lds
    buffer_load_dwordx4 v250, s[4:7], s32 offen offset:1024 sc1 lds
    v_add_u32 v16, s92, v250
    ds_read_b128 a[128:131], v16 offset:0
    ds_read_b128 a[132:135], v16 offset:1024
    ds_read_b128 a[136:139], v16 offset:2048
    ds_read_b128 a[140:143], v16 offset:3072
    ds_read_b128 a[144:147], v16 offset:4096
    ds_read_b128 a[148:151], v16 offset:5120
    ds_read_b128 a[152:155], v16 offset:6144
    ds_read_b128 a[156:159], v16 offset:7168
    ds_read_b128 a[160:163], v16 offset:8192
    s_waitcnt lgkmcnt(6)
    v_mfma_f32_32x32x16_bf16 v[64:79], a[0:3], a[128:131], 0
    v_mfma_f32_32x32x16_bf16 v[80:95], a[0:3], a[132:135], 0
    v_mfma_f32_32x32x16_bf16 v[96:111], a[0:3], a[136:139], 0
    ds_read_b128 a[164:167], v16 offset:9216
    ds_read_b128 a[168:171], v16 offset:10240
    ds_read_b128 a[172:175], v16 offset:11264
    s_waitcnt lgkmcnt(6)
    v_mfma_f32_32x32x16_bf16 v[64:79], a[4:7], a[140:143], v[64:79]
    v_mfma_f32_32x32x16_bf16 v[80:95], a[4:7], a[144:147], v[80:95]
    v_mfma_f32_32x32x16_bf16 v[96:111], a[4:7], a[148:151], v[96:111]
    ds_read_b128 a[128:131], v16 offset:12288
    ds_read_b128 a[132:135], v16 offset:13312
    ds_read_b128 a[136:139], v16 offset:14336
    s_waitcnt lgkmcnt(6)
    v_mfma_f32_32x32x16_bf16 v[64:79], a[8:11], a[152:155], v[64:79]
    v_mfma_f32_32x32x16_bf16 v[80:95], a[8:11], a[156:159], v[80:95]
    v_mfma_f32_32x32x16_bf16 v[96:111], a[8:11], a[160:163], v[96:111]
    ds_read_b128 a[140:143], v16 offset:15360
    ds_read_b128 a[144:147], v16 offset:16384
    ds_read_b128 a[148:151], v16 offset:17408
    s_waitcnt lgkmcnt(6)
    v_mfma_f32_32x32x16_bf16 v[64:79], a[12:15], a[164:167], v[64:79]
    v_mfma_f32_32x32x16_bf16 v[80:95], a[12:15], a[168:171], v[80:95]
    v_mfma_f32_32x32x16_bf16 v[96:111], a[12:15], a[172:175], v[96:111]
    ds_read_b128 a[152:155], v16 offset:18432
    ds_read_b128 a[156:159], v16 offset:19456
    ds_read_b128 a[160:163], v16 offset:20480
    s_waitcnt lgkmcnt(6)
    v_mfma_f32_32x32x16_bf16 v[64:79], a[16:19], a[128:131], v[64:79]
    v_mfma_f32_32x32x16_bf16 v[80:95], a[16:19], a[132:135], v[80:95]
    v_mfma_f32_32x32x16_bf16 v[96:111], a[16:19], a[136:139], v[96:111]
    ds_read_b128 a[164:167], v16 offset:21504
    ds_read_b128 a[168:171], v16 offset:22528
    ds_read_b128 a[172:175], v16 offset:23552
    s_waitcnt lgkmcnt(6)
    v_mfma_f32_32x32x16_bf16 v[64:79], a[20:23], a[140:143], v[64:79]
    v_mfma_f32_32x32x16_bf16 v[80:95], a[20:23], a[144:147], v[80:95]
    v_mfma_f32_32x32x16_bf16 v[96:111], a[20:23], a[148:151], v[96:111]
    s_waitcnt lgkmcnt(3)
    v_mfma_f32_32x32x16_bf16 v[64:79], a[24:27], a[152:155], v[64:79]
    v_mfma_f32_32x32x16_bf16 v[80:95], a[24:27], a[156:159], v[80:95]
    v_mfma_f32_32x32x16_bf16 v[96:111], a[24:27], a[160:163], v[96:111]
    s_waitcnt lgkmcnt(0)
    v_mfma_f32_32x32x16_bf16 v[64:79], a[28:31], a[164:167], v[64:79]
    v_mfma_f32_32x32x16_bf16 v[80:95], a[28:31], a[168:171], v[80:95]
    v_mfma_f32_32x32x16_bf16 v[96:111], a[28:31], a[172:175], v[96:111]
    s_waitcnt vmcnt(12)
    s_barrier
    v_add_u32 v16, s94, v250
    ds_read_b128 a[128:131], v16 offset:0
    ds_read_b128 a[132:135], v16 offset:1024
    ds_read_b128 a[136:139], v16 offset:2048
    ds_read_b128 a[140:143], v16 offset:3072
    ds_read_b128 a[144:147], v16 offset:4096
    ds_read_b128 a[148:151], v16 offset:5120
    ds_read_b128 a[152:155], v16 offset:6144
    ds_read_b128 a[156:159], v16 offset:7168
    ds_read_b128 a[160:163], v16 offset:8192
    s_waitcnt lgkmcnt(6)
    v_mfma_f32_32x32x16_bf16 v[200:215], a[64:67], a[128:131], v[200:215]
    v_mfma_f32_32x32x16_bf16 v[216:231], a[64:67], a[132:135], v[216:231]
    v_mfma_f32_32x32x16_bf16 v[232:247], a[64:67], a[136:139], v[232:247]
    ds_read_b128 a[164:167], v16 offset:9216
    ds_read_b128 a[168:171], v16 offset:10240
    ds_read_b128 a[172:175], v16 offset:11264
    s_waitcnt lgkmcnt(6)
    v_mfma_f32_32x32x16_bf16 v[200:215], a[68:71], a[140:143], v[200:215]
    v_mfma_f32_32x32x16_bf16 v[216:231], a[68:71], a[144:147], v[216:231]
    v_mfma_f32_32x32x16_bf16 v[232:247], a[68:71], a[148:151], v[232:247]
    ds_read_b128 a[128:131], v16 offset:12288
    ds_read_b128 a[132:135], v16 offset:13312
    ds_read_b128 a[136:139], v16 offset:14336
    s_waitcnt lgkmcnt(6)
    v_mfma_f32_32x32x16_bf16 v[200:215], a[72:75], a[152:155], v[200:215]
    v_mfma_f32_32x32x16_bf16 v[216:231], a[72:75], a[156:159], v[216:231]
    v_mfma_f32_32x32x16_bf16 v[232:247], a[72:75], a[160:163], v[232:247]
    ds_read_b128 a[140:143], v16 offset:15360
    ds_read_b128 a[144:147], v16 offset:16384
    ds_read_b128 a[148:151], v16 offset:17408
    s_waitcnt lgkmcnt(6)
    v_mfma_f32_32x32x16_bf16 v[200:215], a[76:79], a[164:167], v[200:215]
    v_mfma_f32_32x32x16_bf16 v[216:231], a[76:79], a[168:171], v[216:231]
    v_mfma_f32_32x32x16_bf16 v[232:247], a[76:79], a[172:175], v[232:247]
    ds_read_b128 a[152:155], v16 offset:18432
    ds_read_b128 a[156:159], v16 offset:19456
    ds_read_b128 a[160:163], v16 offset:20480
    s_waitcnt lgkmcnt(6)
    v_mfma_f32_32x32x16_bf16 v[200:215], a[80:83], a[128:131], v[200:215]
    v_mfma_f32_32x32x16_bf16 v[216:231], a[80:83], a[132:135], v[216:231]
    v_mfma_f32_32x32x16_bf16 v[232:247], a[80:83], a[136:139], v[232:247]
    ds_read_b128 a[164:167], v16 offset:21504
    ds_read_b128 a[168:171], v16 offset:22528
    ds_read_b128 a[172:175], v16 offset:23552
    s_waitcnt lgkmcnt(6)
    v_mfma_f32_32x32x16_bf16 v[200:215], a[84:87], a[140:143], v[200:215]
    v_mfma_f32_32x32x16_bf16 v[216:231], a[84:87], a[144:147], v[216:231]
    v_mfma_f32_32x32x16_bf16 v[232:247], a[84:87], a[148:151], v[232:247]
    s_waitcnt lgkmcnt(3)
    v_mfma_f32_32x32x16_bf16 v[200:215], a[88:91], a[152:155], v[200:215]
    v_mfma_f32_32x32x16_bf16 v[216:231], a[88:91], a[156:159], v[216:231]
    v_mfma_f32_32x32x16_bf16 v[232:247], a[88:91], a[160:163], v[232:247]
    s_waitcnt lgkmcnt(0)
    v_mfma_f32_32x32x16_bf16 v[200:215], a[92:95], a[164:167], v[200:215]
    v_mfma_f32_32x32x16_bf16 v[216:231], a[92:95], a[168:171], v[216:231]
    v_mfma_f32_32x32x16_bf16 v[232:247], a[92:95], a[172:175], v[232:247]
    s_waitcnt vmcnt(6)
    s_barrier
    s_and_b32 s78, s39, 3
    s_add_u32 s78, s78, 2
    s_and_b32 s78, s78, 3
    s_mul_i32 s78, s78, 24576
    s_add_u32 s32, s66, s78
    s_add_u32 s32, s32, 3145728
    s_add_u32 m0, s67, s94
    s_nop 0
    buffer_load_dwordx4 v250, s[4:7], s32 offen offset:0 sc1 lds
    buffer_load_dwordx4 v250, s[4:7], s32 offen offset:1024 sc1 lds
    buffer_load_dwordx4 v250, s[4:7], s32 offen offset:2048 sc1 lds
    buffer_load_dwordx4 v250, s[4:7], s32 offen offset:3072 sc1 lds
    s_add_u32 m0, m0, 4096
    s_add_u32 s32, s32, 4096
    buffer_load_dwordx4 v250, s[4:7], s32 offen offset:0 sc1 lds
    buffer_load_dwordx4 v250, s[4:7], s32 offen offset:1024 sc1 lds
    v_add_u32 v16, s101, v250
    ds_read_b128 a[128:131], v16 offset:0
    ds_read_b128 a[132:135], v16 offset:1024
    ds_read_b128 a[136:139], v16 offset:2048
    ds_read_b128 a[140:143], v16 offset:3072
    ds_read_b128 a[144:147], v16 offset:4096
    ds_read_b128 a[148:151], v16 offset:5120
    ds_read_b128 a[152:155], v16 offset:6144
    ds_read_b128 a[156:159], v16 offset:7168
    ds_read_b128 a[160:163], v16 offset:8192
    s_waitcnt lgkmcnt(6)
    v_mfma_f32_32x32x16_bf16 v[200:215], a[96:99], a[128:131], v[200:215]
    v_mfma_f32_32x32x16_bf16 v[216:231], a[96:99], a[132:135], v[216:231]
    v_mfma_f32_32x32x16_bf16 v[232:247], a[96:99], a[136:139], v[232:247]
    ds_read_b128 a[164:167], v16 offset:9216
    ds_read_b128 a[168:171], v16 offset:10240
    ds_read_b128 a[172:175], v16 offset:11264
    s_waitcnt lgkmcnt(6)
    v_mfma_f32_32x32x16_bf16 v[200:215], a[100:103], a[140:143], v[200:215]
    v_mfma_f32_32x32x16_bf16 v[216:231], a[100:103], a[144:147], v[216:231]
    v_mfma_f32_32x32x16_bf16 v[232:247], a[100:103], a[148:151], v[232:247]
    ds_read_b128 a[128:131], v16 offset:12288
    ds_read_b128 a[132:135], v16 offset:13312
    ds_read_b128 a[136:139], v16 offset:14336
    s_waitcnt lgkmcnt(6)
    v_mfma_f32_32x32x16_bf16 v[200:215], a[104:107], a[152:155], v[200:215]
    v_mfma_f32_32x32x16_bf16 v[216:231], a[104:107], a[156:159], v[216:231]
    v_mfma_f32_32x32x16_bf16 v[232:247], a[104:107], a[160:163], v[232:247]
    ds_read_b128 a[140:143], v16 offset:15360
    ds_read_b128 a[144:147], v16 offset:16384
    ds_read_b128 a[148:151], v16 offset:17408
    s_waitcnt lgkmcnt(6)
    v_mfma_f32_32x32x16_bf16 v[200:215], a[108:111], a[164:167], v[200:215]
    v_mfma_f32_32x32x16_bf16 v[216:231], a[108:111], a[168:171], v[216:231]
    v_mfma_f32_32x32x16_bf16 v[232:247], a[108:111], a[172:175], v[232:247]
    ds_read_b128 a[152:155], v16 offset:18432
    ds_read_b128 a[156:159], v16 offset:19456
    ds_read_b128 a[160:163], v16 offset:20480
    s_waitcnt lgkmcnt(6)
    v_mfma_f32_32x32x16_bf16 v[200:215], a[112:115], a[128:131], v[200:215]
    v_mfma_f32_32x32x16_bf16 v[216:231], a[112:115], a[132:135], v[216:231]
    v_mfma_f32_32x32x16_bf16 v[232:247], a[112:115], a[136:139], v[232:247]
    ds_read_b128 a[164:167], v16 offset:21504
    ds_read_b128 a[168:171], v16 offset:22528
    ds_read_b128 a[172:175], v16 offset:23552
    s_waitcnt lgkmcnt(6)
    v_mfma_f32_32x32x16_bf16 v[200:215], a[116:119], a[140:143], v[200:215]
    v_mfma_f32_32x32x16_bf16 v[216:231], a[116:119], a[144:147], v[216:231]
    v_mfma_f32_32x32x16_bf16 v[232:247], a[116:119], a[148:151], v[232:247]
    s_waitcnt lgkmcnt(3)
    v_mfma_f32_32x32x16_bf16 v[200:215], a[120:123], a[152:155], v[200:215]
    v_mfma_f32_32x32x16_bf16 v[216:231], a[120:123], a[156:159], v[216:231]
    v_mfma_f32_32x32x16_bf16 v[232:247], a[120:123], a[160:163], v[232:247]
    s_waitcnt lgkmcnt(0)
    v_mfma_f32_32x32x16_bf16 v[200:215], a[124:127], a[164:167], v[200:215]
    v_mfma_f32_32x32x16_bf16 v[216:231], a[124:127], a[168:171], v[216:231]
    v_mfma_f32_32x32x16_bf16 v[232:247], a[124:127], a[172:175], v[232:247]
    s_waitcnt vmcnt(6)
    s_barrier
    s_nop 7
    s_lshl_b32 s31, s99, 3
    s_add_u32 s31, s31, s38
    s_add_u32 s31, s31, 0
    s_lshl_b32 s31, s31, 2
    s_add_u32 s31, s31, s34
    s_lshl_b32 s31, s31, 3
    s_add_u32 s31, s31, s30
    s_mul_i32 s31, s31, 24576
    s_add_u32 s32, s31, 3072
    v_cvt_pk_bf16_f32 v200, v200, v201
    v_cvt_pk_bf16_f32 v201, v202, v203
    v_cvt_pk_bf16_f32 v202, v204, v205
    v_cvt_pk_bf16_f32 v203, v206, v207
    v_cvt_pk_bf16_f32 v204, v208, v209
    v_cvt_pk_bf16_f32 v205, v210, v211
    v_cvt_pk_bf16_f32 v206, v212, v213
    v_cvt_pk_bf16_f32 v207, v214, v215
    buffer_store_dwordx4 v[200:203], v46, s[24:27], s31 offen offset:0 sc1
    buffer_store_dwordx4 v[204:207], v46, s[24:27], s32 offen offset:0 sc1
    v_cvt_pk_bf16_f32 v216, v216, v217
    v_cvt_pk_bf16_f32 v217, v218, v219
    v_cvt_pk_bf16_f32 v218, v220, v221
    v_cvt_pk_bf16_f32 v219, v222, v223
    v_cvt_pk_bf16_f32 v220, v224, v225
    v_cvt_pk_bf16_f32 v221, v226, v227
    v_cvt_pk_bf16_f32 v222, v228, v229
    v_cvt_pk_bf16_f32 v223, v230, v231
    buffer_store_dwordx4 v[216:219], v46, s[24:27], s31 offen offset:1024 sc1
    buffer_store_dwordx4 v[220:223], v46, s[24:27], s32 offen offset:1024 sc1
    v_cvt_pk_bf16_f32 v232, v232, v233
    v_cvt_pk_bf16_f32 v233, v234, v235
    v_cvt_pk_bf16_f32 v234, v236, v237
    v_cvt_pk_bf16_f32 v235, v238, v239
    v_cvt_pk_bf16_f32 v236, v240, v241
    v_cvt_pk_bf16_f32 v237, v242, v243
    v_cvt_pk_bf16_f32 v238, v244, v245
    v_cvt_pk_bf16_f32 v239, v246, v247
    buffer_store_dwordx4 v[232:235], v46, s[24:27], s31 offen offset:2048 sc1
    buffer_store_dwordx4 v[236:239], v46, s[24:27], s32 offen offset:2048 sc1
    s_and_b32 s78, s39, 3
    s_add_u32 s78, s78, 3
    s_and_b32 s78, s78, 3
    s_mul_i32 s78, s78, 24576
    s_add_u32 s32, s66, s78
    s_add_u32 s32, s32, 3145728
    s_add_u32 m0, s67, s101
    s_nop 0
    buffer_load_dwordx4 v250, s[4:7], s32 offen offset:0 sc1 lds
    buffer_load_dwordx4 v250, s[4:7], s32 offen offset:1024 sc1 lds
    buffer_load_dwordx4 v250, s[4:7], s32 offen offset:2048 sc1 lds
    buffer_load_dwordx4 v250, s[4:7], s32 offen offset:3072 sc1 lds
    s_add_u32 m0, m0, 4096
    s_add_u32 s32, s32, 4096
    buffer_load_dwordx4 v250, s[4:7], s32 offen offset:0 sc1 lds
    buffer_load_dwordx4 v250, s[4:7], s32 offen offset:1024 sc1 lds
    v_add_u32 v16, s93, v250
    ds_read_b128 a[128:131], v16 offset:0
    ds_read_b128 a[132:135], v16 offset:1024
    ds_read_b128 a[136:139], v16 offset:2048
    ds_read_b128 a[140:143], v16 offset:3072
    ds_read_b128 a[144:147], v16 offset:4096
    ds_read_b128 a[148:151], v16 offset:5120
    ds_read_b128 a[152:155], v16 offset:6144
    ds_read_b128 a[156:159], v16 offset:7168
    ds_read_b128 a[160:163], v16 offset:8192
    s_waitcnt lgkmcnt(6)
    v_mfma_f32_32x32x16_bf16 v[64:79], a[32:35], a[128:131], v[64:79]
    v_mfma_f32_32x32x16_bf16 v[80:95], a[32:35], a[132:135], v[80:95]
    v_mfma_f32_32x32x16_bf16 v[96:111], a[32:35], a[136:139], v[96:111]
    ds_read_b128 a[164:167], v16 offset:9216
    ds_read_b128 a[168:171], v16 offset:10240
    ds_read_b128 a[172:175], v16 offset:11264
    s_waitcnt lgkmcnt(6)
    v_mfma_f32_32x32x16_bf16 v[64:79], a[36:39], a[140:143], v[64:79]
    v_mfma_f32_32x32x16_bf16 v[80:95], a[36:39], a[144:147], v[80:95]
    v_mfma_f32_32x32x16_bf16 v[96:111], a[36:39], a[148:151], v[96:111]
    ds_read_b128 a[128:131], v16 offset:12288
    ds_read_b128 a[132:135], v16 offset:13312
    ds_read_b128 a[136:139], v16 offset:14336
    s_waitcnt lgkmcnt(6)
    v_mfma_f32_32x32x16_bf16 v[64:79], a[40:43], a[152:155], v[64:79]
    v_mfma_f32_32x32x16_bf16 v[80:95], a[40:43], a[156:159], v[80:95]
    v_mfma_f32_32x32x16_bf16 v[96:111], a[40:43], a[160:163], v[96:111]
    ds_read_b128 a[140:143], v16 offset:15360
    ds_read_b128 a[144:147], v16 offset:16384
    ds_read_b128 a[148:151], v16 offset:17408
    s_waitcnt lgkmcnt(6)
    v_mfma_f32_32x32x16_bf16 v[64:79], a[44:47], a[164:167], v[64:79]
    v_mfma_f32_32x32x16_bf16 v[80:95], a[44:47], a[168:171], v[80:95]
    v_mfma_f32_32x32x16_bf16 v[96:111], a[44:47], a[172:175], v[96:111]
    ds_read_b128 a[152:155], v16 offset:18432
    ds_read_b128 a[156:159], v16 offset:19456
    ds_read_b128 a[160:163], v16 offset:20480
    s_waitcnt lgkmcnt(6)
    v_mfma_f32_32x32x16_bf16 v[64:79], a[48:51], a[128:131], v[64:79]
    v_mfma_f32_32x32x16_bf16 v[80:95], a[48:51], a[132:135], v[80:95]
    v_mfma_f32_32x32x16_bf16 v[96:111], a[48:51], a[136:139], v[96:111]
    ds_read_b128 a[164:167], v16 offset:21504
    ds_read_b128 a[168:171], v16 offset:22528
    ds_read_b128 a[172:175], v16 offset:23552
    s_waitcnt lgkmcnt(6)
    v_mfma_f32_32x32x16_bf16 v[64:79], a[52:55], a[140:143], v[64:79]
    v_mfma_f32_32x32x16_bf16 v[80:95], a[52:55], a[144:147], v[80:95]
    v_mfma_f32_32x32x16_bf16 v[96:111], a[52:55], a[148:151], v[96:111]
    s_waitcnt lgkmcnt(3)
    v_mfma_f32_32x32x16_bf16 v[64:79], a[56:59], a[152:155], v[64:79]
    v_mfma_f32_32x32x16_bf16 v[80:95], a[56:59], a[156:159], v[80:95]
    v_mfma_f32_32x32x16_bf16 v[96:111], a[56:59], a[160:163], v[96:111]
    s_waitcnt lgkmcnt(0)
    v_mfma_f32_32x32x16_bf16 v[64:79], a[60:63], a[164:167], v[64:79]
    v_mfma_f32_32x32x16_bf16 v[80:95], a[60:63], a[168:171], v[80:95]
    v_mfma_f32_32x32x16_bf16 v[96:111], a[60:63], a[172:175], v[96:111]
    s_waitcnt vmcnt(12)
    s_barrier
    v_add_u32 v16, s94, v250
    ds_read_b128 a[128:131], v16 offset:0
    ds_read_b128 a[132:135], v16 offset:1024
    ds_read_b128 a[136:139], v16 offset:2048
    ds_read_b128 a[140:143], v16 offset:3072
    ds_read_b128 a[144:147], v16 offset:4096
    ds_read_b128 a[148:151], v16 offset:5120
    ds_read_b128 a[152:155], v16 offset:6144
    ds_read_b128 a[156:159], v16 offset:7168
    ds_read_b128 a[160:163], v16 offset:8192
    s_waitcnt lgkmcnt(6)
    v_mfma_f32_32x32x16_bf16 v[64:79], a[64:67], a[128:131], v[64:79]
    v_mfma_f32_32x32x16_bf16 v[80:95], a[64:67], a[132:135], v[80:95]
    v_mfma_f32_32x32x16_bf16 v[96:111], a[64:67], a[136:139], v[96:111]
    ds_read_b128 a[164:167], v16 offset:9216
    ds_read_b128 a[168:171], v16 offset:10240
    ds_read_b128 a[172:175], v16 offset:11264
    s_waitcnt lgkmcnt(6)
    v_mfma_f32_32x32x16_bf16 v[64:79], a[68:71], a[140:143], v[64:79]
    v_mfma_f32_32x32x16_bf16 v[80:95], a[68:71], a[144:147], v[80:95]
    v_mfma_f32_32x32x16_bf16 v[96:111], a[68:71], a[148:151], v[96:111]
    ds_read_b128 a[128:131], v16 offset:12288
    ds_read_b128 a[132:135], v16 offset:13312
    ds_read_b128 a[136:139], v16 offset:14336
    s_waitcnt lgkmcnt(6)
    v_mfma_f32_32x32x16_bf16 v[64:79], a[72:75], a[152:155], v[64:79]
    v_mfma_f32_32x32x16_bf16 v[80:95], a[72:75], a[156:159], v[80:95]
    v_mfma_f32_32x32x16_bf16 v[96:111], a[72:75], a[160:163], v[96:111]
    ds_read_b128 a[140:143], v16 offset:15360
    ds_read_b128 a[144:147], v16 offset:16384
    ds_read_b128 a[148:151], v16 offset:17408
    s_waitcnt lgkmcnt(6)
    v_mfma_f32_32x32x16_bf16 v[64:79], a[76:79], a[164:167], v[64:79]
    v_mfma_f32_32x32x16_bf16 v[80:95], a[76:79], a[168:171], v[80:95]
    v_mfma_f32_32x32x16_bf16 v[96:111], a[76:79], a[172:175], v[96:111]
    ds_read_b128 a[152:155], v16 offset:18432
    ds_read_b128 a[156:159], v16 offset:19456
    ds_read_b128 a[160:163], v16 offset:20480
    s_waitcnt lgkmcnt(6)
    v_mfma_f32_32x32x16_bf16 v[64:79], a[80:83], a[128:131], v[64:79]
    v_mfma_f32_32x32x16_bf16 v[80:95], a[80:83], a[132:135], v[80:95]
    v_mfma_f32_32x32x16_bf16 v[96:111], a[80:83], a[136:139], v[96:111]
    ds_read_b128 a[164:167], v16 offset:21504
    ds_read_b128 a[168:171], v16 offset:22528
    ds_read_b128 a[172:175], v16 offset:23552
    s_waitcnt lgkmcnt(6)
    v_mfma_f32_32x32x16_bf16 v[64:79], a[84:87], a[140:143], v[64:79]
    v_mfma_f32_32x32x16_bf16 v[80:95], a[84:87], a[144:147], v[80:95]
    v_mfma_f32_32x32x16_bf16 v[96:111], a[84:87], a[148:151], v[96:111]
    s_waitcnt lgkmcnt(3)
    v_mfma_f32_32x32x16_bf16 v[64:79], a[88:91], a[152:155], v[64:79]
    v_mfma_f32_32x32x16_bf16 v[80:95], a[88:91], a[156:159], v[80:95]
    v_mfma_f32_32x32x16_bf16 v[96:111], a[88:91], a[160:163], v[96:111]
    s_waitcnt lgkmcnt(0)
    v_mfma_f32_32x32x16_bf16 v[64:79], a[92:95], a[164:167], v[64:79]
    v_mfma_f32_32x32x16_bf16 v[80:95], a[92:95], a[168:171], v[80:95]
    v_mfma_f32_32x32x16_bf16 v[96:111], a[92:95], a[172:175], v[96:111]
    s_waitcnt vmcnt(0)
    s_barrier
    s_cmp_lg_u32 s3, 0
    s_cbranch_scc1 Lsig_84
    s_lshl_b32 s78, s99, 3
    s_add_u32 s78, s78, s38
    s_add_u32 s78, s78, 0
    s_lshl_b32 s78, s78, 2
    s_add_u32 s78, s78, s34
    s_add_u32 s78, s78, 128
    s_mov_b32 s79, s30
    s_lshl_b32 s78, s78, 8
    s_add_u32 s78, s78, 50331648
    s_lshl_b32 s79, s79, 2
    s_add_u32 s78, s78, s79
    v_mov_b32 v60, s78
    v_mov_b32 v61, s96
    s_mov_b64 exec, 1
    global_store_dword v60, v61, s[64:65] sc1
    s_mov_b64 exec, -1
Lsig_84:
    v_add_u32 v16, s101, v250
    ds_read_b128 a[128:131], v16 offset:0
    ds_read_b128 a[132:135], v16 offset:1024
    ds_read_b128 a[136:139], v16 offset:2048
    ds_read_b128 a[140:143], v16 offset:3072
    ds_read_b128 a[144:147], v16 offset:4096
    ds_read_b128 a[148:151], v16 offset:5120
    ds_read_b128 a[152:155], v16 offset:6144
    ds_read_b128 a[156:159], v16 offset:7168
    ds_read_b128 a[160:163], v16 offset:8192
    s_waitcnt lgkmcnt(6)
    v_mfma_f32_32x32x16_bf16 v[64:79], a[96:99], a[128:131], v[64:79]
    v_mfma_f32_32x32x16_bf16 v[80:95], a[96:99], a[132:135], v[80:95]
    v_mfma_f32_32x32x16_bf16 v[96:111], a[96:99], a[136:139], v[96:111]
    ds_read_b128 a[164:167], v16 offset:9216
    ds_read_b128 a[168:171], v16 offset:10240
    ds_read_b128 a[172:175], v16 offset:11264
    s_waitcnt lgkmcnt(6)
    v_mfma_f32_32x32x16_bf16 v[64:79], a[100:103], a[140:143], v[64:79]
    v_mfma_f32_32x32x16_bf16 v[80:95], a[100:103], a[144:147], v[80:95]
    v_mfma_f32_32x32x16_bf16 v[96:111], a[100:103], a[148:151], v[96:111]
    ds_read_b128 a[128:131], v16 offset:12288
    ds_read_b128 a[132:135], v16 offset:13312
    ds_read_b128 a[136:139], v16 offset:14336
    s_waitcnt lgkmcnt(6)
    v_mfma_f32_32x32x16_bf16 v[64:79], a[104:107], a[152:155], v[64:79]
    v_mfma_f32_32x32x16_bf16 v[80:95], a[104:107], a[156:159], v[80:95]
    v_mfma_f32_32x32x16_bf16 v[96:111], a[104:107], a[160:163], v[96:111]
    ds_read_b128 a[140:143], v16 offset:15360
    ds_read_b128 a[144:147], v16 offset:16384
    ds_read_b128 a[148:151], v16 offset:17408
    s_waitcnt lgkmcnt(6)
    v_mfma_f32_32x32x16_bf16 v[64:79], a[108:111], a[164:167], v[64:79]
    v_mfma_f32_32x32x16_bf16 v[80:95], a[108:111], a[168:171], v[80:95]
    v_mfma_f32_32x32x16_bf16 v[96:111], a[108:111], a[172:175], v[96:111]
    ds_read_b128 a[152:155], v16 offset:18432
    ds_read_b128 a[156:159], v16 offset:19456
    ds_read_b128 a[160:163], v16 offset:20480
    s_waitcnt lgkmcnt(6)
    v_mfma_f32_32x32x16_bf16 v[64:79], a[112:115], a[128:131], v[64:79]
    v_mfma_f32_32x32x16_bf16 v[80:95], a[112:115], a[132:135], v[80:95]
    v_mfma_f32_32x32x16_bf16 v[96:111], a[112:115], a[136:139], v[96:111]
    ds_read_b128 a[164:167], v16 offset:21504
    ds_read_b128 a[168:171], v16 offset:22528
    ds_read_b128 a[172:175], v16 offset:23552
    s_waitcnt lgkmcnt(6)
    v_mfma_f32_32x32x16_bf16 v[64:79], a[116:119], a[140:143], v[64:79]
    v_mfma_f32_32x32x16_bf16 v[80:95], a[116:119], a[144:147], v[80:95]
    v_mfma_f32_32x32x16_bf16 v[96:111], a[116:119], a[148:151], v[96:111]
    s_waitcnt lgkmcnt(3)
    v_mfma_f32_32x32x16_bf16 v[64:79], a[120:123], a[152:155], v[64:79]
    v_mfma_f32_32x32x16_bf16 v[80:95], a[120:123], a[156:159], v[80:95]
    v_mfma_f32_32x32x16_bf16 v[96:111], a[120:123], a[160:163], v[96:111]
    s_waitcnt lgkmcnt(0)
    v_mfma_f32_32x32x16_bf16 v[64:79], a[124:127], a[164:167], v[64:79]
    v_mfma_f32_32x32x16_bf16 v[80:95], a[124:127], a[168:171], v[80:95]
    v_mfma_f32_32x32x16_bf16 v[96:111], a[124:127], a[172:175], v[96:111]
    s_nop 15
    s_lshl_b32 s31, s99, 3
    s_add_u32 s31, s31, s38
    s_add_u32 s31, s31, 4
    s_lshl_b32 s31, s31, 2
    s_add_u32 s31, s31, s34
    s_lshl_b32 s31, s31, 3
    s_add_u32 s31, s31, s30
    s_mul_i32 s31, s31, 24576
    s_add_u32 s32, s31, 3072
    v_cvt_pk_bf16_f32 v64, v64, v65
    v_cvt_pk_bf16_f32 v65, v66, v67
    v_cvt_pk_bf16_f32 v66, v68, v69
    v_cvt_pk_bf16_f32 v67, v70, v71
    v_cvt_pk_bf16_f32 v68, v72, v73
    v_cvt_pk_bf16_f32 v69, v74, v75
    v_cvt_pk_bf16_f32 v70, v76, v77
    v_cvt_pk_bf16_f32 v71, v78, v79
    buffer_store_dwordx4 v[64:67], v46, s[24:27], s31 offen offset:0 sc1
    buffer_store_dwordx4 v[68:71], v46, s[24:27], s32 offen offset:0 sc1
    v_cvt_pk_bf16_f32 v80, v80, v81
    v_cvt_pk_bf16_f32 v81, v82, v83
    v_cvt_pk_bf16_f32 v82, v84, v85
    v_cvt_pk_bf16_f32 v83, v86, v87
    v_cvt_pk_bf16_f32 v84, v88, v89
    v_cvt_pk_bf16_f32 v85, v90, v91
    v_cvt_pk_bf16_f32 v86, v92, v93
    v_cvt_pk_bf16_f32 v87, v94, v95
    buffer_store_dwordx4 v[80:83], v46, s[24:27], s31 offen offset:1024 sc1
    buffer_store_dwordx4 v[84:87], v46, s[24:27], s32 offen offset:1024 sc1
    v_cvt_pk_bf16_f32 v96, v96, v97
    v_cvt_pk_bf16_f32 v97, v98, v99
    v_cvt_pk_bf16_f32 v98, v100, v101
    v_cvt_pk_bf16_f32 v99, v102, v103
    v_cvt_pk_bf16_f32 v100, v104, v105
    v_cvt_pk_bf16_f32 v101, v106, v107
    v_cvt_pk_bf16_f32 v102, v108, v109
    v_cvt_pk_bf16_f32 v103, v110, v111
    buffer_store_dwordx4 v[96:99], v46, s[24:27], s31 offen offset:2048 sc1
    buffer_store_dwordx4 v[100:103], v46, s[24:27], s32 offen offset:2048 sc1
    s_cmp_lg_u32 s3, 0
    s_cbranch_scc1 Lskip_85
    s_lshl_b32 s78, s99, 3
    s_add_u32 s78, s78, s38
    s_add_u32 s78, s78, 0
    s_lshl_b32 s78, s78, 2
    s_add_u32 s78, s78, s34
    s_add_u32 s78, s78, 128
    s_mov_b32 s79, s30
    s_lshl_b32 s78, s78, 8
    s_add_u32 s78, s78, 50331648
    v_and_b32 v62, 7, v1
    v_lshlrev_b32 v62, 2, v62
    v_add_u32 v62, s78, v62
Lpoll_86:
    global_load_dword v63, v62, s[64:65] sc1
    s_waitcnt vmcnt(0)
    v_cmp_ne_u32 vcc, s96, v63
    s_nop 0
    s_cmp_eq_u64 vcc, 0
    s_cbranch_scc1 Lskip_85
    s_sleep 4
    s_branch Lpoll_86
Lskip_85:
    s_waitcnt vmcnt(0)
    s_barrier
    s_cmp_lg_u32 s3, 0
    s_cbranch_scc1 Lsig_87
    s_lshl_b32 s78, s99, 3
    s_add_u32 s78, s78, s38
    s_add_u32 s78, s78, 4
    s_lshl_b32 s78, s78, 2
    s_add_u32 s78, s78, s34
    s_add_u32 s78, s78, 128
    s_mov_b32 s79, s30
    s_lshl_b32 s78, s78, 8
    s_add_u32 s78, s78, 50331648
    s_lshl_b32 s79, s79, 2
    s_add_u32 s78, s78, s79
    v_mov_b32 v60, s78
    v_mov_b32 v61, s96
    s_mov_b64 exec, 1
    global_store_dword v60, v61, s[64:65] sc1
    s_mov_b64 exec, -1
Lsig_87:
    s_mul_i32 s69, s30, 3
    s_add_u32 s69, s69, s3
    s_lshl_b32 s69, s69, 10
    v_lshlrev_b32 v5, 4, v1
    v_and_b32 v2, 31, v1
    v_lshrrev_b32 v3, 5, v1
    v_lshlrev_b32 v6, 11, v2
    v_lshl_add_u32 v6, v3, 4, v6
    s_mul_i32 s70, s38, 96
    s_lshl_b32 s31, s3, 5
    s_add_u32 s70, s70, s31
    s_lshl_b32 s70, s70, 11
    s_lshl_b32 s31, s34, 8
    s_add_u32 s70, s70, s31
    s_lshl_b32 s31, s30, 5
    s_add_u32 s70, s70, s31
    s_lshl_b32 s31, s99, 10
    s_add_u32 s70, s70, s31
    s_mov_b32 s4, s60
    s_mov_b32 s5, s61
    s_mov_b32 s6, 1572864
    s_cmp_eq_u32 s3, 3
    s_cselect_b32 s26, 0, s26
    s_cselect_b32 s6, 0, s6
    v_mov_b32 v7, 0xffff0000
    s_lshl_b32 s31, s99, 3
    s_add_u32 s31, s31, s38
    s_add_u32 s31, s31, 0
    s_lshl_b32 s31, s31, 2
    s_add_u32 s31, s31, s34
    s_mul_i32 s31, s31, 196608
    s_add_u32 s31, s31, s69
    buffer_load_dwordx4 v[16:19], v5, s[24:27], s31 offen sc1
    s_add_u32 s31, s31, 24576
    buffer_load_dwordx4 v[20:23], v5, s[24:27], s31 offen sc1
    s_add_u32 s31, s31, 24576
    buffer_load_dwordx4 v[24:27], v5, s[24:27], s31 offen sc1
    s_add_u32 s31, s31, 24576
    buffer_load_dwordx4 v[28:31], v5, s[24:27], s31 offen sc1
    s_add_u32 s31, s31, 24576
    buffer_load_dwordx4 v[32:35], v5, s[24:27], s31 offen sc1
    s_add_u32 s31, s31, 24576
    buffer_load_dwordx4 v[36:39], v5, s[24:27], s31 offen sc1
    s_add_u32 s31, s31, 24576
    buffer_load_dwordx4 v[40:43], v5, s[24:27], s31 offen sc1
    s_add_u32 s31, s31, 24576
    buffer_load_dwordx4 v[44:47], v5, s[24:27], s31 offen sc1
    s_cmp_lg_u32 s3, 0
    s_cbranch_scc1 Lskip_88
    s_lshl_b32 s78, s99, 3
    s_add_u32 s78, s78, s38
    s_add_u32 s78, s78, 4
    s_lshl_b32 s78, s78, 2
    s_add_u32 s78, s78, s34
    s_add_u32 s78, s78, 128
    s_mov_b32 s79, s30
    s_lshl_b32 s78, s78, 8
    s_add_u32 s78, s78, 50331648
    v_and_b32 v62, 7, v1
    v_lshlrev_b32 v62, 2, v62
    v_add_u32 v62, s78, v62
Lpoll_89:
    global_load_dword v63, v62, s[64:65] sc1
    s_waitcnt vmcnt(0)
    v_cmp_ne_u32 vcc, s96, v63
    s_nop 0
    s_cmp_eq_u64 vcc, 0
    s_cbranch_scc1 Lskip_88
    s_sleep 4
    s_branch Lpoll_89
Lskip_88:
    s_barrier
    s_lshl_b32 s31, s99, 3
    s_add_u32 s31, s31, s38
    s_add_u32 s31, s31, 4
    s_lshl_b32 s31, s31, 2
    s_add_u32 s31, s31, s34
    s_mul_i32 s31, s31, 196608
    s_add_u32 s31, s31, s69
    buffer_load_dwordx4 v[48:51], v5, s[24:27], s31 offen sc1
    s_add_u32 s31, s31, 24576
    buffer_load_dwordx4 v[52:55], v5, s[24:27], s31 offen sc1
    s_add_u32 s31, s31, 24576
    buffer_load_dwordx4 v[56:59], v5, s[24:27], s31 offen sc1
    s_add_u32 s31, s31, 24576
    buffer_load_dwordx4 v[60:63], v5, s[24:27], s31 offen sc1
    s_add_u32 s31, s31, 24576
    buffer_load_dwordx4 v[64:67], v5, s[24:27], s31 offen sc1
    s_add_u32 s31, s31, 24576
    buffer_load_dwordx4 v[68:71], v5, s[24:27], s31 offen sc1
    s_add_u32 s31, s31, 24576
    buffer_load_dwordx4 v[72:75], v5, s[24:27], s31 offen sc1
    s_add_u32 s31, s31, 24576
    buffer_load_dwordx4 v[76:79], v5, s[24:27], s31 offen sc1
    s_waitcnt vmcnt(8)
    v_lshlrev_b32 v96, 16, v16
    v_and_b32 v97, v7, v16
    v_lshlrev_b32 v98, 16, v17
    v_and_b32 v99, v7, v17
    v_lshlrev_b32 v100, 16, v18
    v_and_b32 v101, v7, v18
    v_lshlrev_b32 v102, 16, v19
    v_and_b32 v103, v7, v19
    v_lshlrev_b32 v112, 16, v20
    v_and_b32 v113, v7, v20
    v_add_f32 v96, v96, v112
    v_add_f32 v97, v97, v113
    v_lshlrev_b32 v114, 16, v21
    v_and_b32 v115, v7, v21
    v_add_f32 v98, v98, v114
    v_add_f32 v99, v99, v115
    v_lshlrev_b32 v116, 16, v22
    v_and_b32 v117, v7, v22
    v_add_f32 v100, v100, v116
    v_add_f32 v101, v101, v117
    v_lshlrev_b32 v118, 16, v23
    v_and_b32 v119, v7, v23
    v_add_f32 v102, v102, v118
    v_add_f32 v103, v103, v119
    v_lshlrev_b32 v112, 16, v24
    v_and_b32 v113, v7, v24
    v_add_f32 v96, v96, v112
    v_add_f32 v97, v97, v113
    v_lshlrev_b32 v114, 16, v25
    v_and_b32 v115, v7, v25
    v_add_f32 v98, v98, v114
    v_add_f32 v99, v99, v115
    v_lshlrev_b32 v116, 16, v26
    v_and_b32 v117, v7, v26
    v_add_f32 v100, v100, v116
    v_add_f32 v101, v101, v117
    v_lshlrev_b32 v118, 16, v27
    v_and_b32 v119, v7, v27
    v_add_f32 v102, v102, v118
    v_add_f32 v103, v103, v119
    v_lshlrev_b32 v112, 16, v28
    v_and_b32 v113, v7, v28
    v_add_f32 v96, v96, v112
    v_add_f32 v97, v97, v113
    v_lshlrev_b32 v114, 16, v29
    v_and_b32 v115, v7, v29
    v_add_f32 v98, v98, v114
    v_add_f32 v99, v99, v115
    v_lshlrev_b32 v116, 16, v30
    v_and_b32 v117, v7, v30
    v_add_f32 v100, v100, v116
    v_add_f32 v101, v101, v117
    v_lshlrev_b32 v118, 16, v31
    v_and_b32 v119, v7, v31
    v_add_f32 v102, v102, v118
    v_add_f32 v103, v103, v119
    v_lshlrev_b32 v112, 16, v32
    v_and_b32 v113, v7, v32
    v_add_f32 v96, v96, v112
    v_add_f32 v97, v97, v113
    v_lshlrev_b32 v114, 16, v33
    v_and_b32 v115, v7, v33
    v_add_f32 v98, v98, v114
    v_add_f32 v99, v99, v115
    v_lshlrev_b32 v116, 16, v34
    v_and_b32 v117, v7, v34
    v_add_f32 v100, v100, v116
    v_add_f32 v101, v101, v117
    v_lshlrev_b32 v118, 16, v35
    v_and_b32 v119, v7, v35
    v_add_f32 v102, v102, v118
    v_add_f32 v103, v103, v119
    v_lshlrev_b32 v112, 16, v36
    v_and_b32 v113, v7, v36
    v_add_f32 v96, v96, v112
    v_add_f32 v97, v97, v113
    v_lshlrev_b32 v114, 16, v37
    v_and_b32 v115, v7, v37
    v_add_f32 v98, v98, v114
    v_add_f32 v99, v99, v115
    v_lshlrev_b32 v116, 16, v38
    v_and_b32 v117, v7, v38
    v_add_f32 v100, v100, v116
    v_add_f32 v101, v101, v117
    v_lshlrev_b32 v118, 16, v39
    v_and_b32 v119, v7, v39
    v_add_f32 v102, v102, v118
    v_add_f32 v103, v103, v119
    v_lshlrev_b32 v112, 16, v40
    v_and_b32 v113, v7, v40
    v_add_f32 v96, v96, v112
    v_add_f32 v97, v97, v113
    v_lshlrev_b32 v114, 16, v41
    v_and_b32 v115, v7, v41
    v_add_f32 v98, v98, v114
    v_add_f32 v99, v99, v115
    v_lshlrev_b32 v116, 16, v42
    v_and_b32 v117, v7, v42
    v_add_f32 v100, v100, v116
    v_add_f32 v101, v101, v117
    v_lshlrev_b32 v118, 16, v43
    v_and_b32 v119, v7, v43
    v_add_f32 v102, v102, v118
    v_add_f32 v103, v103, v119
    v_lshlrev_b32 v112, 16, v44
    v_and_b32 v113, v7, v44
    v_add_f32 v96, v96, v112
    v_add_f32 v97, v97, v113
    v_lshlrev_b32 v114, 16, v45
    v_and_b32 v115, v7, v45
    v_add_f32 v98, v98, v114
    v_add_f32 v99, v99, v115
    v_lshlrev_b32 v116, 16, v46
    v_and_b32 v117, v7, v46
    v_add_f32 v100, v100, v116
    v_add_f32 v101, v101, v117
    v_lshlrev_b32 v118, 16, v47
    v_and_b32 v119, v7, v47
    v_add_f32 v102, v102, v118
    v_add_f32 v103, v103, v119
    v_cvt_pk_bf16_f32 v8, v96, v97
    v_cvt_pk_bf16_f32 v9, v98, v99
    v_cvt_pk_bf16_f32 v10, v100, v101
    v_cvt_pk_bf16_f32 v11, v102, v103
    s_add_u32 s31, s70, 0
    buffer_store_dwordx4 v[8:11], v6, s[4:7], s31 offen
    s_waitcnt vmcnt(0)
    v_lshlrev_b32 v104, 16, v48
    v_and_b32 v105, v7, v48
    v_lshlrev_b32 v106, 16, v49
    v_and_b32 v107, v7, v49
    v_lshlrev_b32 v108, 16, v50
    v_and_b32 v109, v7, v50
    v_lshlrev_b32 v110, 16, v51
    v_and_b32 v111, v7, v51
    v_lshlrev_b32 v112, 16, v52
    v_and_b32 v113, v7, v52
    v_add_f32 v104, v104, v112
    v_add_f32 v105, v105, v113
    v_lshlrev_b32 v114, 16, v53
    v_and_b32 v115, v7, v53
    v_add_f32 v106, v106, v114
    v_add_f32 v107, v107, v115
    v_lshlrev_b32 v116, 16, v54
    v_and_b32 v117, v7, v54
    v_add_f32 v108, v108, v116
    v_add_f32 v109, v109, v117
    v_lshlrev_b32 v118, 16, v55
    v_and_b32 v119, v7, v55
    v_add_f32 v110, v110, v118
    v_add_f32 v111, v111, v119
    v_lshlrev_b32 v112, 16, v56
    v_and_b32 v113, v7, v56
    v_add_f32 v104, v104, v112
    v_add_f32 v105, v105, v113
    v_lshlrev_b32 v114, 16, v57
    v_and_b32 v115, v7, v57
    v_add_f32 v106, v106, v114
    v_add_f32 v107, v107, v115
    v_lshlrev_b32 v116, 16, v58
    v_and_b32 v117, v7, v58
    v_add_f32 v108, v108, v116
    v_add_f32 v109, v109, v117
    v_lshlrev_b32 v118, 16, v59
    v_and_b32 v119, v7, v59
    v_add_f32 v110, v110, v118
    v_add_f32 v111, v111, v119
    v_lshlrev_b32 v112, 16, v60
    v_and_b32 v113, v7, v60
    v_add_f32 v104, v104, v112
    v_add_f32 v105, v105, v113
    v_lshlrev_b32 v114, 16, v61
    v_and_b32 v115, v7, v61
    v_add_f32 v106, v106, v114
    v_add_f32 v107, v107, v115
    v_lshlrev_b32 v116, 16, v62
    v_and_b32 v117, v7, v62
    v_add_f32 v108, v108, v116
    v_add_f32 v109, v109, v117
    v_lshlrev_b32 v118, 16, v63
    v_and_b32 v119, v7, v63
    v_add_f32 v110, v110, v118
    v_add_f32 v111, v111, v119
    v_lshlrev_b32 v112, 16, v64
    v_and_b32 v113, v7, v64
    v_add_f32 v104, v104, v112
    v_add_f32 v105, v105, v113
    v_lshlrev_b32 v114, 16, v65
    v_and_b32 v115, v7, v65
    v_add_f32 v106, v106, v114
    v_add_f32 v107, v107, v115
    v_lshlrev_b32 v116, 16, v66
    v_and_b32 v117, v7, v66
    v_add_f32 v108, v108, v116
    v_add_f32 v109, v109, v117
    v_lshlrev_b32 v118, 16, v67
    v_and_b32 v119, v7, v67
    v_add_f32 v110, v110, v118
    v_add_f32 v111, v111, v119
    v_lshlrev_b32 v112, 16, v68
    v_and_b32 v113, v7, v68
    v_add_f32 v104, v104, v112
    v_add_f32 v105, v105, v113
    v_lshlrev_b32 v114, 16, v69
    v_and_b32 v115, v7, v69
    v_add_f32 v106, v106, v114
    v_add_f32 v107, v107, v115
    v_lshlrev_b32 v116, 16, v70
    v_and_b32 v117, v7, v70
    v_add_f32 v108, v108, v116
    v_add_f32 v109, v109, v117
    v_lshlrev_b32 v118, 16, v71
    v_and_b32 v119, v7, v71
    v_add_f32 v110, v110, v118
    v_add_f32 v111, v111, v119
    v_lshlrev_b32 v112, 16, v72
    v_and_b32 v113, v7, v72
    v_add_f32 v104, v104, v112
    v_add_f32 v105, v105, v113
    v_lshlrev_b32 v114, 16, v73
    v_and_b32 v115, v7, v73
    v_add_f32 v106, v106, v114
    v_add_f32 v107, v107, v115
    v_lshlrev_b32 v116, 16, v74
    v_and_b32 v117, v7, v74
    v_add_f32 v108, v108, v116
    v_add_f32 v109, v109, v117
    v_lshlrev_b32 v118, 16, v75
    v_and_b32 v119, v7, v75
    v_add_f32 v110, v110, v118
    v_add_f32 v111, v111, v119
    v_lshlrev_b32 v112, 16, v76
    v_and_b32 v113, v7, v76
    v_add_f32 v104, v104, v112
    v_add_f32 v105, v105, v113
    v_lshlrev_b32 v114, 16, v77
    v_and_b32 v115, v7, v77
    v_add_f32 v106, v106, v114
    v_add_f32 v107, v107, v115
    v_lshlrev_b32 v116, 16, v78
    v_and_b32 v117, v7, v78
    v_add_f32 v108, v108, v116
    v_add_f32 v109, v109, v117
    v_lshlrev_b32 v118, 16, v79
    v_and_b32 v119, v7, v79
    v_add_f32 v110, v110, v118
    v_add_f32 v111, v111, v119
    v_cvt_pk_bf16_f32 v12, v104, v105
    v_cvt_pk_bf16_f32 v13, v106, v107
    v_cvt_pk_bf16_f32 v14, v108, v109
    v_cvt_pk_bf16_f32 v15, v110, v111
    s_add_u32 s31, s70, 786432
    buffer_store_dwordx4 v[12:15], v6, s[4:7], s31 offen
L_end:
    s_endpgm
Lslow_4:
    s_nop 15
    v_max3_f32 v59, v64, v65, v66
    v_max3_f32 v59, v59, v67, v68
    v_max3_f32 v59, v59, v69, v70
    v_max3_f32 v59, v59, v71, v72
    v_max3_f32 v59, v59, v73, v74
    v_max3_f32 v59, v59, v75, v76
    v_max3_f32 v59, v59, v77, v78
    v_max_f32 v59, v59, v79
    v_max3_f32 v60, v80, v81, v82
    v_max3_f32 v60, v60, v83, v84
    v_max3_f32 v60, v60, v85, v86
    v_max3_f32 v60, v60, v87, v88
    v_max3_f32 v60, v60, v89, v90
    v_max3_f32 v60, v60, v91, v92
    v_max3_f32 v60, v60, v93, v94
    v_max_f32 v60, v60, v95
    v_max3_f32 v61, v96, v97, v98
    v_max3_f32 v61, v61, v99, v100
    v_max3_f32 v61, v61, v101, v102
    v_max3_f32 v61, v61, v103, v104
    v_max3_f32 v61, v61, v105, v106
    v_max3_f32 v61, v61, v107, v108
    v_max3_f32 v61, v61, v109, v110
    v_max_f32 v61, v61, v111
    s_waitcnt lgkmcnt(0)
    s_barrier
    ds_write_b32 v48, v59 offset:0
    ds_write_b32 v48, v60 offset:1024
    ds_write_b32 v48, v61 offset:2048
    s_waitcnt lgkmcnt(0)
    s_barrier
    ds_write_b32 v6, v7
    ds_read_b128 v[184:187], v49 offset:0
    ds_read_b128 v[188:191], v49 offset:16
    s_waitcnt lgkmcnt(0)
    v_max3_f32 v59, v184, v185, v186
    v_max3_f32 v59, v59, v187, v188
    v_max3_f32 v59, v59, v189, v190
    v_max_f32 v59, v59, v191
    v_mul_f32 v59, s36, v59
    v_mov_b32 v50, v59
    ds_read_b128 v[184:187], v49 offset:1024
    ds_read_b128 v[188:191], v49 offset:1040
    s_waitcnt lgkmcnt(0)
    v_max3_f32 v59, v184, v185, v186
    v_max3_f32 v59, v59, v187, v188
    v_max3_f32 v59, v59, v189, v190
    v_max_f32 v59, v59, v191
    v_mul_f32 v59, s36, v59
    v_mov_b32 v51, v59
    ds_read_b128 v[184:187], v49 offset:2048
    ds_read_b128 v[188:191], v49 offset:2064
    s_waitcnt lgkmcnt(0)
    v_max3_f32 v59, v184, v185, v186
    v_max3_f32 v59, v59, v187, v188
    v_max3_f32 v59, v59, v189, v190
    v_max_f32 v59, v59, v191
    v_mul_f32 v59, s36, v59
    v_mov_b32 v52, v59
    v_fma_f32 v184, v64, s36, -v50
    v_fma_f32 v185, v65, s36, -v50
    v_fma_f32 v186, v66, s36, -v50
    v_fma_f32 v187, v67, s36, -v50
    v_exp_f32 v184, v184
    v_exp_f32 v185, v185
    v_fma_f32 v188, v68, s36, -v50
    v_fma_f32 v189, v69, s36, -v50
    v_exp_f32 v186, v186
    v_exp_f32 v187, v187
    v_add_f32 v56, v184, v185
    v_cvt_pk_bf16_f32 v160, v184, v185
    v_fma_f32 v190, v70, s36, -v50
    v_fma_f32 v191, v71, s36, -v50
    v_exp_f32 v188, v188
    v_exp_f32 v189, v189
    v_add_f32 v56, v56, v186
    v_add_f32 v56, v56, v187
    v_cvt_pk_bf16_f32 v161, v186, v187
    v_fma_f32 v184, v72, s36, -v50
    v_fma_f32 v185, v73, s36, -v50
    v_exp_f32 v190, v190
    v_exp_f32 v191, v191
    v_add_f32 v56, v56, v188
    v_add_f32 v56, v56, v189
    v_cvt_pk_bf16_f32 v162, v188, v189
    v_fma_f32 v186, v74, s36, -v50
    v_fma_f32 v187, v75, s36, -v50
    v_exp_f32 v184, v184
    v_exp_f32 v185, v185
    v_add_f32 v56, v56, v190
    v_add_f32 v56, v56, v191
    v_cvt_pk_bf16_f32 v163, v190, v191
    v_fma_f32 v188, v76, s36, -v50
    v_fma_f32 v189, v77, s36, -v50
    v_exp_f32 v186, v186
    v_exp_f32 v187, v187
    v_add_f32 v56, v56, v184
    v_add_f32 v56, v56, v185
    v_cvt_pk_bf16_f32 v164, v184, v185
    v_fma_f32 v190, v78, s36, -v50
    v_fma_f32 v191, v79, s36, -v50
    v_exp_f32 v188, v188
    v_exp_f32 v189, v189
    v_add_f32 v56, v56, v186
    v_add_f32 v56, v56, v187
    v_cvt_pk_bf16_f32 v165, v186, v187
    v_exp_f32 v190, v190
    v_exp_f32 v191, v191
    v_add_f32 v56, v56, v188
    v_add_f32 v56, v56, v189
    v_cvt_pk_bf16_f32 v166, v188, v189
    v_add_f32 v56, v56, v190
    v_add_f32 v56, v56, v191
    v_cvt_pk_bf16_f32 v167, v190, v191
    v_fma_f32 v192, v80, s36, -v51
    v_fma_f32 v193, v81, s36, -v51
    v_fma_f32 v194, v82, s36, -v51
    v_fma_f32 v195, v83, s36, -v51
    v_exp_f32 v192, v192
    v_exp_f32 v193, v193
    v_fma_f32 v196, v84, s36, -v51
    v_fma_f32 v197, v85, s36, -v51
    v_exp_f32 v194, v194
    v_exp_f32 v195, v195
    v_add_f32 v57, v192, v193
    v_cvt_pk_bf16_f32 v168, v192, v193
    v_fma_f32 v198, v86, s36, -v51
    v_fma_f32 v199, v87, s36, -v51
    v_exp_f32 v196, v196
    v_exp_f32 v197, v197
    v_add_f32 v57, v57, v194
    v_add_f32 v57, v57, v195
    v_cvt_pk_bf16_f32 v169, v194, v195
    v_fma_f32 v192, v88, s36, -v51
    v_fma_f32 v193, v89, s36, -v51
    v_exp_f32 v198, v198
    v_exp_f32 v199, v199
    v_add_f32 v57, v57, v196
    v_add_f32 v57, v57, v197
    v_cvt_pk_bf16_f32 v170, v196, v197
    v_fma_f32 v194, v90, s36, -v51
    v_fma_f32 v195, v91, s36, -v51
    v_exp_f32 v192, v192
    v_exp_f32 v193, v193
    v_add_f32 v57, v57, v198
    v_add_f32 v57, v57, v199
    v_cvt_pk_bf16_f32 v171, v198, v199
    v_fma_f32 v196, v92, s36, -v51
    v_fma_f32 v197, v93, s36, -v51
    v_exp_f32 v194, v194
    v_exp_f32 v195, v195
    v_add_f32 v57, v57, v192
    v_add_f32 v57, v57, v193
    v_cvt_pk_bf16_f32 v172, v192, v193
    v_fma_f32 v198, v94, s36, -v51
    v_fma_f32 v199, v95, s36, -v51
    v_exp_f32 v196, v196
    v_exp_f32 v197, v197
    v_add_f32 v57, v57, v194
    v_add_f32 v57, v57, v195
    v_cvt_pk_bf16_f32 v173, v194, v195
    v_exp_f32 v198, v198
    v_exp_f32 v199, v199
    v_add_f32 v57, v57, v196
    v_add_f32 v57, v57, v197
    v_cvt_pk_bf16_f32 v174, v196, v197
    v_add_f32 v57, v57, v198
    v_add_f32 v57, v57, v199
    v_cvt_pk_bf16_f32 v175, v198, v199
    v_fma_f32 v184, v96, s36, -v52
    v_fma_f32 v185, v97, s36, -v52
    v_fma_f32 v186, v98, s36, -v52
    v_fma_f32 v187, v99, s36, -v52
    v_exp_f32 v184, v184
    v_exp_f32 v185, v185
    v_fma_f32 v188, v100, s36, -v52
    v_fma_f32 v189, v101, s36, -v52
    v_exp_f32 v186, v186
    v_exp_f32 v187, v187
    v_add_f32 v58, v184, v185
    v_cvt_pk_bf16_f32 v176, v184, v185
    v_fma_f32 v190, v102, s36, -v52
    v_fma_f32 v191, v103, s36, -v52
    v_exp_f32 v188, v188
    v_exp_f32 v189, v189
    v_add_f32 v58, v58, v186
    v_add_f32 v58, v58, v187
    v_cvt_pk_bf16_f32 v177, v186, v187
    v_fma_f32 v184, v104, s36, -v52
    v_fma_f32 v185, v105, s36, -v52
    v_exp_f32 v190, v190
    v_exp_f32 v191, v191
    v_add_f32 v58, v58, v188
    v_add_f32 v58, v58, v189
    v_cvt_pk_bf16_f32 v178, v188, v189
    v_fma_f32 v186, v106, s36, -v52
    v_fma_f32 v187, v107, s36, -v52
    v_exp_f32 v184, v184
    v_exp_f32 v185, v185
    v_add_f32 v58, v58, v190
    v_add_f32 v58, v58, v191
    v_cvt_pk_bf16_f32 v179, v190, v191
    v_fma_f32 v188, v108, s36, -v52
    v_fma_f32 v189, v109, s36, -v52
    v_exp_f32 v186, v186
    v_exp_f32 v187, v187
    v_add_f32 v58, v58, v184
    v_add_f32 v58, v58, v185
    v_cvt_pk_bf16_f32 v180, v184, v185
    v_fma_f32 v190, v110, s36, -v52
    v_fma_f32 v191, v111, s36, -v52
    v_exp_f32 v188, v188
    v_exp_f32 v189, v189
    v_add_f32 v58, v58, v186
    v_add_f32 v58, v58, v187
    v_cvt_pk_bf16_f32 v181, v186, v187
    v_exp_f32 v190, v190
    v_exp_f32 v191, v191
    v_add_f32 v58, v58, v188
    v_add_f32 v58, v58, v189
    v_cvt_pk_bf16_f32 v182, v188, v189
    v_add_f32 v58, v58, v190
    v_add_f32 v58, v58, v191
    v_cvt_pk_bf16_f32 v183, v190, v191
    ds_write_b128 v28, v[160:163] offset:0
    ds_write_b128 v28, v[164:167] offset:3072
    ds_write_b128 v28, v[168:171] offset:1024
    ds_write_b128 v28, v[172:175] offset:4096
    ds_write_b128 v28, v[176:179] offset:2048
    ds_write_b128 v28, v[180:183] offset:5120
    s_waitcnt lgkmcnt(0)
    s_branch Lpost_3
Lslow_7:
    s_nop 15
    v_max3_f32 v59, v64, v65, v66
    v_max3_f32 v59, v59, v67, v68
    v_max3_f32 v59, v59, v69, v70
    v_max3_f32 v59, v59, v71, v72
    v_max3_f32 v59, v59, v73, v74
    v_max3_f32 v59, v59, v75, v76
    v_max3_f32 v59, v59, v77, v78
    v_max_f32 v59, v59, v79
    v_max3_f32 v60, v80, v81, v82
    v_max3_f32 v60, v60, v83, v84
    v_max3_f32 v60, v60, v85, v86
    v_max3_f32 v60, v60, v87, v88
    v_max3_f32 v60, v60, v89, v90
    v_max3_f32 v60, v60, v91, v92
    v_max3_f32 v60, v60, v93, v94
    v_max_f32 v60, v60, v95
    v_max3_f32 v61, v96, v97, v98
    v_max3_f32 v61, v61, v99, v100
    v_max3_f32 v61, v61, v101, v102
    v_max3_f32 v61, v61, v103, v104
    v_max3_f32 v61, v61, v105, v106
    v_max3_f32 v61, v61, v107, v108
    v_max3_f32 v61, v61, v109, v110
    v_max_f32 v61, v61, v111
    s_waitcnt lgkmcnt(0)
    s_barrier
    ds_write_b32 v48, v59 offset:0
    ds_write_b32 v48, v60 offset:1024
    ds_write_b32 v48, v61 offset:2048
    s_waitcnt lgkmcnt(0)
    s_barrier
    ds_write_b32 v6, v7
    ds_read_b128 v[184:187], v49 offset:0
    ds_read_b128 v[188:191], v49 offset:16
    s_waitcnt lgkmcnt(0)
    v_max3_f32 v59, v184, v185, v186
    v_max3_f32 v59, v59, v187, v188
    v_max3_f32 v59, v59, v189, v190
    v_max_f32 v59, v59, v191
    v_mul_f32 v59, s36, v59
    v_max_f32 v59, v59, v50
    v_sub_f32 v60, v50, v59
    v_exp_f32 v60, v60
    v_mov_b32 v50, v59
    v_mul_f32 v53, v53, v60
    v_mul_f32 v112, v112, v60
    v_mul_f32 v113, v113, v60
    v_mul_f32 v114, v114, v60
    v_mul_f32 v115, v115, v60
    v_mul_f32 v116, v116, v60
    v_mul_f32 v117, v117, v60
    v_mul_f32 v118, v118, v60
    v_mul_f32 v119, v119, v60
    v_mul_f32 v120, v120, v60
    v_mul_f32 v121, v121, v60
    v_mul_f32 v122, v122, v60
    v_mul_f32 v123, v123, v60
    v_mul_f32 v124, v124, v60
    v_mul_f32 v125, v125, v60
    v_mul_f32 v126, v126, v60
    v_mul_f32 v127, v127, v60
    ds_read_b128 v[184:187], v49 offset:1024
    ds_read_b128 v[188:191], v49 offset:1040
    s_waitcnt lgkmcnt(0)
    v_max3_f32 v59, v184, v185, v186
    v_max3_f32 v59, v59, v187, v188
    v_max3_f32 v59, v59, v189, v190
    v_max_f32 v59, v59, v191
    v_mul_f32 v59, s36, v59
    v_max_f32 v59, v59, v51
    v_sub_f32 v60, v51, v59
    v_exp_f32 v60, v60
    v_mov_b32 v51, v59
    v_mul_f32 v54, v54, v60
    v_mul_f32 v128, v128, v60
    v_mul_f32 v129, v129, v60
    v_mul_f32 v130, v130, v60
    v_mul_f32 v131, v131, v60
    v_mul_f32 v132, v132, v60
    v_mul_f32 v133, v133, v60
    v_mul_f32 v134, v134, v60
    v_mul_f32 v135, v135, v60
    v_mul_f32 v136, v136, v60
    v_mul_f32 v137, v137, v60
    v_mul_f32 v138, v138, v60
    v_mul_f32 v139, v139, v60
    v_mul_f32 v140, v140, v60
    v_mul_f32 v141, v141, v60
    v_mul_f32 v142, v142, v60
    v_mul_f32 v143, v143, v60
    ds_read_b128 v[184:187], v49 offset:2048
    ds_read_b128 v[188:191], v49 offset:2064
    s_waitcnt lgkmcnt(0)
    v_max3_f32 v59, v184, v185, v186
    v_max3_f32 v59, v59, v187, v188
    v_max3_f32 v59, v59, v189, v190
    v_max_f32 v59, v59, v191
    v_mul_f32 v59, s36, v59
    v_max_f32 v59, v59, v52
    v_sub_f32 v60, v52, v59
    v_exp_f32 v60, v60
    v_mov_b32 v52, v59
    v_mul_f32 v55, v55, v60
    v_mul_f32 v144, v144, v60
    v_mul_f32 v145, v145, v60
    v_mul_f32 v146, v146, v60
    v_mul_f32 v147, v147, v60
    v_mul_f32 v148, v148, v60
    v_mul_f32 v149, v149, v60
    v_mul_f32 v150, v150, v60
    v_mul_f32 v151, v151, v60
    v_mul_f32 v152, v152, v60
    v_mul_f32 v153, v153, v60
    v_mul_f32 v154, v154, v60
    v_mul_f32 v155, v155, v60
    v_mul_f32 v156, v156, v60
    v_mul_f32 v157, v157, v60
    v_mul_f32 v158, v158, v60
    v_mul_f32 v159, v159, v60
    v_fma_f32 v184, v64, s36, -v50
    v_fma_f32 v185, v65, s36, -v50
    v_fma_f32 v186, v66, s36, -v50
    v_fma_f32 v187, v67, s36, -v50
    v_exp_f32 v184, v184
    v_exp_f32 v185, v185
    v_fma_f32 v188, v68, s36, -v50
    v_fma_f32 v189, v69, s36, -v50
    v_exp_f32 v186, v186
    v_exp_f32 v187, v187
    v_add_f32 v56, v184, v185
    v_cvt_pk_bf16_f32 v160, v184, v185
    v_fma_f32 v190, v70, s36, -v50
    v_fma_f32 v191, v71, s36, -v50
    v_exp_f32 v188, v188
    v_exp_f32 v189, v189
    v_add_f32 v56, v56, v186
    v_add_f32 v56, v56, v187
    v_cvt_pk_bf16_f32 v161, v186, v187
    v_fma_f32 v184, v72, s36, -v50
    v_fma_f32 v185, v73, s36, -v50
    v_exp_f32 v190, v190
    v_exp_f32 v191, v191
    v_add_f32 v56, v56, v188
    v_add_f32 v56, v56, v189
    v_cvt_pk_bf16_f32 v162, v188, v189
    v_fma_f32 v186, v74, s36, -v50
    v_fma_f32 v187, v75, s36, -v50
    v_exp_f32 v184, v184
    v_exp_f32 v185, v185
    v_add_f32 v56, v56, v190
    v_add_f32 v56, v56, v191
    v_cvt_pk_bf16_f32 v163, v190, v191
    v_fma_f32 v188, v76, s36, -v50
    v_fma_f32 v189, v77, s36, -v50
    v_exp_f32 v186, v186
    v_exp_f32 v187, v187
    v_add_f32 v56, v56, v184
    v_add_f32 v56, v56, v185
    v_cvt_pk_bf16_f32 v164, v184, v185
    v_fma_f32 v190, v78, s36, -v50
    v_fma_f32 v191, v79, s36, -v50
    v_exp_f32 v188, v188
    v_exp_f32 v189, v189
    v_add_f32 v56, v56, v186
    v_add_f32 v56, v56, v187
    v_cvt_pk_bf16_f32 v165, v186, v187
    v_exp_f32 v190, v190
    v_exp_f32 v191, v191
    v_add_f32 v56, v56, v188
    v_add_f32 v56, v56, v189
    v_cvt_pk_bf16_f32 v166, v188, v189
    v_add_f32 v56, v56, v190
    v_add_f32 v56, v56, v191
    v_cvt_pk_bf16_f32 v167, v190, v191
    v_fma_f32 v192, v80, s36, -v51
    v_fma_f32 v193, v81, s36, -v51
    v_fma_f32 v194, v82, s36, -v51
    v_fma_f32 v195, v83, s36, -v51
    v_exp_f32 v192, v192
    v_exp_f32 v193, v193
    v_fma_f32 v196, v84, s36, -v51
    v_fma_f32 v197, v85, s36, -v51
    v_exp_f32 v194, v194
    v_exp_f32 v195, v195
    v_add_f32 v57, v192, v193
    v_cvt_pk_bf16_f32 v168, v192, v193
    v_fma_f32 v198, v86, s36, -v51
    v_fma_f32 v199, v87, s36, -v51
    v_exp_f32 v196, v196
    v_exp_f32 v197, v197
    v_add_f32 v57, v57, v194
    v_add_f32 v57, v57, v195
    v_cvt_pk_bf16_f32 v169, v194, v195
    v_fma_f32 v192, v88, s36, -v51
    v_fma_f32 v193, v89, s36, -v51
    v_exp_f32 v198, v198
    v_exp_f32 v199, v199
    v_add_f32 v57, v57, v196
    v_add_f32 v57, v57, v197
    v_cvt_pk_bf16_f32 v170, v196, v197
    v_fma_f32 v194, v90, s36, -v51
    v_fma_f32 v195, v91, s36, -v51
    v_exp_f32 v192, v192
    v_exp_f32 v193, v193
    v_add_f32 v57, v57, v198
    v_add_f32 v57, v57, v199
    v_cvt_pk_bf16_f32 v171, v198, v199
    v_fma_f32 v196, v92, s36, -v51
    v_fma_f32 v197, v93, s36, -v51
    v_exp_f32 v194, v194
    v_exp_f32 v195, v195
    v_add_f32 v57, v57, v192
    v_add_f32 v57, v57, v193
    v_cvt_pk_bf16_f32 v172, v192, v193
    v_fma_f32 v198, v94, s36, -v51
    v_fma_f32 v199, v95, s36, -v51
    v_exp_f32 v196, v196
    v_exp_f32 v197, v197
    v_add_f32 v57, v57, v194
    v_add_f32 v57, v57, v195
    v_cvt_pk_bf16_f32 v173, v194, v195
    v_exp_f32 v198, v198
    v_exp_f32 v199, v199
    v_add_f32 v57, v57, v196
    v_add_f32 v57, v57, v197
    v_cvt_pk_bf16_f32 v174, v196, v197
    v_add_f32 v57, v57, v198
    v_add_f32 v57, v57, v199
    v_cvt_pk_bf16_f32 v175, v198, v199
    v_fma_f32 v184, v96, s36, -v52
    v_fma_f32 v185, v97, s36, -v52
    v_fma_f32 v186, v98, s36, -v52
    v_fma_f32 v187, v99, s36, -v52
    v_exp_f32 v184, v184
    v_exp_f32 v185, v185
    v_fma_f32 v188, v100, s36, -v52
    v_fma_f32 v189, v101, s36, -v52
    v_exp_f32 v186, v186
    v_exp_f32 v187, v187
    v_add_f32 v58, v184, v185
    v_cvt_pk_bf16_f32 v176, v184, v185
    v_fma_f32 v190, v102, s36, -v52
    v_fma_f32 v191, v103, s36, -v52
    v_exp_f32 v188, v188
    v_exp_f32 v189, v189
    v_add_f32 v58, v58, v186
    v_add_f32 v58, v58, v187
    v_cvt_pk_bf16_f32 v177, v186, v187
    v_fma_f32 v184, v104, s36, -v52
    v_fma_f32 v185, v105, s36, -v52
    v_exp_f32 v190, v190
    v_exp_f32 v191, v191
    v_add_f32 v58, v58, v188
    v_add_f32 v58, v58, v189
    v_cvt_pk_bf16_f32 v178, v188, v189
    v_fma_f32 v186, v106, s36, -v52
    v_fma_f32 v187, v107, s36, -v52
    v_exp_f32 v184, v184
    v_exp_f32 v185, v185
    v_add_f32 v58, v58, v190
    v_add_f32 v58, v58, v191
    v_cvt_pk_bf16_f32 v179, v190, v191
    v_fma_f32 v188, v108, s36, -v52
    v_fma_f32 v189, v109, s36, -v52
    v_exp_f32 v186, v186
    v_exp_f32 v187, v187
    v_add_f32 v58, v58, v184
    v_add_f32 v58, v58, v185
    v_cvt_pk_bf16_f32 v180, v184, v185
    v_fma_f32 v190, v110, s36, -v52
    v_fma_f32 v191, v111, s36, -v52
    v_exp_f32 v188, v188
    v_exp_f32 v189, v189
    v_add_f32 v58, v58, v186
    v_add_f32 v58, v58, v187
    v_cvt_pk_bf16_f32 v181, v186, v187
    v_exp_f32 v190, v190
    v_exp_f32 v191, v191
    v_add_f32 v58, v58, v188
    v_add_f32 v58, v58, v189
    v_cvt_pk_bf16_f32 v182, v188, v189
    v_add_f32 v58, v58, v190
    v_add_f32 v58, v58, v191
    v_cvt_pk_bf16_f32 v183, v190, v191
    ds_write_b128 v28, v[160:163] offset:0
    ds_write_b128 v28, v[164:167] offset:3072
    ds_write_b128 v28, v[168:171] offset:1024
    ds_write_b128 v28, v[172:175] offset:4096
    ds_write_b128 v28, v[176:179] offset:2048
    ds_write_b128 v28, v[180:183] offset:5120
    s_waitcnt lgkmcnt(0)
    s_branch Lpost_6
Lslow_35:
    s_nop 15
    v_max3_f32 v59, v64, v65, v66
    v_max3_f32 v59, v59, v67, v68
    v_max3_f32 v59, v59, v69, v70
    v_max3_f32 v59, v59, v71, v72
    v_max3_f32 v59, v59, v73, v74
    v_max3_f32 v59, v59, v75, v76
    v_max3_f32 v59, v59, v77, v78
    v_max_f32 v59, v59, v79
    v_max3_f32 v60, v80, v81, v82
    v_max3_f32 v60, v60, v83, v84
    v_max3_f32 v60, v60, v85, v86
    v_max3_f32 v60, v60, v87, v88
    v_max3_f32 v60, v60, v89, v90
    v_max3_f32 v60, v60, v91, v92
    v_max3_f32 v60, v60, v93, v94
    v_max_f32 v60, v60, v95
    v_max3_f32 v61, v96, v97, v98
    v_max3_f32 v61, v61, v99, v100
    v_max3_f32 v61, v61, v101, v102
    v_max3_f32 v61, v61, v103, v104
    v_max3_f32 v61, v61, v105, v106
    v_max3_f32 v61, v61, v107, v108
    v_max3_f32 v61, v61, v109, v110
    v_max_f32 v61, v61, v111
    s_waitcnt lgkmcnt(0)
    s_barrier
    ds_write_b32 v48, v59 offset:0
    ds_write_b32 v48, v60 offset:1024
    ds_write_b32 v48, v61 offset:2048
    s_waitcnt lgkmcnt(0)
    s_barrier
    ds_write_b32 v6, v7
    ds_read_b128 v[184:187], v49 offset:0
    ds_read_b128 v[188:191], v49 offset:16
    s_waitcnt lgkmcnt(0)
    v_max3_f32 v59, v184, v185, v186
    v_max3_f32 v59, v59, v187, v188
    v_max3_f32 v59, v59, v189, v190
    v_max_f32 v59, v59, v191
    v_mul_f32 v59, s36, v59
    v_max_f32 v59, v59, v50
    v_sub_f32 v60, v50, v59
    v_exp_f32 v60, v60
    v_mov_b32 v50, v59
    v_mul_f32 v53, v53, v60
    v_mul_f32 v112, v112, v60
    v_mul_f32 v113, v113, v60
    v_mul_f32 v114, v114, v60
    v_mul_f32 v115, v115, v60
    v_mul_f32 v116, v116, v60
    v_mul_f32 v117, v117, v60
    v_mul_f32 v118, v118, v60
    v_mul_f32 v119, v119, v60
    v_mul_f32 v120, v120, v60
    v_mul_f32 v121, v121, v60
    v_mul_f32 v122, v122, v60
    v_mul_f32 v123, v123, v60
    v_mul_f32 v124, v124, v60
    v_mul_f32 v125, v125, v60
    v_mul_f32 v126, v126, v60
    v_mul_f32 v127, v127, v60
    ds_read_b128 v[184:187], v49 offset:1024
    ds_read_b128 v[188:191], v49 offset:1040
    s_waitcnt lgkmcnt(0)
    v_max3_f32 v59, v184, v185, v186
    v_max3_f32 v59, v59, v187, v188
    v_max3_f32 v59, v59, v189, v190
    v_max_f32 v59, v59, v191
    v_mul_f32 v59, s36, v59
    v_max_f32 v59, v59, v51
    v_sub_f32 v60, v51, v59
    v_exp_f32 v60, v60
    v_mov_b32 v51, v59
    v_mul_f32 v54, v54, v60
    v_mul_f32 v128, v128, v60
    v_mul_f32 v129, v129, v60
    v_mul_f32 v130, v130, v60
    v_mul_f32 v131, v131, v60
    v_mul_f32 v132, v132, v60
    v_mul_f32 v133, v133, v60
    v_mul_f32 v134, v134, v60
    v_mul_f32 v135, v135, v60
    v_mul_f32 v136, v136, v60
    v_mul_f32 v137, v137, v60
    v_mul_f32 v138, v138, v60
    v_mul_f32 v139, v139, v60
    v_mul_f32 v140, v140, v60
    v_mul_f32 v141, v141, v60
    v_mul_f32 v142, v142, v60
    v_mul_f32 v143, v143, v60
    ds_read_b128 v[184:187], v49 offset:2048
    ds_read_b128 v[188:191], v49 offset:2064
    s_waitcnt lgkmcnt(0)
    v_max3_f32 v59, v184, v185, v186
    v_max3_f32 v59, v59, v187, v188
    v_max3_f32 v59, v59, v189, v190
    v_max_f32 v59, v59, v191
    v_mul_f32 v59, s36, v59
    v_max_f32 v59, v59, v52
    v_sub_f32 v60, v52, v59
    v_exp_f32 v60, v60
    v_mov_b32 v52, v59
    v_mul_f32 v55, v55, v60
    v_mul_f32 v144, v144, v60
    v_mul_f32 v145, v145, v60
    v_mul_f32 v146, v146, v60
    v_mul_f32 v147, v147, v60
    v_mul_f32 v148, v148, v60
    v_mul_f32 v149, v149, v60
    v_mul_f32 v150, v150, v60
    v_mul_f32 v151, v151, v60
    v_mul_f32 v152, v152, v60
    v_mul_f32 v153, v153, v60
    v_mul_f32 v154, v154, v60
    v_mul_f32 v155, v155, v60
    v_mul_f32 v156, v156, v60
    v_mul_f32 v157, v157, v60
    v_mul_f32 v158, v158, v60
    v_mul_f32 v159, v159, v60
    v_fma_f32 v184, v64, s36, -v50
    v_fma_f32 v185, v65, s36, -v50
    v_fma_f32 v186, v66, s36, -v50
    v_fma_f32 v187, v67, s36, -v50
    v_exp_f32 v184, v184
    v_exp_f32 v185, v185
    v_fma_f32 v188, v68, s36, -v50
    v_fma_f32 v189, v69, s36, -v50
    v_exp_f32 v186, v186
    v_exp_f32 v187, v187
    v_add_f32 v56, v184, v185
    v_cvt_pk_bf16_f32 v160, v184, v185
    v_fma_f32 v190, v70, s36, -v50
    v_fma_f32 v191, v71, s36, -v50
    v_exp_f32 v188, v188
    v_exp_f32 v189, v189
    v_add_f32 v56, v56, v186
    v_add_f32 v56, v56, v187
    v_cvt_pk_bf16_f32 v161, v186, v187
    v_fma_f32 v184, v72, s36, -v50
    v_fma_f32 v185, v73, s36, -v50
    v_exp_f32 v190, v190
    v_exp_f32 v191, v191
    v_add_f32 v56, v56, v188
    v_add_f32 v56, v56, v189
    v_cvt_pk_bf16_f32 v162, v188, v189
    v_fma_f32 v186, v74, s36, -v50
    v_fma_f32 v187, v75, s36, -v50
    v_exp_f32 v184, v184
    v_exp_f32 v185, v185
    v_add_f32 v56, v56, v190
    v_add_f32 v56, v56, v191
    v_cvt_pk_bf16_f32 v163, v190, v191
    v_fma_f32 v188, v76, s36, -v50
    v_fma_f32 v189, v77, s36, -v50
    v_exp_f32 v186, v186
    v_exp_f32 v187, v187
    v_add_f32 v56, v56, v184
    v_add_f32 v56, v56, v185
    v_cvt_pk_bf16_f32 v164, v184, v185
    v_fma_f32 v190, v78, s36, -v50
    v_fma_f32 v191, v79, s36, -v50
    v_exp_f32 v188, v188
    v_exp_f32 v189, v189
    v_add_f32 v56, v56, v186
    v_add_f32 v56, v56, v187
    v_cvt_pk_bf16_f32 v165, v186, v187
    v_exp_f32 v190, v190
    v_exp_f32 v191, v191
    v_add_f32 v56, v56, v188
    v_add_f32 v56, v56, v189
    v_cvt_pk_bf16_f32 v166, v188, v189
    v_add_f32 v56, v56, v190
    v_add_f32 v56, v56, v191
    v_cvt_pk_bf16_f32 v167, v190, v191
    v_fma_f32 v192, v80, s36, -v51
    v_fma_f32 v193, v81, s36, -v51
    v_fma_f32 v194, v82, s36, -v51
    v_fma_f32 v195, v83, s36, -v51
    v_exp_f32 v192, v192
    v_exp_f32 v193, v193
    v_fma_f32 v196, v84, s36, -v51
    v_fma_f32 v197, v85, s36, -v51
    v_exp_f32 v194, v194
    v_exp_f32 v195, v195
    v_add_f32 v57, v192, v193
    v_cvt_pk_bf16_f32 v168, v192, v193
    v_fma_f32 v198, v86, s36, -v51
    v_fma_f32 v199, v87, s36, -v51
    v_exp_f32 v196, v196
    v_exp_f32 v197, v197
    v_add_f32 v57, v57, v194
    v_add_f32 v57, v57, v195
    v_cvt_pk_bf16_f32 v169, v194, v195
    v_fma_f32 v192, v88, s36, -v51
    v_fma_f32 v193, v89, s36, -v51
    v_exp_f32 v198, v198
    v_exp_f32 v199, v199
    v_add_f32 v57, v57, v196
    v_add_f32 v57, v57, v197
    v_cvt_pk_bf16_f32 v170, v196, v197
    v_fma_f32 v194, v90, s36, -v51
    v_fma_f32 v195, v91, s36, -v51
    v_exp_f32 v192, v192
    v_exp_f32 v193, v193
    v_add_f32 v57, v57, v198
    v_add_f32 v57, v57, v199
    v_cvt_pk_bf16_f32 v171, v198, v199
    v_fma_f32 v196, v92, s36, -v51
    v_fma_f32 v197, v93, s36, -v51
    v_exp_f32 v194, v194
    v_exp_f32 v195, v195
    v_add_f32 v57, v57, v192
    v_add_f32 v57, v57, v193
    v_cvt_pk_bf16_f32 v172, v192, v193
    v_fma_f32 v198, v94, s36, -v51
    v_fma_f32 v199, v95, s36, -v51
    v_exp_f32 v196, v196
    v_exp_f32 v197, v197
    v_add_f32 v57, v57, v194
    v_add_f32 v57, v57, v195
    v_cvt_pk_bf16_f32 v173, v194, v195
    v_exp_f32 v198, v198
    v_exp_f32 v199, v199
    v_add_f32 v57, v57, v196
    v_add_f32 v57, v57, v197
    v_cvt_pk_bf16_f32 v174, v196, v197
    v_add_f32 v57, v57, v198
    v_add_f32 v57, v57, v199
    v_cvt_pk_bf16_f32 v175, v198, v199
    v_fma_f32 v184, v96, s36, -v52
    v_fma_f32 v185, v97, s36, -v52
    v_fma_f32 v186, v98, s36, -v52
    v_fma_f32 v187, v99, s36, -v52
    v_exp_f32 v184, v184
    v_exp_f32 v185, v185
    v_fma_f32 v188, v100, s36, -v52
    v_fma_f32 v189, v101, s36, -v52
    v_exp_f32 v186, v186
    v_exp_f32 v187, v187
    v_add_f32 v58, v184, v185
    v_cvt_pk_bf16_f32 v176, v184, v185
    v_fma_f32 v190, v102, s36, -v52
    v_fma_f32 v191, v103, s36, -v52
    v_exp_f32 v188, v188
    v_exp_f32 v189, v189
    v_add_f32 v58, v58, v186
    v_add_f32 v58, v58, v187
    v_cvt_pk_bf16_f32 v177, v186, v187
    v_fma_f32 v184, v104, s36, -v52
    v_fma_f32 v185, v105, s36, -v52
    v_exp_f32 v190, v190
    v_exp_f32 v191, v191
    v_add_f32 v58, v58, v188
    v_add_f32 v58, v58, v189
    v_cvt_pk_bf16_f32 v178, v188, v189
    v_fma_f32 v186, v106, s36, -v52
    v_fma_f32 v187, v107, s36, -v52
    v_exp_f32 v184, v184
    v_exp_f32 v185, v185
    v_add_f32 v58, v58, v190
    v_add_f32 v58, v58, v191
    v_cvt_pk_bf16_f32 v179, v190, v191
    v_fma_f32 v188, v108, s36, -v52
    v_fma_f32 v189, v109, s36, -v52
    v_exp_f32 v186, v186
    v_exp_f32 v187, v187
    v_add_f32 v58, v58, v184
    v_add_f32 v58, v58, v185
    v_cvt_pk_bf16_f32 v180, v184, v185
    v_fma_f32 v190, v110, s36, -v52
    v_fma_f32 v191, v111, s36, -v52
    v_exp_f32 v188, v188
    v_exp_f32 v189, v189
    v_add_f32 v58, v58, v186
    v_add_f32 v58, v58, v187
    v_cvt_pk_bf16_f32 v181, v186, v187
    v_exp_f32 v190, v190
    v_exp_f32 v191, v191
    v_add_f32 v58, v58, v188
    v_add_f32 v58, v58, v189
    v_cvt_pk_bf16_f32 v182, v188, v189
    v_add_f32 v58, v58, v190
    v_add_f32 v58, v58, v191
    v_cvt_pk_bf16_f32 v183, v190, v191
    ds_write_b128 v28, v[160:163] offset:0
    ds_write_b128 v28, v[164:167] offset:3072
    ds_write_b128 v28, v[168:171] offset:1024
    ds_write_b128 v28, v[172:175] offset:4096
    ds_write_b128 v28, v[176:179] offset:2048
    ds_write_b128 v28, v[180:183] offset:5120
    s_waitcnt lgkmcnt(0)
    s_branch Lpost_34
Lslow_38:
    s_nop 15
    v_max3_f32 v59, v64, v65, v66
    v_max3_f32 v59, v59, v67, v68
    v_max3_f32 v59, v59, v69, v70
    v_max3_f32 v59, v59, v71, v72
    v_max3_f32 v59, v59, v73, v74
    v_max3_f32 v59, v59, v75, v76
    v_max3_f32 v59, v59, v77, v78
    v_max_f32 v59, v59, v79
    v_max3_f32 v60, v80, v81, v82
    v_max3_f32 v60, v60, v83, v84
    v_max3_f32 v60, v60, v85, v86
    v_max3_f32 v60, v60, v87, v88
    v_max3_f32 v60, v60, v89, v90
    v_max3_f32 v60, v60, v91, v92
    v_max3_f32 v60, v60, v93, v94
    v_max_f32 v60, v60, v95
    v_max3_f32 v61, v96, v97, v98
    v_max3_f32 v61, v61, v99, v100
    v_max3_f32 v61, v61, v101, v102
    v_max3_f32 v61, v61, v103, v104
    v_max3_f32 v61, v61, v105, v106
    v_max3_f32 v61, v61, v107, v108
    v_max3_f32 v61, v61, v109, v110
    v_max_f32 v61, v61, v111
    s_waitcnt lgkmcnt(0)
    s_barrier
    ds_write_b32 v48, v59 offset:0
    ds_write_b32 v48, v60 offset:1024
    ds_write_b32 v48, v61 offset:2048
    s_waitcnt lgkmcnt(0)
    s_barrier
    ds_write_b32 v6, v7
    ds_read_b128 v[184:187], v49 offset:0
    ds_read_b128 v[188:191], v49 offset:16
    s_waitcnt lgkmcnt(0)
    v_max3_f32 v59, v184, v185, v186
    v_max3_f32 v59, v59, v187, v188
    v_max3_f32 v59, v59, v189, v190
    v_max_f32 v59, v59, v191
    v_mul_f32 v59, s36, v59
    v_max_f32 v59, v59, v50
    v_sub_f32 v60, v50, v59
    v_exp_f32 v60, v60
    v_mov_b32 v50, v59
    v_mul_f32 v53, v53, v60
    v_mul_f32 v112, v112, v60
    v_mul_f32 v113, v113, v60
    v_mul_f32 v114, v114, v60
    v_mul_f32 v115, v115, v60
    v_mul_f32 v116, v116, v60
    v_mul_f32 v117, v117, v60
    v_mul_f32 v118, v118, v60
    v_mul_f32 v119, v119, v60
    v_mul_f32 v120, v120, v60
    v_mul_f32 v121, v121, v60
    v_mul_f32 v122, v122, v60
    v_mul_f32 v123, v123, v60
    v_mul_f32 v124, v124, v60
    v_mul_f32 v125, v125, v60
    v_mul_f32 v126, v126, v60
    v_mul_f32 v127, v127, v60
    ds_read_b128 v[184:187], v49 offset:1024
    ds_read_b128 v[188:191], v49 offset:1040
    s_waitcnt lgkmcnt(0)
    v_max3_f32 v59, v184, v185, v186
    v_max3_f32 v59, v59, v187, v188
    v_max3_f32 v59, v59, v189, v190
    v_max_f32 v59, v59, v191
    v_mul_f32 v59, s36, v59
    v_max_f32 v59, v59, v51
    v_sub_f32 v60, v51, v59
    v_exp_f32 v60, v60
    v_mov_b32 v51, v59
    v_mul_f32 v54, v54, v60
    v_mul_f32 v128, v128, v60
    v_mul_f32 v129, v129, v60
    v_mul_f32 v130, v130, v60
    v_mul_f32 v131, v131, v60
    v_mul_f32 v132, v132, v60
    v_mul_f32 v133, v133, v60
    v_mul_f32 v134, v134, v60
    v_mul_f32 v135, v135, v60
    v_mul_f32 v136, v136, v60
    v_mul_f32 v137, v137, v60
    v_mul_f32 v138, v138, v60
    v_mul_f32 v139, v139, v60
    v_mul_f32 v140, v140, v60
    v_mul_f32 v141, v141, v60
    v_mul_f32 v142, v142, v60
    v_mul_f32 v143, v143, v60
    ds_read_b128 v[184:187], v49 offset:2048
    ds_read_b128 v[188:191], v49 offset:2064
    s_waitcnt lgkmcnt(0)
    v_max3_f32 v59, v184, v185, v186
    v_max3_f32 v59, v59, v187, v188
    v_max3_f32 v59, v59, v189, v190
    v_max_f32 v59, v59, v191
    v_mul_f32 v59, s36, v59
    v_max_f32 v59, v59, v52
    v_sub_f32 v60, v52, v59
    v_exp_f32 v60, v60
    v_mov_b32 v52, v59
    v_mul_f32 v55, v55, v60
    v_mul_f32 v144, v144, v60
    v_mul_f32 v145, v145, v60
    v_mul_f32 v146, v146, v60
    v_mul_f32 v147, v147, v60
    v_mul_f32 v148, v148, v60
    v_mul_f32 v149, v149, v60
    v_mul_f32 v150, v150, v60
    v_mul_f32 v151, v151, v60
    v_mul_f32 v152, v152, v60
    v_mul_f32 v153, v153, v60
    v_mul_f32 v154, v154, v60
    v_mul_f32 v155, v155, v60
    v_mul_f32 v156, v156, v60
    v_mul_f32 v157, v157, v60
    v_mul_f32 v158, v158, v60
    v_mul_f32 v159, v159, v60
    v_fma_f32 v184, v64, s36, -v50
    v_fma_f32 v185, v65, s36, -v50
    v_fma_f32 v186, v66, s36, -v50
    v_fma_f32 v187, v67, s36, -v50
    v_exp_f32 v184, v184
    v_exp_f32 v185, v185
    v_fma_f32 v188, v68, s36, -v50
    v_fma_f32 v189, v69, s36, -v50
    v_exp_f32 v186, v186
    v_exp_f32 v187, v187
    v_add_f32 v56, v184, v185
    v_cvt_pk_bf16_f32 v160, v184, v185
    v_fma_f32 v190, v70, s36, -v50
    v_fma_f32 v191, v71, s36, -v50
    v_exp_f32 v188, v188
    v_exp_f32 v189, v189
    v_add_f32 v56, v56, v186
    v_add_f32 v56, v56, v187
    v_cvt_pk_bf16_f32 v161, v186, v187
    v_fma_f32 v184, v72, s36, -v50
    v_fma_f32 v185, v73, s36, -v50
    v_exp_f32 v190, v190
    v_exp_f32 v191, v191
    v_add_f32 v56, v56, v188
    v_add_f32 v56, v56, v189
    v_cvt_pk_bf16_f32 v162, v188, v189
    v_fma_f32 v186, v74, s36, -v50
    v_fma_f32 v187, v75, s36, -v50
    v_exp_f32 v184, v184
    v_exp_f32 v185, v185
    v_add_f32 v56, v56, v190
    v_add_f32 v56, v56, v191
    v_cvt_pk_bf16_f32 v163, v190, v191
    v_fma_f32 v188, v76, s36, -v50
    v_fma_f32 v189, v77, s36, -v50
    v_exp_f32 v186, v186
    v_exp_f32 v187, v187
    v_add_f32 v56, v56, v184
    v_add_f32 v56, v56, v185
    v_cvt_pk_bf16_f32 v164, v184, v185
    v_fma_f32 v190, v78, s36, -v50
    v_fma_f32 v191, v79, s36, -v50
    v_exp_f32 v188, v188
    v_exp_f32 v189, v189
    v_add_f32 v56, v56, v186
    v_add_f32 v56, v56, v187
    v_cvt_pk_bf16_f32 v165, v186, v187
    v_exp_f32 v190, v190
    v_exp_f32 v191, v191
    v_add_f32 v56, v56, v188
    v_add_f32 v56, v56, v189
    v_cvt_pk_bf16_f32 v166, v188, v189
    v_add_f32 v56, v56, v190
    v_add_f32 v56, v56, v191
    v_cvt_pk_bf16_f32 v167, v190, v191
    v_fma_f32 v192, v80, s36, -v51
    v_fma_f32 v193, v81, s36, -v51
    v_fma_f32 v194, v82, s36, -v51
    v_fma_f32 v195, v83, s36, -v51
    v_exp_f32 v192, v192
    v_exp_f32 v193, v193
    v_fma_f32 v196, v84, s36, -v51
    v_fma_f32 v197, v85, s36, -v51
    v_exp_f32 v194, v194
    v_exp_f32 v195, v195
    v_add_f32 v57, v192, v193
    v_cvt_pk_bf16_f32 v168, v192, v193
    v_fma_f32 v198, v86, s36, -v51
    v_fma_f32 v199, v87, s36, -v51
    v_exp_f32 v196, v196
    v_exp_f32 v197, v197
    v_add_f32 v57, v57, v194
    v_add_f32 v57, v57, v195
    v_cvt_pk_bf16_f32 v169, v194, v195
    v_fma_f32 v192, v88, s36, -v51
    v_fma_f32 v193, v89, s36, -v51
    v_exp_f32 v198, v198
    v_exp_f32 v199, v199
    v_add_f32 v57, v57, v196
    v_add_f32 v57, v57, v197
    v_cvt_pk_bf16_f32 v170, v196, v197
    v_fma_f32 v194, v90, s36, -v51
    v_fma_f32 v195, v91, s36, -v51
    v_exp_f32 v192, v192
    v_exp_f32 v193, v193
    v_add_f32 v57, v57, v198
    v_add_f32 v57, v57, v199
    v_cvt_pk_bf16_f32 v171, v198, v199
    v_fma_f32 v196, v92, s36, -v51
    v_fma_f32 v197, v93, s36, -v51
    v_exp_f32 v194, v194
    v_exp_f32 v195, v195
    v_add_f32 v57, v57, v192
    v_add_f32 v57, v57, v193
    v_cvt_pk_bf16_f32 v172, v192, v193
    v_fma_f32 v198, v94, s36, -v51
    v_fma_f32 v199, v95, s36, -v51
    v_exp_f32 v196, v196
    v_exp_f32 v197, v197
    v_add_f32 v57, v57, v194
    v_add_f32 v57, v57, v195
    v_cvt_pk_bf16_f32 v173, v194, v195
    v_exp_f32 v198, v198
    v_exp_f32 v199, v199
    v_add_f32 v57, v57, v196
    v_add_f32 v57, v57, v197
    v_cvt_pk_bf16_f32 v174, v196, v197
    v_add_f32 v57, v57, v198
    v_add_f32 v57, v57, v199
    v_cvt_pk_bf16_f32 v175, v198, v199
    v_fma_f32 v184, v96, s36, -v52
    v_fma_f32 v185, v97, s36, -v52
    v_fma_f32 v186, v98, s36, -v52
    v_fma_f32 v187, v99, s36, -v52
    v_exp_f32 v184, v184
    v_exp_f32 v185, v185
    v_fma_f32 v188, v100, s36, -v52
    v_fma_f32 v189, v101, s36, -v52
    v_exp_f32 v186, v186
    v_exp_f32 v187, v187
    v_add_f32 v58, v184, v185
    v_cvt_pk_bf16_f32 v176, v184, v185
    v_fma_f32 v190, v102, s36, -v52
    v_fma_f32 v191, v103, s36, -v52
    v_exp_f32 v188, v188
    v_exp_f32 v189, v189
    v_add_f32 v58, v58, v186
    v_add_f32 v58, v58, v187
    v_cvt_pk_bf16_f32 v177, v186, v187
    v_fma_f32 v184, v104, s36, -v52
    v_fma_f32 v185, v105, s36, -v52
    v_exp_f32 v190, v190
    v_exp_f32 v191, v191
    v_add_f32 v58, v58, v188
    v_add_f32 v58, v58, v189
    v_cvt_pk_bf16_f32 v178, v188, v189
    v_fma_f32 v186, v106, s36, -v52
    v_fma_f32 v187, v107, s36, -v52
    v_exp_f32 v184, v184
    v_exp_f32 v185, v185
    v_add_f32 v58, v58, v190
    v_add_f32 v58, v58, v191
    v_cvt_pk_bf16_f32 v179, v190, v191
    v_fma_f32 v188, v108, s36, -v52
    v_fma_f32 v189, v109, s36, -v52
    v_exp_f32 v186, v186
    v_exp_f32 v187, v187
    v_add_f32 v58, v58, v184
    v_add_f32 v58, v58, v185
    v_cvt_pk_bf16_f32 v180, v184, v185
    v_fma_f32 v190, v110, s36, -v52
    v_fma_f32 v191, v111, s36, -v52
    v_exp_f32 v188, v188
    v_exp_f32 v189, v189
    v_add_f32 v58, v58, v186
    v_add_f32 v58, v58, v187
    v_cvt_pk_bf16_f32 v181, v186, v187
    v_exp_f32 v190, v190
    v_exp_f32 v191, v191
    v_add_f32 v58, v58, v188
    v_add_f32 v58, v58, v189
    v_cvt_pk_bf16_f32 v182, v188, v189
    v_add_f32 v58, v58, v190
    v_add_f32 v58, v58, v191
    v_cvt_pk_bf16_f32 v183, v190, v191
    ds_write_b128 v28, v[160:163] offset:0
    ds_write_b128 v28, v[164:167] offset:3072
    ds_write_b128 v28, v[168:171] offset:1024
    ds_write_b128 v28, v[172:175] offset:4096
    ds_write_b128 v28, v[176:179] offset:2048
    ds_write_b128 v28, v[180:183] offset:5120
    s_waitcnt lgkmcnt(0)
    s_branch Lpost_37
Lslow_41:
    s_nop 15
    v_max3_f32 v59, v64, v65, v66
    v_max3_f32 v59, v59, v67, v68
    v_max3_f32 v59, v59, v69, v70
    v_max3_f32 v59, v59, v71, v72
    v_max3_f32 v59, v59, v73, v74
    v_max3_f32 v59, v59, v75, v76
    v_max3_f32 v59, v59, v77, v78
    v_max_f32 v59, v59, v79
    v_max3_f32 v60, v80, v81, v82
    v_max3_f32 v60, v60, v83, v84
    v_max3_f32 v60, v60, v85, v86
    v_max3_f32 v60, v60, v87, v88
    v_max3_f32 v60, v60, v89, v90
    v_max3_f32 v60, v60, v91, v92
    v_max3_f32 v60, v60, v93, v94
    v_max_f32 v60, v60, v95
    v_max3_f32 v61, v96, v97, v98
    v_max3_f32 v61, v61, v99, v100
    v_max3_f32 v61, v61, v101, v102
    v_max3_f32 v61, v61, v103, v104
    v_max3_f32 v61, v61, v105, v106
    v_max3_f32 v61, v61, v107, v108
    v_max3_f32 v61, v61, v109, v110
    v_max_f32 v61, v61, v111
    s_waitcnt lgkmcnt(0)
    s_barrier
    ds_write_b32 v48, v59 offset:0
    ds_write_b32 v48, v60 offset:1024
    ds_write_b32 v48, v61 offset:2048
    s_waitcnt lgkmcnt(0)
    s_barrier
    ds_write_b32 v6, v7
    ds_read_b128 v[184:187], v49 offset:0
    ds_read_b128 v[188:191], v49 offset:16
    s_waitcnt lgkmcnt(0)
    v_max3_f32 v59, v184, v185, v186
    v_max3_f32 v59, v59, v187, v188
    v_max3_f32 v59, v59, v189, v190
    v_max_f32 v59, v59, v191
    v_mul_f32 v59, s36, v59
    v_max_f32 v59, v59, v50
    v_sub_f32 v60, v50, v59
    v_exp_f32 v60, v60
    v_mov_b32 v50, v59
    v_mul_f32 v53, v53, v60
    v_mul_f32 v112, v112, v60
    v_mul_f32 v113, v113, v60
    v_mul_f32 v114, v114, v60
    v_mul_f32 v115, v115, v60
    v_mul_f32 v116, v116, v60
    v_mul_f32 v117, v117, v60
    v_mul_f32 v118, v118, v60
    v_mul_f32 v119, v119, v60
    v_mul_f32 v120, v120, v60
    v_mul_f32 v121, v121, v60
    v_mul_f32 v122, v122, v60
    v_mul_f32 v123, v123, v60
    v_mul_f32 v124, v124, v60
    v_mul_f32 v125, v125, v60
    v_mul_f32 v126, v126, v60
    v_mul_f32 v127, v127, v60
    ds_read_b128 v[184:187], v49 offset:1024
    ds_read_b128 v[188:191], v49 offset:1040
    s_waitcnt lgkmcnt(0)
    v_max3_f32 v59, v184, v185, v186
    v_max3_f32 v59, v59, v187, v188
    v_max3_f32 v59, v59, v189, v190
    v_max_f32 v59, v59, v191
    v_mul_f32 v59, s36, v59
    v_max_f32 v59, v59, v51
    v_sub_f32 v60, v51, v59
    v_exp_f32 v60, v60
    v_mov_b32 v51, v59
    v_mul_f32 v54, v54, v60
    v_mul_f32 v128, v128, v60
    v_mul_f32 v129, v129, v60
    v_mul_f32 v130, v130, v60
    v_mul_f32 v131, v131, v60
    v_mul_f32 v132, v132, v60
    v_mul_f32 v133, v133, v60
    v_mul_f32 v134, v134, v60
    v_mul_f32 v135, v135, v60
    v_mul_f32 v136, v136, v60
    v_mul_f32 v137, v137, v60
    v_mul_f32 v138, v138, v60
    v_mul_f32 v139, v139, v60
    v_mul_f32 v140, v140, v60
    v_mul_f32 v141, v141, v60
    v_mul_f32 v142, v142, v60
    v_mul_f32 v143, v143, v60
    ds_read_b128 v[184:187], v49 offset:2048
    ds_read_b128 v[188:191], v49 offset:2064
    s_waitcnt lgkmcnt(0)
    v_max3_f32 v59, v184, v185, v186
    v_max3_f32 v59, v59, v187, v188
    v_max3_f32 v59, v59, v189, v190
    v_max_f32 v59, v59, v191
    v_mul_f32 v59, s36, v59
    v_max_f32 v59, v59, v52
    v_sub_f32 v60, v52, v59
    v_exp_f32 v60, v60
    v_mov_b32 v52, v59
    v_mul_f32 v55, v55, v60
    v_mul_f32 v144, v144, v60
    v_mul_f32 v145, v145, v60
    v_mul_f32 v146, v146, v60
    v_mul_f32 v147, v147, v60
    v_mul_f32 v148, v148, v60
    v_mul_f32 v149, v149, v60
    v_mul_f32 v150, v150, v60
    v_mul_f32 v151, v151, v60
    v_mul_f32 v152, v152, v60
    v_mul_f32 v153, v153, v60
    v_mul_f32 v154, v154, v60
    v_mul_f32 v155, v155, v60
    v_mul_f32 v156, v156, v60
    v_mul_f32 v157, v157, v60
    v_mul_f32 v158, v158, v60
    v_mul_f32 v159, v159, v60
    v_fma_f32 v184, v64, s36, -v50
    v_fma_f32 v185, v65, s36, -v50
    v_fma_f32 v186, v66, s36, -v50
    v_fma_f32 v187, v67, s36, -v50
    v_exp_f32 v184, v184
    v_exp_f32 v185, v185
    v_fma_f32 v188, v68, s36, -v50
    v_fma_f32 v189, v69, s36, -v50
    v_exp_f32 v186, v186
    v_exp_f32 v187, v187
    v_add_f32 v56, v184, v185
    v_cvt_pk_bf16_f32 v160, v184, v185
    v_fma_f32 v190, v70, s36, -v50
    v_fma_f32 v191, v71, s36, -v50
    v_exp_f32 v188, v188
    v_exp_f32 v189, v189
    v_add_f32 v56, v56, v186
    v_add_f32 v56, v56, v187
    v_cvt_pk_bf16_f32 v161, v186, v187
    v_fma_f32 v184, v72, s36, -v50
    v_fma_f32 v185, v73, s36, -v50
    v_exp_f32 v190, v190
    v_exp_f32 v191, v191
    v_add_f32 v56, v56, v188
    v_add_f32 v56, v56, v189
    v_cvt_pk_bf16_f32 v162, v188, v189
    v_fma_f32 v186, v74, s36, -v50
    v_fma_f32 v187, v75, s36, -v50
    v_exp_f32 v184, v184
    v_exp_f32 v185, v185
    v_add_f32 v56, v56, v190
    v_add_f32 v56, v56, v191
    v_cvt_pk_bf16_f32 v163, v190, v191
    v_fma_f32 v188, v76, s36, -v50
    v_fma_f32 v189, v77, s36, -v50
    v_exp_f32 v186, v186
    v_exp_f32 v187, v187
    v_add_f32 v56, v56, v184
    v_add_f32 v56, v56, v185
    v_cvt_pk_bf16_f32 v164, v184, v185
    v_fma_f32 v190, v78, s36, -v50
    v_fma_f32 v191, v79, s36, -v50
    v_exp_f32 v188, v188
    v_exp_f32 v189, v189
    v_add_f32 v56, v56, v186
    v_add_f32 v56, v56, v187
    v_cvt_pk_bf16_f32 v165, v186, v187
    v_exp_f32 v190, v190
    v_exp_f32 v191, v191
    v_add_f32 v56, v56, v188
    v_add_f32 v56, v56, v189
    v_cvt_pk_bf16_f32 v166, v188, v189
    v_add_f32 v56, v56, v190
    v_add_f32 v56, v56, v191
    v_cvt_pk_bf16_f32 v167, v190, v191
    v_fma_f32 v192, v80, s36, -v51
    v_fma_f32 v193, v81, s36, -v51
    v_fma_f32 v194, v82, s36, -v51
    v_fma_f32 v195, v83, s36, -v51
    v_exp_f32 v192, v192
    v_exp_f32 v193, v193
    v_fma_f32 v196, v84, s36, -v51
    v_fma_f32 v197, v85, s36, -v51
    v_exp_f32 v194, v194
    v_exp_f32 v195, v195
    v_add_f32 v57, v192, v193
    v_cvt_pk_bf16_f32 v168, v192, v193
    v_fma_f32 v198, v86, s36, -v51
    v_fma_f32 v199, v87, s36, -v51
    v_exp_f32 v196, v196
    v_exp_f32 v197, v197
    v_add_f32 v57, v57, v194
    v_add_f32 v57, v57, v195
    v_cvt_pk_bf16_f32 v169, v194, v195
    v_fma_f32 v192, v88, s36, -v51
    v_fma_f32 v193, v89, s36, -v51
    v_exp_f32 v198, v198
    v_exp_f32 v199, v199
    v_add_f32 v57, v57, v196
    v_add_f32 v57, v57, v197
    v_cvt_pk_bf16_f32 v170, v196, v197
    v_fma_f32 v194, v90, s36, -v51
    v_fma_f32 v195, v91, s36, -v51
    v_exp_f32 v192, v192
    v_exp_f32 v193, v193
    v_add_f32 v57, v57, v198
    v_add_f32 v57, v57, v199
    v_cvt_pk_bf16_f32 v171, v198, v199
    v_fma_f32 v196, v92, s36, -v51
    v_fma_f32 v197, v93, s36, -v51
    v_exp_f32 v194, v194
    v_exp_f32 v195, v195
    v_add_f32 v57, v57, v192
    v_add_f32 v57, v57, v193
    v_cvt_pk_bf16_f32 v172, v192, v193
    v_fma_f32 v198, v94, s36, -v51
    v_fma_f32 v199, v95, s36, -v51
    v_exp_f32 v196, v196
    v_exp_f32 v197, v197
    v_add_f32 v57, v57, v194
    v_add_f32 v57, v57, v195
    v_cvt_pk_bf16_f32 v173, v194, v195
    v_exp_f32 v198, v198
    v_exp_f32 v199, v199
    v_add_f32 v57, v57, v196
    v_add_f32 v57, v57, v197
    v_cvt_pk_bf16_f32 v174, v196, v197
    v_add_f32 v57, v57, v198
    v_add_f32 v57, v57, v199
    v_cvt_pk_bf16_f32 v175, v198, v199
    v_fma_f32 v184, v96, s36, -v52
    v_fma_f32 v185, v97, s36, -v52
    v_fma_f32 v186, v98, s36, -v52
    v_fma_f32 v187, v99, s36, -v52
    v_exp_f32 v184, v184
    v_exp_f32 v185, v185
    v_fma_f32 v188, v100, s36, -v52
    v_fma_f32 v189, v101, s36, -v52
    v_exp_f32 v186, v186
    v_exp_f32 v187, v187
    v_add_f32 v58, v184, v185
    v_cvt_pk_bf16_f32 v176, v184, v185
    v_fma_f32 v190, v102, s36, -v52
    v_fma_f32 v191, v103, s36, -v52
    v_exp_f32 v188, v188
    v_exp_f32 v189, v189
    v_add_f32 v58, v58, v186
    v_add_f32 v58, v58, v187
    v_cvt_pk_bf16_f32 v177, v186, v187
    v_fma_f32 v184, v104, s36, -v52
    v_fma_f32 v185, v105, s36, -v52
    v_exp_f32 v190, v190
    v_exp_f32 v191, v191
    v_add_f32 v58, v58, v188
    v_add_f32 v58, v58, v189
    v_cvt_pk_bf16_f32 v178, v188, v189
    v_fma_f32 v186, v106, s36, -v52
    v_fma_f32 v187, v107, s36, -v52
    v_exp_f32 v184, v184
    v_exp_f32 v185, v185
    v_add_f32 v58, v58, v190
    v_add_f32 v58, v58, v191
    v_cvt_pk_bf16_f32 v179, v190, v191
    v_fma_f32 v188, v108, s36, -v52
    v_fma_f32 v189, v109, s36, -v52
    v_exp_f32 v186, v186
    v_exp_f32 v187, v187
    v_add_f32 v58, v58, v184
    v_add_f32 v58, v58, v185
    v_cvt_pk_bf16_f32 v180, v184, v185
    v_fma_f32 v190, v110, s36, -v52
    v_fma_f32 v191, v111, s36, -v52
    v_exp_f32 v188, v188
    v_exp_f32 v189, v189
    v_add_f32 v58, v58, v186
    v_add_f32 v58, v58, v187
    v_cvt_pk_bf16_f32 v181, v186, v187
    v_exp_f32 v190, v190
    v_exp_f32 v191, v191
    v_add_f32 v58, v58, v188
    v_add_f32 v58, v58, v189
    v_cvt_pk_bf16_f32 v182, v188, v189
    v_add_f32 v58, v58, v190
    v_add_f32 v58, v58, v191
    v_cvt_pk_bf16_f32 v183, v190, v191
    ds_write_b128 v28, v[160:163] offset:0
    ds_write_b128 v28, v[164:167] offset:3072
    ds_write_b128 v28, v[168:171] offset:1024
    ds_write_b128 v28, v[172:175] offset:4096
    ds_write_b128 v28, v[176:179] offset:2048
    ds_write_b128 v28, v[180:183] offset:5120
    s_waitcnt lgkmcnt(0)
    s_branch Lpost_40
Lslow_44:
    s_nop 15
    v_max3_f32 v59, v64, v65, v66
    v_max3_f32 v59, v59, v67, v68
    v_max3_f32 v59, v59, v69, v70
    v_max3_f32 v59, v59, v71, v72
    v_max3_f32 v59, v59, v73, v74
    v_max3_f32 v59, v59, v75, v76
    v_max3_f32 v59, v59, v77, v78
    v_max_f32 v59, v59, v79
    v_max3_f32 v60, v80, v81, v82
    v_max3_f32 v60, v60, v83, v84
    v_max3_f32 v60, v60, v85, v86
    v_max3_f32 v60, v60, v87, v88
    v_max3_f32 v60, v60, v89, v90
    v_max3_f32 v60, v60, v91, v92
    v_max3_f32 v60, v60, v93, v94
    v_max_f32 v60, v60, v95
    v_max3_f32 v61, v96, v97, v98
    v_max3_f32 v61, v61, v99, v100
    v_max3_f32 v61, v61, v101, v102
    v_max3_f32 v61, v61, v103, v104
    v_max3_f32 v61, v61, v105, v106
    v_max3_f32 v61, v61, v107, v108
    v_max3_f32 v61, v61, v109, v110
    v_max_f32 v61, v61, v111
    s_waitcnt lgkmcnt(0)
    s_barrier
    ds_write_b32 v48, v59 offset:0
    ds_write_b32 v48, v60 offset:1024
    ds_write_b32 v48, v61 offset:2048
    s_waitcnt lgkmcnt(0)
    s_barrier
    ds_write_b32 v6, v7
    ds_read_b128 v[184:187], v49 offset:0
    ds_read_b128 v[188:191], v49 offset:16
    s_waitcnt lgkmcnt(0)
    v_max3_f32 v59, v184, v185, v186
    v_max3_f32 v59, v59, v187, v188
    v_max3_f32 v59, v59, v189, v190
    v_max_f32 v59, v59, v191
    v_mul_f32 v59, s36, v59
    v_mov_b32 v50, v59
    ds_read_b128 v[184:187], v49 offset:1024
    ds_read_b128 v[188:191], v49 offset:1040
    s_waitcnt lgkmcnt(0)
    v_max3_f32 v59, v184, v185, v186
    v_max3_f32 v59, v59, v187, v188
    v_max3_f32 v59, v59, v189, v190
    v_max_f32 v59, v59, v191
    v_mul_f32 v59, s36, v59
    v_mov_b32 v51, v59
    ds_read_b128 v[184:187], v49 offset:2048
    ds_read_b128 v[188:191], v49 offset:2064
    s_waitcnt lgkmcnt(0)
    v_max3_f32 v59, v184, v185, v186
    v_max3_f32 v59, v59, v187, v188
    v_max3_f32 v59, v59, v189, v190
    v_max_f32 v59, v59, v191
    v_mul_f32 v59, s36, v59
    v_mov_b32 v52, v59
    v_fma_f32 v184, v64, s36, -v50
    v_fma_f32 v185, v65, s36, -v50
    v_fma_f32 v186, v66, s36, -v50
    v_fma_f32 v187, v67, s36, -v50
    v_exp_f32 v184, v184
    v_exp_f32 v185, v185
    v_fma_f32 v188, v68, s36, -v50
    v_fma_f32 v189, v69, s36, -v50
    v_exp_f32 v186, v186
    v_exp_f32 v187, v187
    v_add_f32 v56, v184, v185
    v_cvt_pk_bf16_f32 v160, v184, v185
    v_fma_f32 v190, v70, s36, -v50
    v_fma_f32 v191, v71, s36, -v50
    v_exp_f32 v188, v188
    v_exp_f32 v189, v189
    v_add_f32 v56, v56, v186
    v_add_f32 v56, v56, v187
    v_cvt_pk_bf16_f32 v161, v186, v187
    v_fma_f32 v184, v72, s36, -v50
    v_fma_f32 v185, v73, s36, -v50
    v_exp_f32 v190, v190
    v_exp_f32 v191, v191
    v_add_f32 v56, v56, v188
    v_add_f32 v56, v56, v189
    v_cvt_pk_bf16_f32 v162, v188, v189
    v_fma_f32 v186, v74, s36, -v50
    v_fma_f32 v187, v75, s36, -v50
    v_exp_f32 v184, v184
    v_exp_f32 v185, v185
    v_add_f32 v56, v56, v190
    v_add_f32 v56, v56, v191
    v_cvt_pk_bf16_f32 v163, v190, v191
    v_fma_f32 v188, v76, s36, -v50
    v_fma_f32 v189, v77, s36, -v50
    v_exp_f32 v186, v186
    v_exp_f32 v187, v187
    v_add_f32 v56, v56, v184
    v_add_f32 v56, v56, v185
    v_cvt_pk_bf16_f32 v164, v184, v185
    v_fma_f32 v190, v78, s36, -v50
    v_fma_f32 v191, v79, s36, -v50
    v_exp_f32 v188, v188
    v_exp_f32 v189, v189
    v_add_f32 v56, v56, v186
    v_add_f32 v56, v56, v187
    v_cvt_pk_bf16_f32 v165, v186, v187
    v_exp_f32 v190, v190
    v_exp_f32 v191, v191
    v_add_f32 v56, v56, v188
    v_add_f32 v56, v56, v189
    v_cvt_pk_bf16_f32 v166, v188, v189
    v_add_f32 v56, v56, v190
    v_add_f32 v56, v56, v191
    v_cvt_pk_bf16_f32 v167, v190, v191
    v_fma_f32 v192, v80, s36, -v51
    v_fma_f32 v193, v81, s36, -v51
    v_fma_f32 v194, v82, s36, -v51
    v_fma_f32 v195, v83, s36, -v51
    v_exp_f32 v192, v192
    v_exp_f32 v193, v193
    v_fma_f32 v196, v84, s36, -v51
    v_fma_f32 v197, v85, s36, -v51
    v_exp_f32 v194, v194
    v_exp_f32 v195, v195
    v_add_f32 v57, v192, v193
    v_cvt_pk_bf16_f32 v168, v192, v193
    v_fma_f32 v198, v86, s36, -v51
    v_fma_f32 v199, v87, s36, -v51
    v_exp_f32 v196, v196
    v_exp_f32 v197, v197
    v_add_f32 v57, v57, v194
    v_add_f32 v57, v57, v195
    v_cvt_pk_bf16_f32 v169, v194, v195
    v_fma_f32 v192, v88, s36, -v51
    v_fma_f32 v193, v89, s36, -v51
    v_exp_f32 v198, v198
    v_exp_f32 v199, v199
    v_add_f32 v57, v57, v196
    v_add_f32 v57, v57, v197
    v_cvt_pk_bf16_f32 v170, v196, v197
    v_fma_f32 v194, v90, s36, -v51
    v_fma_f32 v195, v91, s36, -v51
    v_exp_f32 v192, v192
    v_exp_f32 v193, v193
    v_add_f32 v57, v57, v198
    v_add_f32 v57, v57, v199
    v_cvt_pk_bf16_f32 v171, v198, v199
    v_fma_f32 v196, v92, s36, -v51
    v_fma_f32 v197, v93, s36, -v51
    v_exp_f32 v194, v194
    v_exp_f32 v195, v195
    v_add_f32 v57, v57, v192
    v_add_f32 v57, v57, v193
    v_cvt_pk_bf16_f32 v172, v192, v193
    v_fma_f32 v198, v94, s36, -v51
    v_fma_f32 v199, v95, s36, -v51
    v_exp_f32 v196, v196
    v_exp_f32 v197, v197
    v_add_f32 v57, v57, v194
    v_add_f32 v57, v57, v195
    v_cvt_pk_bf16_f32 v173, v194, v195
    v_exp_f32 v198, v198
    v_exp_f32 v199, v199
    v_add_f32 v57, v57, v196
    v_add_f32 v57, v57, v197
    v_cvt_pk_bf16_f32 v174, v196, v197
    v_add_f32 v57, v57, v198
    v_add_f32 v57, v57, v199
    v_cvt_pk_bf16_f32 v175, v198, v199
    v_fma_f32 v184, v96, s36, -v52
    v_fma_f32 v185, v97, s36, -v52
    v_fma_f32 v186, v98, s36, -v52
    v_fma_f32 v187, v99, s36, -v52
    v_exp_f32 v184, v184
    v_exp_f32 v185, v185
    v_fma_f32 v188, v100, s36, -v52
    v_fma_f32 v189, v101, s36, -v52
    v_exp_f32 v186, v186
    v_exp_f32 v187, v187
    v_add_f32 v58, v184, v185
    v_cvt_pk_bf16_f32 v176, v184, v185
    v_fma_f32 v190, v102, s36, -v52
    v_fma_f32 v191, v103, s36, -v52
    v_exp_f32 v188, v188
    v_exp_f32 v189, v189
    v_add_f32 v58, v58, v186
    v_add_f32 v58, v58, v187
    v_cvt_pk_bf16_f32 v177, v186, v187
    v_fma_f32 v184, v104, s36, -v52
    v_fma_f32 v185, v105, s36, -v52
    v_exp_f32 v190, v190
    v_exp_f32 v191, v191
    v_add_f32 v58, v58, v188
    v_add_f32 v58, v58, v189
    v_cvt_pk_bf16_f32 v178, v188, v189
    v_fma_f32 v186, v106, s36, -v52
    v_fma_f32 v187, v107, s36, -v52
    v_exp_f32 v184, v184
    v_exp_f32 v185, v185
    v_add_f32 v58, v58, v190
    v_add_f32 v58, v58, v191
    v_cvt_pk_bf16_f32 v179, v190, v191
    v_fma_f32 v188, v108, s36, -v52
    v_fma_f32 v189, v109, s36, -v52
    v_exp_f32 v186, v186
    v_exp_f32 v187, v187
    v_add_f32 v58, v58, v184
    v_add_f32 v58, v58, v185
    v_cvt_pk_bf16_f32 v180, v184, v185
    v_fma_f32 v190, v110, s36, -v52
    v_fma_f32 v191, v111, s36, -v52
    v_exp_f32 v188, v188
    v_exp_f32 v189, v189
    v_add_f32 v58, v58, v186
    v_add_f32 v58, v58, v187
    v_cvt_pk_bf16_f32 v181, v186, v187
    v_exp_f32 v190, v190
    v_exp_f32 v191, v191
    v_add_f32 v58, v58, v188
    v_add_f32 v58, v58, v189
    v_cvt_pk_bf16_f32 v182, v188, v189
    v_add_f32 v58, v58, v190
    v_add_f32 v58, v58, v191
    v_cvt_pk_bf16_f32 v183, v190, v191
    ds_write_b128 v28, v[160:163] offset:0
    ds_write_b128 v28, v[164:167] offset:3072
    ds_write_b128 v28, v[168:171] offset:1024
    ds_write_b128 v28, v[172:175] offset:4096
    ds_write_b128 v28, v[176:179] offset:2048
    ds_write_b128 v28, v[180:183] offset:5120
    s_waitcnt lgkmcnt(0)
    s_branch Lpost_43
Lslow_47:
    s_nop 15
    v_max3_f32 v59, v64, v65, v66
    v_max3_f32 v59, v59, v67, v68
    v_max3_f32 v59, v59, v69, v70
    v_max3_f32 v59, v59, v71, v72
    v_max3_f32 v59, v59, v73, v74
    v_max3_f32 v59, v59, v75, v76
    v_max3_f32 v59, v59, v77, v78
    v_max_f32 v59, v59, v79
    v_max3_f32 v60, v80, v81, v82
    v_max3_f32 v60, v60, v83, v84
    v_max3_f32 v60, v60, v85, v86
    v_max3_f32 v60, v60, v87, v88
    v_max3_f32 v60, v60, v89, v90
    v_max3_f32 v60, v60, v91, v92
    v_max3_f32 v60, v60, v93, v94
    v_max_f32 v60, v60, v95
    v_max3_f32 v61, v96, v97, v98
    v_max3_f32 v61, v61, v99, v100
    v_max3_f32 v61, v61, v101, v102
    v_max3_f32 v61, v61, v103, v104
    v_max3_f32 v61, v61, v105, v106
    v_max3_f32 v61, v61, v107, v108
    v_max3_f32 v61, v61, v109, v110
    v_max_f32 v61, v61, v111
    s_waitcnt lgkmcnt(0)
    s_barrier
    ds_write_b32 v48, v59 offset:0
    ds_write_b32 v48, v60 offset:1024
    ds_write_b32 v48, v61 offset:2048
    s_waitcnt lgkmcnt(0)
    s_barrier
    ds_write_b32 v6, v7
    ds_read_b128 v[184:187], v49 offset:0
    ds_read_b128 v[188:191], v49 offset:16
    s_waitcnt lgkmcnt(0)
    v_max3_f32 v59, v184, v185, v186
    v_max3_f32 v59, v59, v187, v188
    v_max3_f32 v59, v59, v189, v190
    v_max_f32 v59, v59, v191
    v_mul_f32 v59, s36, v59
    v_max_f32 v59, v59, v50
    v_sub_f32 v60, v50, v59
    v_exp_f32 v60, v60
    v_mov_b32 v50, v59
    v_mul_f32 v53, v53, v60
    v_mul_f32 v112, v112, v60
    v_mul_f32 v113, v113, v60
    v_mul_f32 v114, v114, v60
    v_mul_f32 v115, v115, v60
    v_mul_f32 v116, v116, v60
    v_mul_f32 v117, v117, v60
    v_mul_f32 v118, v118, v60
    v_mul_f32 v119, v119, v60
    v_mul_f32 v120, v120, v60
    v_mul_f32 v121, v121, v60
    v_mul_f32 v122, v122, v60
    v_mul_f32 v123, v123, v60
    v_mul_f32 v124, v124, v60
    v_mul_f32 v125, v125, v60
    v_mul_f32 v126, v126, v60
    v_mul_f32 v127, v127, v60
    ds_read_b128 v[184:187], v49 offset:1024
    ds_read_b128 v[188:191], v49 offset:1040
    s_waitcnt lgkmcnt(0)
    v_max3_f32 v59, v184, v185, v186
    v_max3_f32 v59, v59, v187, v188
    v_max3_f32 v59, v59, v189, v190
    v_max_f32 v59, v59, v191
    v_mul_f32 v59, s36, v59
    v_max_f32 v59, v59, v51
    v_sub_f32 v60, v51, v59
    v_exp_f32 v60, v60
    v_mov_b32 v51, v59
    v_mul_f32 v54, v54, v60
    v_mul_f32 v128, v128, v60
    v_mul_f32 v129, v129, v60
    v_mul_f32 v130, v130, v60
    v_mul_f32 v131, v131, v60
    v_mul_f32 v132, v132, v60
    v_mul_f32 v133, v133, v60
    v_mul_f32 v134, v134, v60
    v_mul_f32 v135, v135, v60
    v_mul_f32 v136, v136, v60
    v_mul_f32 v137, v137, v60
    v_mul_f32 v138, v138, v60
    v_mul_f32 v139, v139, v60
    v_mul_f32 v140, v140, v60
    v_mul_f32 v141, v141, v60
    v_mul_f32 v142, v142, v60
    v_mul_f32 v143, v143, v60
    ds_read_b128 v[184:187], v49 offset:2048
    ds_read_b128 v[188:191], v49 offset:2064
    s_waitcnt lgkmcnt(0)
    v_max3_f32 v59, v184, v185, v186
    v_max3_f32 v59, v59, v187, v188
    v_max3_f32 v59, v59, v189, v190
    v_max_f32 v59, v59, v191
    v_mul_f32 v59, s36, v59
    v_max_f32 v59, v59, v52
    v_sub_f32 v60, v52, v59
    v_exp_f32 v60, v60
    v_mov_b32 v52, v59
    v_mul_f32 v55, v55, v60
    v_mul_f32 v144, v144, v60
    v_mul_f32 v145, v145, v60
    v_mul_f32 v146, v146, v60
    v_mul_f32 v147, v147, v60
    v_mul_f32 v148, v148, v60
    v_mul_f32 v149, v149, v60
    v_mul_f32 v150, v150, v60
    v_mul_f32 v151, v151, v60
    v_mul_f32 v152, v152, v60
    v_mul_f32 v153, v153, v60
    v_mul_f32 v154, v154, v60
    v_mul_f32 v155, v155, v60
    v_mul_f32 v156, v156, v60
    v_mul_f32 v157, v157, v60
    v_mul_f32 v158, v158, v60
    v_mul_f32 v159, v159, v60
    v_fma_f32 v184, v64, s36, -v50
    v_fma_f32 v185, v65, s36, -v50
    v_fma_f32 v186, v66, s36, -v50
    v_fma_f32 v187, v67, s36, -v50
    v_exp_f32 v184, v184
    v_exp_f32 v185, v185
    v_fma_f32 v188, v68, s36, -v50
    v_fma_f32 v189, v69, s36, -v50
    v_exp_f32 v186, v186
    v_exp_f32 v187, v187
    v_add_f32 v56, v184, v185
    v_cvt_pk_bf16_f32 v160, v184, v185
    v_fma_f32 v190, v70, s36, -v50
    v_fma_f32 v191, v71, s36, -v50
    v_exp_f32 v188, v188
    v_exp_f32 v189, v189
    v_add_f32 v56, v56, v186
    v_add_f32 v56, v56, v187
    v_cvt_pk_bf16_f32 v161, v186, v187
    v_fma_f32 v184, v72, s36, -v50
    v_fma_f32 v185, v73, s36, -v50
    v_exp_f32 v190, v190
    v_exp_f32 v191, v191
    v_add_f32 v56, v56, v188
    v_add_f32 v56, v56, v189
    v_cvt_pk_bf16_f32 v162, v188, v189
    v_fma_f32 v186, v74, s36, -v50
    v_fma_f32 v187, v75, s36, -v50
    v_exp_f32 v184, v184
    v_exp_f32 v185, v185
    v_add_f32 v56, v56, v190
    v_add_f32 v56, v56, v191
    v_cvt_pk_bf16_f32 v163, v190, v191
    v_fma_f32 v188, v76, s36, -v50
    v_fma_f32 v189, v77, s36, -v50
    v_exp_f32 v186, v186
    v_exp_f32 v187, v187
    v_add_f32 v56, v56, v184
    v_add_f32 v56, v56, v185
    v_cvt_pk_bf16_f32 v164, v184, v185
    v_fma_f32 v190, v78, s36, -v50
    v_fma_f32 v191, v79, s36, -v50
    v_exp_f32 v188, v188
    v_exp_f32 v189, v189
    v_add_f32 v56, v56, v186
    v_add_f32 v56, v56, v187
    v_cvt_pk_bf16_f32 v165, v186, v187
    v_exp_f32 v190, v190
    v_exp_f32 v191, v191
    v_add_f32 v56, v56, v188
    v_add_f32 v56, v56, v189
    v_cvt_pk_bf16_f32 v166, v188, v189
    v_add_f32 v56, v56, v190
    v_add_f32 v56, v56, v191
    v_cvt_pk_bf16_f32 v167, v190, v191
    v_fma_f32 v192, v80, s36, -v51
    v_fma_f32 v193, v81, s36, -v51
    v_fma_f32 v194, v82, s36, -v51
    v_fma_f32 v195, v83, s36, -v51
    v_exp_f32 v192, v192
    v_exp_f32 v193, v193
    v_fma_f32 v196, v84, s36, -v51
    v_fma_f32 v197, v85, s36, -v51
    v_exp_f32 v194, v194
    v_exp_f32 v195, v195
    v_add_f32 v57, v192, v193
    v_cvt_pk_bf16_f32 v168, v192, v193
    v_fma_f32 v198, v86, s36, -v51
    v_fma_f32 v199, v87, s36, -v51
    v_exp_f32 v196, v196
    v_exp_f32 v197, v197
    v_add_f32 v57, v57, v194
    v_add_f32 v57, v57, v195
    v_cvt_pk_bf16_f32 v169, v194, v195
    v_fma_f32 v192, v88, s36, -v51
    v_fma_f32 v193, v89, s36, -v51
    v_exp_f32 v198, v198
    v_exp_f32 v199, v199
    v_add_f32 v57, v57, v196
    v_add_f32 v57, v57, v197
    v_cvt_pk_bf16_f32 v170, v196, v197
    v_fma_f32 v194, v90, s36, -v51
    v_fma_f32 v195, v91, s36, -v51
    v_exp_f32 v192, v192
    v_exp_f32 v193, v193
    v_add_f32 v57, v57, v198
    v_add_f32 v57, v57, v199
    v_cvt_pk_bf16_f32 v171, v198, v199
    v_fma_f32 v196, v92, s36, -v51
    v_fma_f32 v197, v93, s36, -v51
    v_exp_f32 v194, v194
    v_exp_f32 v195, v195
    v_add_f32 v57, v57, v192
    v_add_f32 v57, v57, v193
    v_cvt_pk_bf16_f32 v172, v192, v193
    v_fma_f32 v198, v94, s36, -v51
    v_fma_f32 v199, v95, s36, -v51
    v_exp_f32 v196, v196
    v_exp_f32 v197, v197
    v_add_f32 v57, v57, v194
    v_add_f32 v57, v57, v195
    v_cvt_pk_bf16_f32 v173, v194, v195
    v_exp_f32 v198, v198
    v_exp_f32 v199, v199
    v_add_f32 v57, v57, v196
    v_add_f32 v57, v57, v197
    v_cvt_pk_bf16_f32 v174, v196, v197
    v_add_f32 v57, v57, v198
    v_add_f32 v57, v57, v199
    v_cvt_pk_bf16_f32 v175, v198, v199
    v_fma_f32 v184, v96, s36, -v52
    v_fma_f32 v185, v97, s36, -v52
    v_fma_f32 v186, v98, s36, -v52
    v_fma_f32 v187, v99, s36, -v52
    v_exp_f32 v184, v184
    v_exp_f32 v185, v185
    v_fma_f32 v188, v100, s36, -v52
    v_fma_f32 v189, v101, s36, -v52
    v_exp_f32 v186, v186
    v_exp_f32 v187, v187
    v_add_f32 v58, v184, v185
    v_cvt_pk_bf16_f32 v176, v184, v185
    v_fma_f32 v190, v102, s36, -v52
    v_fma_f32 v191, v103, s36, -v52
    v_exp_f32 v188, v188
    v_exp_f32 v189, v189
    v_add_f32 v58, v58, v186
    v_add_f32 v58, v58, v187
    v_cvt_pk_bf16_f32 v177, v186, v187
    v_fma_f32 v184, v104, s36, -v52
    v_fma_f32 v185, v105, s36, -v52
    v_exp_f32 v190, v190
    v_exp_f32 v191, v191
    v_add_f32 v58, v58, v188
    v_add_f32 v58, v58, v189
    v_cvt_pk_bf16_f32 v178, v188, v189
    v_fma_f32 v186, v106, s36, -v52
    v_fma_f32 v187, v107, s36, -v52
    v_exp_f32 v184, v184
    v_exp_f32 v185, v185
    v_add_f32 v58, v58, v190
    v_add_f32 v58, v58, v191
    v_cvt_pk_bf16_f32 v179, v190, v191
    v_fma_f32 v188, v108, s36, -v52
    v_fma_f32 v189, v109, s36, -v52
    v_exp_f32 v186, v186
    v_exp_f32 v187, v187
    v_add_f32 v58, v58, v184
    v_add_f32 v58, v58, v185
    v_cvt_pk_bf16_f32 v180, v184, v185
    v_fma_f32 v190, v110, s36, -v52
    v_fma_f32 v191, v111, s36, -v52
    v_exp_f32 v188, v188
    v_exp_f32 v189, v189
    v_add_f32 v58, v58, v186
    v_add_f32 v58, v58, v187
    v_cvt_pk_bf16_f32 v181, v186, v187
    v_exp_f32 v190, v190
    v_exp_f32 v191, v191
    v_add_f32 v58, v58, v188
    v_add_f32 v58, v58, v189
    v_cvt_pk_bf16_f32 v182, v188, v189
    v_add_f32 v58, v58, v190
    v_add_f32 v58, v58, v191
    v_cvt_pk_bf16_f32 v183, v190, v191
    ds_write_b128 v28, v[160:163] offset:0
    ds_write_b128 v28, v[164:167] offset:3072
    ds_write_b128 v28, v[168:171] offset:1024
    ds_write_b128 v28, v[172:175] offset:4096
    ds_write_b128 v28, v[176:179] offset:2048
    ds_write_b128 v28, v[180:183] offset:5120
    s_waitcnt lgkmcnt(0)
    s_branch Lpost_46
Lslow_50:
    s_nop 15
    v_max3_f32 v59, v64, v65, v66
    v_max3_f32 v59, v59, v67, v68
    v_max3_f32 v59, v59, v69, v70
    v_max3_f32 v59, v59, v71, v72
    v_max3_f32 v59, v59, v73, v74
    v_max3_f32 v59, v59, v75, v76
    v_max3_f32 v59, v59, v77, v78
    v_max_f32 v59, v59, v79
    v_max3_f32 v60, v80, v81, v82
    v_max3_f32 v60, v60, v83, v84
    v_max3_f32 v60, v60, v85, v86
    v_max3_f32 v60, v60, v87, v88
    v_max3_f32 v60, v60, v89, v90
    v_max3_f32 v60, v60, v91, v92
    v_max3_f32 v60, v60, v93, v94
    v_max_f32 v60, v60, v95
    v_max3_f32 v61, v96, v97, v98
    v_max3_f32 v61, v61, v99, v100
    v_max3_f32 v61, v61, v101, v102
    v_max3_f32 v61, v61, v103, v104
    v_max3_f32 v61, v61, v105, v106
    v_max3_f32 v61, v61, v107, v108
    v_max3_f32 v61, v61, v109, v110
    v_max_f32 v61, v61, v111
    s_waitcnt lgkmcnt(0)
    s_barrier
    ds_write_b32 v48, v59 offset:0
    ds_write_b32 v48, v60 offset:1024
    ds_write_b32 v48, v61 offset:2048
    s_waitcnt lgkmcnt(0)
    s_barrier
    ds_write_b32 v6, v7
    ds_read_b128 v[184:187], v49 offset:0
    ds_read_b128 v[188:191], v49 offset:16
    s_waitcnt lgkmcnt(0)
    v_max3_f32 v59, v184, v185, v186
    v_max3_f32 v59, v59, v187, v188
    v_max3_f32 v59, v59, v189, v190
    v_max_f32 v59, v59, v191
    v_mul_f32 v59, s36, v59
    v_max_f32 v59, v59, v50
    v_sub_f32 v60, v50, v59
    v_exp_f32 v60, v60
    v_mov_b32 v50, v59
    v_mul_f32 v53, v53, v60
    v_mul_f32 v112, v112, v60
    v_mul_f32 v113, v113, v60
    v_mul_f32 v114, v114, v60
    v_mul_f32 v115, v115, v60
    v_mul_f32 v116, v116, v60
    v_mul_f32 v117, v117, v60
    v_mul_f32 v118, v118, v60
    v_mul_f32 v119, v119, v60
    v_mul_f32 v120, v120, v60
    v_mul_f32 v121, v121, v60
    v_mul_f32 v122, v122, v60
    v_mul_f32 v123, v123, v60
    v_mul_f32 v124, v124, v60
    v_mul_f32 v125, v125, v60
    v_mul_f32 v126, v126, v60
    v_mul_f32 v127, v127, v60
    ds_read_b128 v[184:187], v49 offset:1024
    ds_read_b128 v[188:191], v49 offset:1040
    s_waitcnt lgkmcnt(0)
    v_max3_f32 v59, v184, v185, v186
    v_max3_f32 v59, v59, v187, v188
    v_max3_f32 v59, v59, v189, v190
    v_max_f32 v59, v59, v191
    v_mul_f32 v59, s36, v59
    v_max_f32 v59, v59, v51
    v_sub_f32 v60, v51, v59
    v_exp_f32 v60, v60
    v_mov_b32 v51, v59
    v_mul_f32 v54, v54, v60
    v_mul_f32 v128, v128, v60
    v_mul_f32 v129, v129, v60
    v_mul_f32 v130, v130, v60
    v_mul_f32 v131, v131, v60
    v_mul_f32 v132, v132, v60
    v_mul_f32 v133, v133, v60
    v_mul_f32 v134, v134, v60
    v_mul_f32 v135, v135, v60
    v_mul_f32 v136, v136, v60
    v_mul_f32 v137, v137, v60
    v_mul_f32 v138, v138, v60
    v_mul_f32 v139, v139, v60
    v_mul_f32 v140, v140, v60
    v_mul_f32 v141, v141, v60
    v_mul_f32 v142, v142, v60
    v_mul_f32 v143, v143, v60
    ds_read_b128 v[184:187], v49 offset:2048
    ds_read_b128 v[188:191], v49 offset:2064
    s_waitcnt lgkmcnt(0)
    v_max3_f32 v59, v184, v185, v186
    v_max3_f32 v59, v59, v187, v188
    v_max3_f32 v59, v59, v189, v190
    v_max_f32 v59, v59, v191
    v_mul_f32 v59, s36, v59
    v_max_f32 v59, v59, v52
    v_sub_f32 v60, v52, v59
    v_exp_f32 v60, v60
    v_mov_b32 v52, v59
    v_mul_f32 v55, v55, v60
    v_mul_f32 v144, v144, v60
    v_mul_f32 v145, v145, v60
    v_mul_f32 v146, v146, v60
    v_mul_f32 v147, v147, v60
    v_mul_f32 v148, v148, v60
    v_mul_f32 v149, v149, v60
    v_mul_f32 v150, v150, v60
    v_mul_f32 v151, v151, v60
    v_mul_f32 v152, v152, v60
    v_mul_f32 v153, v153, v60
    v_mul_f32 v154, v154, v60
    v_mul_f32 v155, v155, v60
    v_mul_f32 v156, v156, v60
    v_mul_f32 v157, v157, v60
    v_mul_f32 v158, v158, v60
    v_mul_f32 v159, v159, v60
    v_fma_f32 v184, v64, s36, -v50
    v_fma_f32 v185, v65, s36, -v50
    v_fma_f32 v186, v66, s36, -v50
    v_fma_f32 v187, v67, s36, -v50
    v_exp_f32 v184, v184
    v_exp_f32 v185, v185
    v_fma_f32 v188, v68, s36, -v50
    v_fma_f32 v189, v69, s36, -v50
    v_exp_f32 v186, v186
    v_exp_f32 v187, v187
    v_add_f32 v56, v184, v185
    v_cvt_pk_bf16_f32 v160, v184, v185
    v_fma_f32 v190, v70, s36, -v50
    v_fma_f32 v191, v71, s36, -v50
    v_exp_f32 v188, v188
    v_exp_f32 v189, v189
    v_add_f32 v56, v56, v186
    v_add_f32 v56, v56, v187
    v_cvt_pk_bf16_f32 v161, v186, v187
    v_fma_f32 v184, v72, s36, -v50
    v_fma_f32 v185, v73, s36, -v50
    v_exp_f32 v190, v190
    v_exp_f32 v191, v191
    v_add_f32 v56, v56, v188
    v_add_f32 v56, v56, v189
    v_cvt_pk_bf16_f32 v162, v188, v189
    v_fma_f32 v186, v74, s36, -v50
    v_fma_f32 v187, v75, s36, -v50
    v_exp_f32 v184, v184
    v_exp_f32 v185, v185
    v_add_f32 v56, v56, v190
    v_add_f32 v56, v56, v191
    v_cvt_pk_bf16_f32 v163, v190, v191
    v_fma_f32 v188, v76, s36, -v50
    v_fma_f32 v189, v77, s36, -v50
    v_exp_f32 v186, v186
    v_exp_f32 v187, v187
    v_add_f32 v56, v56, v184
    v_add_f32 v56, v56, v185
    v_cvt_pk_bf16_f32 v164, v184, v185
    v_fma_f32 v190, v78, s36, -v50
    v_fma_f32 v191, v79, s36, -v50
    v_exp_f32 v188, v188
    v_exp_f32 v189, v189
    v_add_f32 v56, v56, v186
    v_add_f32 v56, v56, v187
    v_cvt_pk_bf16_f32 v165, v186, v187
    v_exp_f32 v190, v190
    v_exp_f32 v191, v191
    v_add_f32 v56, v56, v188
    v_add_f32 v56, v56, v189
    v_cvt_pk_bf16_f32 v166, v188, v189
    v_add_f32 v56, v56, v190
    v_add_f32 v56, v56, v191
    v_cvt_pk_bf16_f32 v167, v190, v191
    v_fma_f32 v192, v80, s36, -v51
    v_fma_f32 v193, v81, s36, -v51
    v_fma_f32 v194, v82, s36, -v51
    v_fma_f32 v195, v83, s36, -v51
    v_exp_f32 v192, v192
    v_exp_f32 v193, v193
    v_fma_f32 v196, v84, s36, -v51
    v_fma_f32 v197, v85, s36, -v51
    v_exp_f32 v194, v194
    v_exp_f32 v195, v195
    v_add_f32 v57, v192, v193
    v_cvt_pk_bf16_f32 v168, v192, v193
    v_fma_f32 v198, v86, s36, -v51
    v_fma_f32 v199, v87, s36, -v51
    v_exp_f32 v196, v196
    v_exp_f32 v197, v197
    v_add_f32 v57, v57, v194
    v_add_f32 v57, v57, v195
    v_cvt_pk_bf16_f32 v169, v194, v195
    v_fma_f32 v192, v88, s36, -v51
    v_fma_f32 v193, v89, s36, -v51
    v_exp_f32 v198, v198
    v_exp_f32 v199, v199
    v_add_f32 v57, v57, v196
    v_add_f32 v57, v57, v197
    v_cvt_pk_bf16_f32 v170, v196, v197
    v_fma_f32 v194, v90, s36, -v51
    v_fma_f32 v195, v91, s36, -v51
    v_exp_f32 v192, v192
    v_exp_f32 v193, v193
    v_add_f32 v57, v57, v198
    v_add_f32 v57, v57, v199
    v_cvt_pk_bf16_f32 v171, v198, v199
    v_fma_f32 v196, v92, s36, -v51
    v_fma_f32 v197, v93, s36, -v51
    v_exp_f32 v194, v194
    v_exp_f32 v195, v195
    v_add_f32 v57, v57, v192
    v_add_f32 v57, v57, v193
    v_cvt_pk_bf16_f32 v172, v192, v193
    v_fma_f32 v198, v94, s36, -v51
    v_fma_f32 v199, v95, s36, -v51
    v_exp_f32 v196, v196
    v_exp_f32 v197, v197
    v_add_f32 v57, v57, v194
    v_add_f32 v57, v57, v195
    v_cvt_pk_bf16_f32 v173, v194, v195
    v_exp_f32 v198, v198
    v_exp_f32 v199, v199
    v_add_f32 v57, v57, v196
    v_add_f32 v57, v57, v197
    v_cvt_pk_bf16_f32 v174, v196, v197
    v_add_f32 v57, v57, v198
    v_add_f32 v57, v57, v199
    v_cvt_pk_bf16_f32 v175, v198, v199
    v_fma_f32 v184, v96, s36, -v52
    v_fma_f32 v185, v97, s36, -v52
    v_fma_f32 v186, v98, s36, -v52
    v_fma_f32 v187, v99, s36, -v52
    v_exp_f32 v184, v184
    v_exp_f32 v185, v185
    v_fma_f32 v188, v100, s36, -v52
    v_fma_f32 v189, v101, s36, -v52
    v_exp_f32 v186, v186
    v_exp_f32 v187, v187
    v_add_f32 v58, v184, v185
    v_cvt_pk_bf16_f32 v176, v184, v185
    v_fma_f32 v190, v102, s36, -v52
    v_fma_f32 v191, v103, s36, -v52
    v_exp_f32 v188, v188
    v_exp_f32 v189, v189
    v_add_f32 v58, v58, v186
    v_add_f32 v58, v58, v187
    v_cvt_pk_bf16_f32 v177, v186, v187
    v_fma_f32 v184, v104, s36, -v52
    v_fma_f32 v185, v105, s36, -v52
    v_exp_f32 v190, v190
    v_exp_f32 v191, v191
    v_add_f32 v58, v58, v188
    v_add_f32 v58, v58, v189
    v_cvt_pk_bf16_f32 v178, v188, v189
    v_fma_f32 v186, v106, s36, -v52
    v_fma_f32 v187, v107, s36, -v52
    v_exp_f32 v184, v184
    v_exp_f32 v185, v185
    v_add_f32 v58, v58, v190
    v_add_f32 v58, v58, v191
    v_cvt_pk_bf16_f32 v179, v190, v191
    v_fma_f32 v188, v108, s36, -v52
    v_fma_f32 v189, v109, s36, -v52
    v_exp_f32 v186, v186
    v_exp_f32 v187, v187
    v_add_f32 v58, v58, v184
    v_add_f32 v58, v58, v185
    v_cvt_pk_bf16_f32 v180, v184, v185
    v_fma_f32 v190, v110, s36, -v52
    v_fma_f32 v191, v111, s36, -v52
    v_exp_f32 v188, v188
    v_exp_f32 v189, v189
    v_add_f32 v58, v58, v186
    v_add_f32 v58, v58, v187
    v_cvt_pk_bf16_f32 v181, v186, v187
    v_exp_f32 v190, v190
    v_exp_f32 v191, v191
    v_add_f32 v58, v58, v188
    v_add_f32 v58, v58, v189
    v_cvt_pk_bf16_f32 v182, v188, v189
    v_add_f32 v58, v58, v190
    v_add_f32 v58, v58, v191
    v_cvt_pk_bf16_f32 v183, v190, v191
    ds_write_b128 v28, v[160:163] offset:0
    ds_write_b128 v28, v[164:167] offset:3072
    ds_write_b128 v28, v[168:171] offset:1024
    ds_write_b128 v28, v[172:175] offset:4096
    ds_write_b128 v28, v[176:179] offset:2048
    ds_write_b128 v28, v[180:183] offset:5120
    s_waitcnt lgkmcnt(0)
    s_branch Lpost_49
Lslow_53:
    s_nop 15
    v_max3_f32 v59, v64, v65, v66
    v_max3_f32 v59, v59, v67, v68
    v_max3_f32 v59, v59, v69, v70
    v_max3_f32 v59, v59, v71, v72
    v_max3_f32 v59, v59, v73, v74
    v_max3_f32 v59, v59, v75, v76
    v_max3_f32 v59, v59, v77, v78
    v_max_f32 v59, v59, v79
    v_max3_f32 v60, v80, v81, v82
    v_max3_f32 v60, v60, v83, v84
    v_max3_f32 v60, v60, v85, v86
    v_max3_f32 v60, v60, v87, v88
    v_max3_f32 v60, v60, v89, v90
    v_max3_f32 v60, v60, v91, v92
    v_max3_f32 v60, v60, v93, v94
    v_max_f32 v60, v60, v95
    v_max3_f32 v61, v96, v97, v98
    v_max3_f32 v61, v61, v99, v100
    v_max3_f32 v61, v61, v101, v102
    v_max3_f32 v61, v61, v103, v104
    v_max3_f32 v61, v61, v105, v106
    v_max3_f32 v61, v61, v107, v108
    v_max3_f32 v61, v61, v109, v110
    v_max_f32 v61, v61, v111
    s_waitcnt lgkmcnt(0)
    s_barrier
    ds_write_b32 v48, v59 offset:0
    ds_write_b32 v48, v60 offset:1024
    ds_write_b32 v48, v61 offset:2048
    s_waitcnt lgkmcnt(0)
    s_barrier
    ds_write_b32 v6, v7
    ds_read_b128 v[184:187], v49 offset:0
    ds_read_b128 v[188:191], v49 offset:16
    s_waitcnt lgkmcnt(0)
    v_max3_f32 v59, v184, v185, v186
    v_max3_f32 v59, v59, v187, v188
    v_max3_f32 v59, v59, v189, v190
    v_max_f32 v59, v59, v191
    v_mul_f32 v59, s36, v59
    v_max_f32 v59, v59, v50
    v_sub_f32 v60, v50, v59
    v_exp_f32 v60, v60
    v_mov_b32 v50, v59
    v_mul_f32 v53, v53, v60
    v_mul_f32 v112, v112, v60
    v_mul_f32 v113, v113, v60
    v_mul_f32 v114, v114, v60
    v_mul_f32 v115, v115, v60
    v_mul_f32 v116, v116, v60
    v_mul_f32 v117, v117, v60
    v_mul_f32 v118, v118, v60
    v_mul_f32 v119, v119, v60
    v_mul_f32 v120, v120, v60
    v_mul_f32 v121, v121, v60
    v_mul_f32 v122, v122, v60
    v_mul_f32 v123, v123, v60
    v_mul_f32 v124, v124, v60
    v_mul_f32 v125, v125, v60
    v_mul_f32 v126, v126, v60
    v_mul_f32 v127, v127, v60
    ds_read_b128 v[184:187], v49 offset:1024
    ds_read_b128 v[188:191], v49 offset:1040
    s_waitcnt lgkmcnt(0)
    v_max3_f32 v59, v184, v185, v186
    v_max3_f32 v59, v59, v187, v188
    v_max3_f32 v59, v59, v189, v190
    v_max_f32 v59, v59, v191
    v_mul_f32 v59, s36, v59
    v_max_f32 v59, v59, v51
    v_sub_f32 v60, v51, v59
    v_exp_f32 v60, v60
    v_mov_b32 v51, v59
    v_mul_f32 v54, v54, v60
    v_mul_f32 v128, v128, v60
    v_mul_f32 v129, v129, v60
    v_mul_f32 v130, v130, v60
    v_mul_f32 v131, v131, v60
    v_mul_f32 v132, v132, v60
    v_mul_f32 v133, v133, v60
    v_mul_f32 v134, v134, v60
    v_mul_f32 v135, v135, v60
    v_mul_f32 v136, v136, v60
    v_mul_f32 v137, v137, v60
    v_mul_f32 v138, v138, v60
    v_mul_f32 v139, v139, v60
    v_mul_f32 v140, v140, v60
    v_mul_f32 v141, v141, v60
    v_mul_f32 v142, v142, v60
    v_mul_f32 v143, v143, v60
    ds_read_b128 v[184:187], v49 offset:2048
    ds_read_b128 v[188:191], v49 offset:2064
    s_waitcnt lgkmcnt(0)
    v_max3_f32 v59, v184, v185, v186
    v_max3_f32 v59, v59, v187, v188
    v_max3_f32 v59, v59, v189, v190
    v_max_f32 v59, v59, v191
    v_mul_f32 v59, s36, v59
    v_max_f32 v59, v59, v52
    v_sub_f32 v60, v52, v59
    v_exp_f32 v60, v60
    v_mov_b32 v52, v59
    v_mul_f32 v55, v55, v60
    v_mul_f32 v144, v144, v60
    v_mul_f32 v145, v145, v60
    v_mul_f32 v146, v146, v60
    v_mul_f32 v147, v147, v60
    v_mul_f32 v148, v148, v60
    v_mul_f32 v149, v149, v60
    v_mul_f32 v150, v150, v60
    v_mul_f32 v151, v151, v60
    v_mul_f32 v152, v152, v60
    v_mul_f32 v153, v153, v60
    v_mul_f32 v154, v154, v60
    v_mul_f32 v155, v155, v60
    v_mul_f32 v156, v156, v60
    v_mul_f32 v157, v157, v60
    v_mul_f32 v158, v158, v60
    v_mul_f32 v159, v159, v60
    v_fma_f32 v184, v64, s36, -v50
    v_fma_f32 v185, v65, s36, -v50
    v_fma_f32 v186, v66, s36, -v50
    v_fma_f32 v187, v67, s36, -v50
    v_exp_f32 v184, v184
    v_exp_f32 v185, v185
    v_fma_f32 v188, v68, s36, -v50
    v_fma_f32 v189, v69, s36, -v50
    v_exp_f32 v186, v186
    v_exp_f32 v187, v187
    v_add_f32 v56, v184, v185
    v_cvt_pk_bf16_f32 v160, v184, v185
    v_fma_f32 v190, v70, s36, -v50
    v_fma_f32 v191, v71, s36, -v50
    v_exp_f32 v188, v188
    v_exp_f32 v189, v189
    v_add_f32 v56, v56, v186
    v_add_f32 v56, v56, v187
    v_cvt_pk_bf16_f32 v161, v186, v187
    v_fma_f32 v184, v72, s36, -v50
    v_fma_f32 v185, v73, s36, -v50
    v_exp_f32 v190, v190
    v_exp_f32 v191, v191
    v_add_f32 v56, v56, v188
    v_add_f32 v56, v56, v189
    v_cvt_pk_bf16_f32 v162, v188, v189
    v_fma_f32 v186, v74, s36, -v50
    v_fma_f32 v187, v75, s36, -v50
    v_exp_f32 v184, v184
    v_exp_f32 v185, v185
    v_add_f32 v56, v56, v190
    v_add_f32 v56, v56, v191
    v_cvt_pk_bf16_f32 v163, v190, v191
    v_fma_f32 v188, v76, s36, -v50
    v_fma_f32 v189, v77, s36, -v50
    v_exp_f32 v186, v186
    v_exp_f32 v187, v187
    v_add_f32 v56, v56, v184
    v_add_f32 v56, v56, v185
    v_cvt_pk_bf16_f32 v164, v184, v185
    v_fma_f32 v190, v78, s36, -v50
    v_fma_f32 v191, v79, s36, -v50
    v_exp_f32 v188, v188
    v_exp_f32 v189, v189
    v_add_f32 v56, v56, v186
    v_add_f32 v56, v56, v187
    v_cvt_pk_bf16_f32 v165, v186, v187
    v_exp_f32 v190, v190
    v_exp_f32 v191, v191
    v_add_f32 v56, v56, v188
    v_add_f32 v56, v56, v189
    v_cvt_pk_bf16_f32 v166, v188, v189
    v_add_f32 v56, v56, v190
    v_add_f32 v56, v56, v191
    v_cvt_pk_bf16_f32 v167, v190, v191
    v_fma_f32 v192, v80, s36, -v51
    v_fma_f32 v193, v81, s36, -v51
    v_fma_f32 v194, v82, s36, -v51
    v_fma_f32 v195, v83, s36, -v51
    v_exp_f32 v192, v192
    v_exp_f32 v193, v193
    v_fma_f32 v196, v84, s36, -v51
    v_fma_f32 v197, v85, s36, -v51
    v_exp_f32 v194, v194
    v_exp_f32 v195, v195
    v_add_f32 v57, v192, v193
    v_cvt_pk_bf16_f32 v168, v192, v193
    v_fma_f32 v198, v86, s36, -v51
    v_fma_f32 v199, v87, s36, -v51
    v_exp_f32 v196, v196
    v_exp_f32 v197, v197
    v_add_f32 v57, v57, v194
    v_add_f32 v57, v57, v195
    v_cvt_pk_bf16_f32 v169, v194, v195
    v_fma_f32 v192, v88, s36, -v51
    v_fma_f32 v193, v89, s36, -v51
    v_exp_f32 v198, v198
    v_exp_f32 v199, v199
    v_add_f32 v57, v57, v196
    v_add_f32 v57, v57, v197
    v_cvt_pk_bf16_f32 v170, v196, v197
    v_fma_f32 v194, v90, s36, -v51
    v_fma_f32 v195, v91, s36, -v51
    v_exp_f32 v192, v192
    v_exp_f32 v193, v193
    v_add_f32 v57, v57, v198
    v_add_f32 v57, v57, v199
    v_cvt_pk_bf16_f32 v171, v198, v199
    v_fma_f32 v196, v92, s36, -v51
    v_fma_f32 v197, v93, s36, -v51
    v_exp_f32 v194, v194
    v_exp_f32 v195, v195
    v_add_f32 v57, v57, v192
    v_add_f32 v57, v57, v193
    v_cvt_pk_bf16_f32 v172, v192, v193
    v_fma_f32 v198, v94, s36, -v51
    v_fma_f32 v199, v95, s36, -v51
    v_exp_f32 v196, v196
    v_exp_f32 v197, v197
    v_add_f32 v57, v57, v194
    v_add_f32 v57, v57, v195
    v_cvt_pk_bf16_f32 v173, v194, v195
    v_exp_f32 v198, v198
    v_exp_f32 v199, v199
    v_add_f32 v57, v57, v196
    v_add_f32 v57, v57, v197
    v_cvt_pk_bf16_f32 v174, v196, v197
    v_add_f32 v57, v57, v198
    v_add_f32 v57, v57, v199
    v_cvt_pk_bf16_f32 v175, v198, v199
    v_fma_f32 v184, v96, s36, -v52
    v_fma_f32 v185, v97, s36, -v52
    v_fma_f32 v186, v98, s36, -v52
    v_fma_f32 v187, v99, s36, -v52
    v_exp_f32 v184, v184
    v_exp_f32 v185, v185
    v_fma_f32 v188, v100, s36, -v52
    v_fma_f32 v189, v101, s36, -v52
    v_exp_f32 v186, v186
    v_exp_f32 v187, v187
    v_add_f32 v58, v184, v185
    v_cvt_pk_bf16_f32 v176, v184, v185
    v_fma_f32 v190, v102, s36, -v52
    v_fma_f32 v191, v103, s36, -v52
    v_exp_f32 v188, v188
    v_exp_f32 v189, v189
    v_add_f32 v58, v58, v186
    v_add_f32 v58, v58, v187
    v_cvt_pk_bf16_f32 v177, v186, v187
    v_fma_f32 v184, v104, s36, -v52
    v_fma_f32 v185, v105, s36, -v52
    v_exp_f32 v190, v190
    v_exp_f32 v191, v191
    v_add_f32 v58, v58, v188
    v_add_f32 v58, v58, v189
    v_cvt_pk_bf16_f32 v178, v188, v189
    v_fma_f32 v186, v106, s36, -v52
    v_fma_f32 v187, v107, s36, -v52
    v_exp_f32 v184, v184
    v_exp_f32 v185, v185
    v_add_f32 v58, v58, v190
    v_add_f32 v58, v58, v191
    v_cvt_pk_bf16_f32 v179, v190, v191
    v_fma_f32 v188, v108, s36, -v52
    v_fma_f32 v189, v109, s36, -v52
    v_exp_f32 v186, v186
    v_exp_f32 v187, v187
    v_add_f32 v58, v58, v184
    v_add_f32 v58, v58, v185
    v_cvt_pk_bf16_f32 v180, v184, v185
    v_fma_f32 v190, v110, s36, -v52
    v_fma_f32 v191, v111, s36, -v52
    v_exp_f32 v188, v188
    v_exp_f32 v189, v189
    v_add_f32 v58, v58, v186
    v_add_f32 v58, v58, v187
    v_cvt_pk_bf16_f32 v181, v186, v187
    v_exp_f32 v190, v190
    v_exp_f32 v191, v191
    v_add_f32 v58, v58, v188
    v_add_f32 v58, v58, v189
    v_cvt_pk_bf16_f32 v182, v188, v189
    v_add_f32 v58, v58, v190
    v_add_f32 v58, v58, v191
    v_cvt_pk_bf16_f32 v183, v190, v191
    ds_write_b128 v28, v[160:163] offset:0
    ds_write_b128 v28, v[164:167] offset:3072
    ds_write_b128 v28, v[168:171] offset:1024
    ds_write_b128 v28, v[172:175] offset:4096
    ds_write_b128 v28, v[176:179] offset:2048
    ds_write_b128 v28, v[180:183] offset:5120
    s_waitcnt lgkmcnt(0)
    s_branch Lpost_52
Lslow_72:
    s_nop 15
    v_max3_f32 v59, v64, v65, v66
    v_max3_f32 v59, v59, v67, v68
    v_max3_f32 v59, v59, v69, v70
    v_max3_f32 v59, v59, v71, v72
    v_max3_f32 v59, v59, v73, v74
    v_max3_f32 v59, v59, v75, v76
    v_max3_f32 v59, v59, v77, v78
    v_max_f32 v59, v59, v79
    v_max3_f32 v60, v80, v81, v82
    v_max3_f32 v60, v60, v83, v84
    v_max3_f32 v60, v60, v85, v86
    v_max3_f32 v60, v60, v87, v88
    v_max3_f32 v60, v60, v89, v90
    v_max3_f32 v60, v60, v91, v92
    v_max3_f32 v60, v60, v93, v94
    v_max_f32 v60, v60, v95
    v_max3_f32 v61, v96, v97, v98
    v_max3_f32 v61, v61, v99, v100
    v_max3_f32 v61, v61, v101, v102
    v_max3_f32 v61, v61, v103, v104
    v_max3_f32 v61, v61, v105, v106
    v_max3_f32 v61, v61, v107, v108
    v_max3_f32 v61, v61, v109, v110
    v_max_f32 v61, v61, v111
    s_waitcnt lgkmcnt(0)
    s_barrier
    ds_write_b32 v48, v59 offset:0
    ds_write_b32 v48, v60 offset:1024
    ds_write_b32 v48, v61 offset:2048
    s_waitcnt lgkmcnt(0)
    s_barrier
    ds_write_b32 v6, v7
    ds_read_b128 v[184:187], v49 offset:0
    ds_read_b128 v[188:191], v49 offset:16
    s_waitcnt lgkmcnt(0)
    v_max3_f32 v59, v184, v185, v186
    v_max3_f32 v59, v59, v187, v188
    v_max3_f32 v59, v59, v189, v190
    v_max_f32 v59, v59, v191
    v_mul_f32 v59, s36, v59
    v_max_f32 v59, v59, v50
    v_sub_f32 v60, v50, v59
    v_exp_f32 v60, v60
    v_mov_b32 v50, v59
    v_mul_f32 v53, v53, v60
    v_mul_f32 v112, v112, v60
    v_mul_f32 v113, v113, v60
    v_mul_f32 v114, v114, v60
    v_mul_f32 v115, v115, v60
    v_mul_f32 v116, v116, v60
    v_mul_f32 v117, v117, v60
    v_mul_f32 v118, v118, v60
    v_mul_f32 v119, v119, v60
    v_mul_f32 v120, v120, v60
    v_mul_f32 v121, v121, v60
    v_mul_f32 v122, v122, v60
    v_mul_f32 v123, v123, v60
    v_mul_f32 v124, v124, v60
    v_mul_f32 v125, v125, v60
    v_mul_f32 v126, v126, v60
    v_mul_f32 v127, v127, v60
    ds_read_b128 v[184:187], v49 offset:1024
    ds_read_b128 v[188:191], v49 offset:1040
    s_waitcnt lgkmcnt(0)
    v_max3_f32 v59, v184, v185, v186
    v_max3_f32 v59, v59, v187, v188
    v_max3_f32 v59, v59, v189, v190
    v_max_f32 v59, v59, v191
    v_mul_f32 v59, s36, v59
    v_max_f32 v59, v59, v51
    v_sub_f32 v60, v51, v59
    v_exp_f32 v60, v60
    v_mov_b32 v51, v59
    v_mul_f32 v54, v54, v60
    v_mul_f32 v128, v128, v60
    v_mul_f32 v129, v129, v60
    v_mul_f32 v130, v130, v60
    v_mul_f32 v131, v131, v60
    v_mul_f32 v132, v132, v60
    v_mul_f32 v133, v133, v60
    v_mul_f32 v134, v134, v60
    v_mul_f32 v135, v135, v60
    v_mul_f32 v136, v136, v60
    v_mul_f32 v137, v137, v60
    v_mul_f32 v138, v138, v60
    v_mul_f32 v139, v139, v60
    v_mul_f32 v140, v140, v60
    v_mul_f32 v141, v141, v60
    v_mul_f32 v142, v142, v60
    v_mul_f32 v143, v143, v60
    ds_read_b128 v[184:187], v49 offset:2048
    ds_read_b128 v[188:191], v49 offset:2064
    s_waitcnt lgkmcnt(0)
    v_max3_f32 v59, v184, v185, v186
    v_max3_f32 v59, v59, v187, v188
    v_max3_f32 v59, v59, v189, v190
    v_max_f32 v59, v59, v191
    v_mul_f32 v59, s36, v59
    v_max_f32 v59, v59, v52
    v_sub_f32 v60, v52, v59
    v_exp_f32 v60, v60
    v_mov_b32 v52, v59
    v_mul_f32 v55, v55, v60
    v_mul_f32 v144, v144, v60
    v_mul_f32 v145, v145, v60
    v_mul_f32 v146, v146, v60
    v_mul_f32 v147, v147, v60
    v_mul_f32 v148, v148, v60
    v_mul_f32 v149, v149, v60
    v_mul_f32 v150, v150, v60
    v_mul_f32 v151, v151, v60
    v_mul_f32 v152, v152, v60
    v_mul_f32 v153, v153, v60
    v_mul_f32 v154, v154, v60
    v_mul_f32 v155, v155, v60
    v_mul_f32 v156, v156, v60
    v_mul_f32 v157, v157, v60
    v_mul_f32 v158, v158, v60
    v_mul_f32 v159, v159, v60
    v_fma_f32 v184, v64, s36, -v50
    v_fma_f32 v185, v65, s36, -v50
    v_fma_f32 v186, v66, s36, -v50
    v_fma_f32 v187, v67, s36, -v50
    v_exp_f32 v184, v184
    v_exp_f32 v185, v185
    v_fma_f32 v188, v68, s36, -v50
    v_fma_f32 v189, v69, s36, -v50
    v_exp_f32 v186, v186
    v_exp_f32 v187, v187
    v_add_f32 v56, v184, v185
    v_cvt_pk_bf16_f32 v160, v184, v185
    v_fma_f32 v190, v70, s36, -v50
    v_fma_f32 v191, v71, s36, -v50
    v_exp_f32 v188, v188
    v_exp_f32 v189, v189
    v_add_f32 v56, v56, v186
    v_add_f32 v56, v56, v187
    v_cvt_pk_bf16_f32 v161, v186, v187
    v_fma_f32 v184, v72, s36, -v50
    v_fma_f32 v185, v73, s36, -v50
    v_exp_f32 v190, v190
    v_exp_f32 v191, v191
    v_add_f32 v56, v56, v188
    v_add_f32 v56, v56, v189
    v_cvt_pk_bf16_f32 v162, v188, v189
    v_fma_f32 v186, v74, s36, -v50
    v_fma_f32 v187, v75, s36, -v50
    v_exp_f32 v184, v184
    v_exp_f32 v185, v185
    v_add_f32 v56, v56, v190
    v_add_f32 v56, v56, v191
    v_cvt_pk_bf16_f32 v163, v190, v191
    v_fma_f32 v188, v76, s36, -v50
    v_fma_f32 v189, v77, s36, -v50
    v_exp_f32 v186, v186
    v_exp_f32 v187, v187
    v_add_f32 v56, v56, v184
    v_add_f32 v56, v56, v185
    v_cvt_pk_bf16_f32 v164, v184, v185
    v_fma_f32 v190, v78, s36, -v50
    v_fma_f32 v191, v79, s36, -v50
    v_exp_f32 v188, v188
    v_exp_f32 v189, v189
    v_add_f32 v56, v56, v186
    v_add_f32 v56, v56, v187
    v_cvt_pk_bf16_f32 v165, v186, v187
    v_exp_f32 v190, v190
    v_exp_f32 v191, v191
    v_add_f32 v56, v56, v188
    v_add_f32 v56, v56, v189
    v_cvt_pk_bf16_f32 v166, v188, v189
    v_add_f32 v56, v56, v190
    v_add_f32 v56, v56, v191
    v_cvt_pk_bf16_f32 v167, v190, v191
    v_fma_f32 v192, v80, s36, -v51
    v_fma_f32 v193, v81, s36, -v51
    v_fma_f32 v194, v82, s36, -v51
    v_fma_f32 v195, v83, s36, -v51
    v_exp_f32 v192, v192
    v_exp_f32 v193, v193
    v_fma_f32 v196, v84, s36, -v51
    v_fma_f32 v197, v85, s36, -v51
    v_exp_f32 v194, v194
    v_exp_f32 v195, v195
    v_add_f32 v57, v192, v193
    v_cvt_pk_bf16_f32 v168, v192, v193
    v_fma_f32 v198, v86, s36, -v51
    v_fma_f32 v199, v87, s36, -v51
    v_exp_f32 v196, v196
    v_exp_f32 v197, v197
    v_add_f32 v57, v57, v194
    v_add_f32 v57, v57, v195
    v_cvt_pk_bf16_f32 v169, v194, v195
    v_fma_f32 v192, v88, s36, -v51
    v_fma_f32 v193, v89, s36, -v51
    v_exp_f32 v198, v198
    v_exp_f32 v199, v199
    v_add_f32 v57, v57, v196
    v_add_f32 v57, v57, v197
    v_cvt_pk_bf16_f32 v170, v196, v197
    v_fma_f32 v194, v90, s36, -v51
    v_fma_f32 v195, v91, s36, -v51
    v_exp_f32 v192, v192
    v_exp_f32 v193, v193
    v_add_f32 v57, v57, v198
    v_add_f32 v57, v57, v199
    v_cvt_pk_bf16_f32 v171, v198, v199
    v_fma_f32 v196, v92, s36, -v51
    v_fma_f32 v197, v93, s36, -v51
    v_exp_f32 v194, v194
    v_exp_f32 v195, v195
    v_add_f32 v57, v57, v192
    v_add_f32 v57, v57, v193
    v_cvt_pk_bf16_f32 v172, v192, v193
    v_fma_f32 v198, v94, s36, -v51
    v_fma_f32 v199, v95, s36, -v51
    v_exp_f32 v196, v196
    v_exp_f32 v197, v197
    v_add_f32 v57, v57, v194
    v_add_f32 v57, v57, v195
    v_cvt_pk_bf16_f32 v173, v194, v195
    v_exp_f32 v198, v198
    v_exp_f32 v199, v199
    v_add_f32 v57, v57, v196
    v_add_f32 v57, v57, v197
    v_cvt_pk_bf16_f32 v174, v196, v197
    v_add_f32 v57, v57, v198
    v_add_f32 v57, v57, v199
    v_cvt_pk_bf16_f32 v175, v198, v199
    v_fma_f32 v184, v96, s36, -v52
    v_fma_f32 v185, v97, s36, -v52
    v_fma_f32 v186, v98, s36, -v52
    v_fma_f32 v187, v99, s36, -v52
    v_exp_f32 v184, v184
    v_exp_f32 v185, v185
    v_fma_f32 v188, v100, s36, -v52
    v_fma_f32 v189, v101, s36, -v52
    v_exp_f32 v186, v186
    v_exp_f32 v187, v187
    v_add_f32 v58, v184, v185
    v_cvt_pk_bf16_f32 v176, v184, v185
    v_fma_f32 v190, v102, s36, -v52
    v_fma_f32 v191, v103, s36, -v52
    v_exp_f32 v188, v188
    v_exp_f32 v189, v189
    v_add_f32 v58, v58, v186
    v_add_f32 v58, v58, v187
    v_cvt_pk_bf16_f32 v177, v186, v187
    v_fma_f32 v184, v104, s36, -v52
    v_fma_f32 v185, v105, s36, -v52
    v_exp_f32 v190, v190
    v_exp_f32 v191, v191
    v_add_f32 v58, v58, v188
    v_add_f32 v58, v58, v189
    v_cvt_pk_bf16_f32 v178, v188, v189
    v_fma_f32 v186, v106, s36, -v52
    v_fma_f32 v187, v107, s36, -v52
    v_exp_f32 v184, v184
    v_exp_f32 v185, v185
    v_add_f32 v58, v58, v190
    v_add_f32 v58, v58, v191
    v_cvt_pk_bf16_f32 v179, v190, v191
    v_fma_f32 v188, v108, s36, -v52
    v_fma_f32 v189, v109, s36, -v52
    v_exp_f32 v186, v186
    v_exp_f32 v187, v187
    v_add_f32 v58, v58, v184
    v_add_f32 v58, v58, v185
    v_cvt_pk_bf16_f32 v180, v184, v185
    v_fma_f32 v190, v110, s36, -v52
    v_fma_f32 v191, v111, s36, -v52
    v_exp_f32 v188, v188
    v_exp_f32 v189, v189
    v_add_f32 v58, v58, v186
    v_add_f32 v58, v58, v187
    v_cvt_pk_bf16_f32 v181, v186, v187
    v_exp_f32 v190, v190
    v_exp_f32 v191, v191
    v_add_f32 v58, v58, v188
    v_add_f32 v58, v58, v189
    v_cvt_pk_bf16_f32 v182, v188, v189
    v_add_f32 v58, v58, v190
    v_add_f32 v58, v58, v191
    v_cvt_pk_bf16_f32 v183, v190, v191
    ds_write_b128 v28, v[160:163] offset:0
    ds_write_b128 v28, v[164:167] offset:3072
    ds_write_b128 v28, v[168:171] offset:1024
    ds_write_b128 v28, v[172:175] offset:4096
    ds_write_b128 v28, v[176:179] offset:2048
    ds_write_b128 v28, v[180:183] offset:5120
    s_waitcnt lgkmcnt(0)
    s_branch Lpost_71
Lslow_75:
    s_nop 15
    v_max3_f32 v59, v64, v65, v66
    v_max3_f32 v59, v59, v67, v68
    v_max3_f32 v59, v59, v69, v70
    v_max3_f32 v59, v59, v71, v72
    v_max3_f32 v59, v59, v73, v74
    v_max3_f32 v59, v59, v75, v76
    v_max3_f32 v59, v59, v77, v78
    v_max_f32 v59, v59, v79
    v_max3_f32 v60, v80, v81, v82
    v_max3_f32 v60, v60, v83, v84
    v_max3_f32 v60, v60, v85, v86
    v_max3_f32 v60, v60, v87, v88
    v_max3_f32 v60, v60, v89, v90
    v_max3_f32 v60, v60, v91, v92
    v_max3_f32 v60, v60, v93, v94
    v_max_f32 v60, v60, v95
    v_max3_f32 v61, v96, v97, v98
    v_max3_f32 v61, v61, v99, v100
    v_max3_f32 v61, v61, v101, v102
    v_max3_f32 v61, v61, v103, v104
    v_max3_f32 v61, v61, v105, v106
    v_max3_f32 v61, v61, v107, v108
    v_max3_f32 v61, v61, v109, v110
    v_max_f32 v61, v61, v111
    s_waitcnt lgkmcnt(0)
    s_barrier
    ds_write_b32 v48, v59 offset:0
    ds_write_b32 v48, v60 offset:1024
    ds_write_b32 v48, v61 offset:2048
    s_waitcnt lgkmcnt(0)
    s_barrier
    ds_write_b32 v6, v7
    ds_read_b128 v[184:187], v49 offset:0
    ds_read_b128 v[188:191], v49 offset:16
    s_waitcnt lgkmcnt(0)
    v_max3_f32 v59, v184, v185, v186
    v_max3_f32 v59, v59, v187, v188
    v_max3_f32 v59, v59, v189, v190
    v_max_f32 v59, v59, v191
    v_mul_f32 v59, s36, v59
    v_max_f32 v59, v59, v50
    v_sub_f32 v60, v50, v59
    v_exp_f32 v60, v60
    v_mov_b32 v50, v59
    v_mul_f32 v53, v53, v60
    v_mul_f32 v112, v112, v60
    v_mul_f32 v113, v113, v60
    v_mul_f32 v114, v114, v60
    v_mul_f32 v115, v115, v60
    v_mul_f32 v116, v116, v60
    v_mul_f32 v117, v117, v60
    v_mul_f32 v118, v118, v60
    v_mul_f32 v119, v119, v60
    v_mul_f32 v120, v120, v60
    v_mul_f32 v121, v121, v60
    v_mul_f32 v122, v122, v60
    v_mul_f32 v123, v123, v60
    v_mul_f32 v124, v124, v60
    v_mul_f32 v125, v125, v60
    v_mul_f32 v126, v126, v60
    v_mul_f32 v127, v127, v60
    ds_read_b128 v[184:187], v49 offset:1024
    ds_read_b128 v[188:191], v49 offset:1040
    s_waitcnt lgkmcnt(0)
    v_max3_f32 v59, v184, v185, v186
    v_max3_f32 v59, v59, v187, v188
    v_max3_f32 v59, v59, v189, v190
    v_max_f32 v59, v59, v191
    v_mul_f32 v59, s36, v59
    v_max_f32 v59, v59, v51
    v_sub_f32 v60, v51, v59
    v_exp_f32 v60, v60
    v_mov_b32 v51, v59
    v_mul_f32 v54, v54, v60
    v_mul_f32 v128, v128, v60
    v_mul_f32 v129, v129, v60
    v_mul_f32 v130, v130, v60
    v_mul_f32 v131, v131, v60
    v_mul_f32 v132, v132, v60
    v_mul_f32 v133, v133, v60
    v_mul_f32 v134, v134, v60
    v_mul_f32 v135, v135, v60
    v_mul_f32 v136, v136, v60
    v_mul_f32 v137, v137, v60
    v_mul_f32 v138, v138, v60
    v_mul_f32 v139, v139, v60
    v_mul_f32 v140, v140, v60
    v_mul_f32 v141, v141, v60
    v_mul_f32 v142, v142, v60
    v_mul_f32 v143, v143, v60
    ds_read_b128 v[184:187], v49 offset:2048
    ds_read_b128 v[188:191], v49 offset:2064
    s_waitcnt lgkmcnt(0)
    v_max3_f32 v59, v184, v185, v186
    v_max3_f32 v59, v59, v187, v188
    v_max3_f32 v59, v59, v189, v190
    v_max_f32 v59, v59, v191
    v_mul_f32 v59, s36, v59
    v_max_f32 v59, v59, v52
    v_sub_f32 v60, v52, v59
    v_exp_f32 v60, v60
    v_mov_b32 v52, v59
    v_mul_f32 v55, v55, v60
    v_mul_f32 v144, v144, v60
    v_mul_f32 v145, v145, v60
    v_mul_f32 v146, v146, v60
    v_mul_f32 v147, v147, v60
    v_mul_f32 v148, v148, v60
    v_mul_f32 v149, v149, v60
    v_mul_f32 v150, v150, v60
    v_mul_f32 v151, v151, v60
    v_mul_f32 v152, v152, v60
    v_mul_f32 v153, v153, v60
    v_mul_f32 v154, v154, v60
    v_mul_f32 v155, v155, v60
    v_mul_f32 v156, v156, v60
    v_mul_f32 v157, v157, v60
    v_mul_f32 v158, v158, v60
    v_mul_f32 v159, v159, v60
    v_fma_f32 v184, v64, s36, -v50
    v_fma_f32 v185, v65, s36, -v50
    v_fma_f32 v186, v66, s36, -v50
    v_fma_f32 v187, v67, s36, -v50
    v_exp_f32 v184, v184
    v_exp_f32 v185, v185
    v_fma_f32 v188, v68, s36, -v50
    v_fma_f32 v189, v69, s36, -v50
    v_exp_f32 v186, v186
    v_exp_f32 v187, v187
    v_add_f32 v56, v184, v185
    v_cvt_pk_bf16_f32 v160, v184, v185
    v_fma_f32 v190, v70, s36, -v50
    v_fma_f32 v191, v71, s36, -v50
    v_exp_f32 v188, v188
    v_exp_f32 v189, v189
    v_add_f32 v56, v56, v186
    v_add_f32 v56, v56, v187
    v_cvt_pk_bf16_f32 v161, v186, v187
    v_fma_f32 v184, v72, s36, -v50
    v_fma_f32 v185, v73, s36, -v50
    v_exp_f32 v190, v190
    v_exp_f32 v191, v191
    v_add_f32 v56, v56, v188
    v_add_f32 v56, v56, v189
    v_cvt_pk_bf16_f32 v162, v188, v189
    v_fma_f32 v186, v74, s36, -v50
    v_fma_f32 v187, v75, s36, -v50
    v_exp_f32 v184, v184
    v_exp_f32 v185, v185
    v_add_f32 v56, v56, v190
    v_add_f32 v56, v56, v191
    v_cvt_pk_bf16_f32 v163, v190, v191
    v_fma_f32 v188, v76, s36, -v50
    v_fma_f32 v189, v77, s36, -v50
    v_exp_f32 v186, v186
    v_exp_f32 v187, v187
    v_add_f32 v56, v56, v184
    v_add_f32 v56, v56, v185
    v_cvt_pk_bf16_f32 v164, v184, v185
    v_fma_f32 v190, v78, s36, -v50
    v_fma_f32 v191, v79, s36, -v50
    v_exp_f32 v188, v188
    v_exp_f32 v189, v189
    v_add_f32 v56, v56, v186
    v_add_f32 v56, v56, v187
    v_cvt_pk_bf16_f32 v165, v186, v187
    v_exp_f32 v190, v190
    v_exp_f32 v191, v191
    v_add_f32 v56, v56, v188
    v_add_f32 v56, v56, v189
    v_cvt_pk_bf16_f32 v166, v188, v189
    v_add_f32 v56, v56, v190
    v_add_f32 v56, v56, v191
    v_cvt_pk_bf16_f32 v167, v190, v191
    v_fma_f32 v192, v80, s36, -v51
    v_fma_f32 v193, v81, s36, -v51
    v_fma_f32 v194, v82, s36, -v51
    v_fma_f32 v195, v83, s36, -v51
    v_exp_f32 v192, v192
    v_exp_f32 v193, v193
    v_fma_f32 v196, v84, s36, -v51
    v_fma_f32 v197, v85, s36, -v51
    v_exp_f32 v194, v194
    v_exp_f32 v195, v195
    v_add_f32 v57, v192, v193
    v_cvt_pk_bf16_f32 v168, v192, v193
    v_fma_f32 v198, v86, s36, -v51
    v_fma_f32 v199, v87, s36, -v51
    v_exp_f32 v196, v196
    v_exp_f32 v197, v197
    v_add_f32 v57, v57, v194
    v_add_f32 v57, v57, v195
    v_cvt_pk_bf16_f32 v169, v194, v195
    v_fma_f32 v192, v88, s36, -v51
    v_fma_f32 v193, v89, s36, -v51
    v_exp_f32 v198, v198
    v_exp_f32 v199, v199
    v_add_f32 v57, v57, v196
    v_add_f32 v57, v57, v197
    v_cvt_pk_bf16_f32 v170, v196, v197
    v_fma_f32 v194, v90, s36, -v51
    v_fma_f32 v195, v91, s36, -v51
    v_exp_f32 v192, v192
    v_exp_f32 v193, v193
    v_add_f32 v57, v57, v198
    v_add_f32 v57, v57, v199
    v_cvt_pk_bf16_f32 v171, v198, v199
    v_fma_f32 v196, v92, s36, -v51
    v_fma_f32 v197, v93, s36, -v51
    v_exp_f32 v194, v194
    v_exp_f32 v195, v195
    v_add_f32 v57, v57, v192
    v_add_f32 v57, v57, v193
    v_cvt_pk_bf16_f32 v172, v192, v193
    v_fma_f32 v198, v94, s36, -v51
    v_fma_f32 v199, v95, s36, -v51
    v_exp_f32 v196, v196
    v_exp_f32 v197, v197
    v_add_f32 v57, v57, v194
    v_add_f32 v57, v57, v195
    v_cvt_pk_bf16_f32 v173, v194, v195
    v_exp_f32 v198, v198
    v_exp_f32 v199, v199
    v_add_f32 v57, v57, v196
    v_add_f32 v57, v57, v197
    v_cvt_pk_bf16_f32 v174, v196, v197
    v_add_f32 v57, v57, v198
    v_add_f32 v57, v57, v199
    v_cvt_pk_bf16_f32 v175, v198, v199
    v_fma_f32 v184, v96, s36, -v52
    v_fma_f32 v185, v97, s36, -v52
    v_fma_f32 v186, v98, s36, -v52
    v_fma_f32 v187, v99, s36, -v52
    v_exp_f32 v184, v184
    v_exp_f32 v185, v185
    v_fma_f32 v188, v100, s36, -v52
    v_fma_f32 v189, v101, s36, -v52
    v_exp_f32 v186, v186
    v_exp_f32 v187, v187
    v_add_f32 v58, v184, v185
    v_cvt_pk_bf16_f32 v176, v184, v185
    v_fma_f32 v190, v102, s36, -v52
    v_fma_f32 v191, v103, s36, -v52
    v_exp_f32 v188, v188
    v_exp_f32 v189, v189
    v_add_f32 v58, v58, v186
    v_add_f32 v58, v58, v187
    v_cvt_pk_bf16_f32 v177, v186, v187
    v_fma_f32 v184, v104, s36, -v52
    v_fma_f32 v185, v105, s36, -v52
    v_exp_f32 v190, v190
    v_exp_f32 v191, v191
    v_add_f32 v58, v58, v188
    v_add_f32 v58, v58, v189
    v_cvt_pk_bf16_f32 v178, v188, v189
    v_fma_f32 v186, v106, s36, -v52
    v_fma_f32 v187, v107, s36, -v52
    v_exp_f32 v184, v184
    v_exp_f32 v185, v185
    v_add_f32 v58, v58, v190
    v_add_f32 v58, v58, v191
    v_cvt_pk_bf16_f32 v179, v190, v191
    v_fma_f32 v188, v108, s36, -v52
    v_fma_f32 v189, v109, s36, -v52
    v_exp_f32 v186, v186
    v_exp_f32 v187, v187
    v_add_f32 v58, v58, v184
    v_add_f32 v58, v58, v185
    v_cvt_pk_bf16_f32 v180, v184, v185
    v_fma_f32 v190, v110, s36, -v52
    v_fma_f32 v191, v111, s36, -v52
    v_exp_f32 v188, v188
    v_exp_f32 v189, v189
    v_add_f32 v58, v58, v186
    v_add_f32 v58, v58, v187
    v_cvt_pk_bf16_f32 v181, v186, v187
    v_exp_f32 v190, v190
    v_exp_f32 v191, v191
    v_add_f32 v58, v58, v188
    v_add_f32 v58, v58, v189
    v_cvt_pk_bf16_f32 v182, v188, v189
    v_add_f32 v58, v58, v190
    v_add_f32 v58, v58, v191
    v_cvt_pk_bf16_f32 v183, v190, v191
    ds_write_b128 v28, v[160:163] offset:0
    ds_write_b128 v28, v[164:167] offset:3072
    ds_write_b128 v28, v[168:171] offset:1024
    ds_write_b128 v28, v[172:175] offset:4096
    ds_write_b128 v28, v[176:179] offset:2048
    ds_write_b128 v28, v[180:183] offset:5120
    s_waitcnt lgkmcnt(0)
    s_branch Lpost_74
Lslow_78:
    s_nop 15
    v_max3_f32 v59, v64, v65, v66
    v_max3_f32 v59, v59, v67, v68
    v_max3_f32 v59, v59, v69, v70
    v_max3_f32 v59, v59, v71, v72
    v_max3_f32 v59, v59, v73, v74
    v_max3_f32 v59, v59, v75, v76
    v_max3_f32 v59, v59, v77, v78
    v_max_f32 v59, v59, v79
    v_max3_f32 v60, v80, v81, v82
    v_max3_f32 v60, v60, v83, v84
    v_max3_f32 v60, v60, v85, v86
    v_max3_f32 v60, v60, v87, v88
    v_max3_f32 v60, v60, v89, v90
    v_max3_f32 v60, v60, v91, v92
    v_max3_f32 v60, v60, v93, v94
    v_max_f32 v60, v60, v95
    v_max3_f32 v61, v96, v97, v98
    v_max3_f32 v61, v61, v99, v100
    v_max3_f32 v61, v61, v101, v102
    v_max3_f32 v61, v61, v103, v104
    v_max3_f32 v61, v61, v105, v106
    v_max3_f32 v61, v61, v107, v108
    v_max3_f32 v61, v61, v109, v110
    v_max_f32 v61, v61, v111
    s_waitcnt lgkmcnt(0)
    s_barrier
    ds_write_b32 v48, v59 offset:0
    ds_write_b32 v48, v60 offset:1024
    ds_write_b32 v48, v61 offset:2048
    s_waitcnt lgkmcnt(0)
    s_barrier
    ds_write_b32 v6, v7
    ds_read_b128 v[184:187], v49 offset:0
    ds_read_b128 v[188:191], v49 offset:16
    s_waitcnt lgkmcnt(0)
    v_max3_f32 v59, v184, v185, v186
    v_max3_f32 v59, v59, v187, v188
    v_max3_f32 v59, v59, v189, v190
    v_max_f32 v59, v59, v191
    v_mul_f32 v59, s36, v59
    v_max_f32 v59, v59, v50
    v_sub_f32 v60, v50, v59
    v_exp_f32 v60, v60
    v_mov_b32 v50, v59
    v_mul_f32 v53, v53, v60
    v_mul_f32 v112, v112, v60
    v_mul_f32 v113, v113, v60
    v_mul_f32 v114, v114, v60
    v_mul_f32 v115, v115, v60
    v_mul_f32 v116, v116, v60
    v_mul_f32 v117, v117, v60
    v_mul_f32 v118, v118, v60
    v_mul_f32 v119, v119, v60
    v_mul_f32 v120, v120, v60
    v_mul_f32 v121, v121, v60
    v_mul_f32 v122, v122, v60
    v_mul_f32 v123, v123, v60
    v_mul_f32 v124, v124, v60
    v_mul_f32 v125, v125, v60
    v_mul_f32 v126, v126, v60
    v_mul_f32 v127, v127, v60
    ds_read_b128 v[184:187], v49 offset:1024
    ds_read_b128 v[188:191], v49 offset:1040
    s_waitcnt lgkmcnt(0)
    v_max3_f32 v59, v184, v185, v186
    v_max3_f32 v59, v59, v187, v188
    v_max3_f32 v59, v59, v189, v190
    v_max_f32 v59, v59, v191
    v_mul_f32 v59, s36, v59
    v_max_f32 v59, v59, v51
    v_sub_f32 v60, v51, v59
    v_exp_f32 v60, v60
    v_mov_b32 v51, v59
    v_mul_f32 v54, v54, v60
    v_mul_f32 v128, v128, v60
    v_mul_f32 v129, v129, v60
    v_mul_f32 v130, v130, v60
    v_mul_f32 v131, v131, v60
    v_mul_f32 v132, v132, v60
    v_mul_f32 v133, v133, v60
    v_mul_f32 v134, v134, v60
    v_mul_f32 v135, v135, v60
    v_mul_f32 v136, v136, v60
    v_mul_f32 v137, v137, v60
    v_mul_f32 v138, v138, v60
    v_mul_f32 v139, v139, v60
    v_mul_f32 v140, v140, v60
    v_mul_f32 v141, v141, v60
    v_mul_f32 v142, v142, v60
    v_mul_f32 v143, v143, v60
    ds_read_b128 v[184:187], v49 offset:2048
    ds_read_b128 v[188:191], v49 offset:2064
    s_waitcnt lgkmcnt(0)
    v_max3_f32 v59, v184, v185, v186
    v_max3_f32 v59, v59, v187, v188
    v_max3_f32 v59, v59, v189, v190
    v_max_f32 v59, v59, v191
    v_mul_f32 v59, s36, v59
    v_max_f32 v59, v59, v52
    v_sub_f32 v60, v52, v59
    v_exp_f32 v60, v60
    v_mov_b32 v52, v59
    v_mul_f32 v55, v55, v60
    v_mul_f32 v144, v144, v60
    v_mul_f32 v145, v145, v60
    v_mul_f32 v146, v146, v60
    v_mul_f32 v147, v147, v60
    v_mul_f32 v148, v148, v60
    v_mul_f32 v149, v149, v60
    v_mul_f32 v150, v150, v60
    v_mul_f32 v151, v151, v60
    v_mul_f32 v152, v152, v60
    v_mul_f32 v153, v153, v60
    v_mul_f32 v154, v154, v60
    v_mul_f32 v155, v155, v60
    v_mul_f32 v156, v156, v60
    v_mul_f32 v157, v157, v60
    v_mul_f32 v158, v158, v60
    v_mul_f32 v159, v159, v60
    v_fma_f32 v184, v64, s36, -v50
    v_fma_f32 v185, v65, s36, -v50
    v_fma_f32 v186, v66, s36, -v50
    v_fma_f32 v187, v67, s36, -v50
    v_exp_f32 v184, v184
    v_exp_f32 v185, v185
    v_fma_f32 v188, v68, s36, -v50
    v_fma_f32 v189, v69, s36, -v50
    v_exp_f32 v186, v186
    v_exp_f32 v187, v187
    v_add_f32 v56, v184, v185
    v_cvt_pk_bf16_f32 v160, v184, v185
    v_fma_f32 v190, v70, s36, -v50
    v_fma_f32 v191, v71, s36, -v50
    v_exp_f32 v188, v188
    v_exp_f32 v189, v189
    v_add_f32 v56, v56, v186
    v_add_f32 v56, v56, v187
    v_cvt_pk_bf16_f32 v161, v186, v187
    v_fma_f32 v184, v72, s36, -v50
    v_fma_f32 v185, v73, s36, -v50
    v_exp_f32 v190, v190
    v_exp_f32 v191, v191
    v_add_f32 v56, v56, v188
    v_add_f32 v56, v56, v189
    v_cvt_pk_bf16_f32 v162, v188, v189
    v_fma_f32 v186, v74, s36, -v50
    v_fma_f32 v187, v75, s36, -v50
    v_exp_f32 v184, v184
    v_exp_f32 v185, v185
    v_add_f32 v56, v56, v190
    v_add_f32 v56, v56, v191
    v_cvt_pk_bf16_f32 v163, v190, v191
    v_fma_f32 v188, v76, s36, -v50
    v_fma_f32 v189, v77, s36, -v50
    v_exp_f32 v186, v186
    v_exp_f32 v187, v187
    v_add_f32 v56, v56, v184
    v_add_f32 v56, v56, v185
    v_cvt_pk_bf16_f32 v164, v184, v185
    v_fma_f32 v190, v78, s36, -v50
    v_fma_f32 v191, v79, s36, -v50
    v_exp_f32 v188, v188
    v_exp_f32 v189, v189
    v_add_f32 v56, v56, v186
    v_add_f32 v56, v56, v187
    v_cvt_pk_bf16_f32 v165, v186, v187
    v_exp_f32 v190, v190
    v_exp_f32 v191, v191
    v_add_f32 v56, v56, v188
    v_add_f32 v56, v56, v189
    v_cvt_pk_bf16_f32 v166, v188, v189
    v_add_f32 v56, v56, v190
    v_add_f32 v56, v56, v191
    v_cvt_pk_bf16_f32 v167, v190, v191
    v_fma_f32 v192, v80, s36, -v51
    v_fma_f32 v193, v81, s36, -v51
    v_fma_f32 v194, v82, s36, -v51
    v_fma_f32 v195, v83, s36, -v51
    v_exp_f32 v192, v192
    v_exp_f32 v193, v193
    v_fma_f32 v196, v84, s36, -v51
    v_fma_f32 v197, v85, s36, -v51
    v_exp_f32 v194, v194
    v_exp_f32 v195, v195
    v_add_f32 v57, v192, v193
    v_cvt_pk_bf16_f32 v168, v192, v193
    v_fma_f32 v198, v86, s36, -v51
    v_fma_f32 v199, v87, s36, -v51
    v_exp_f32 v196, v196
    v_exp_f32 v197, v197
    v_add_f32 v57, v57, v194
    v_add_f32 v57, v57, v195
    v_cvt_pk_bf16_f32 v169, v194, v195
    v_fma_f32 v192, v88, s36, -v51
    v_fma_f32 v193, v89, s36, -v51
    v_exp_f32 v198, v198
    v_exp_f32 v199, v199
    v_add_f32 v57, v57, v196
    v_add_f32 v57, v57, v197
    v_cvt_pk_bf16_f32 v170, v196, v197
    v_fma_f32 v194, v90, s36, -v51
    v_fma_f32 v195, v91, s36, -v51
    v_exp_f32 v192, v192
    v_exp_f32 v193, v193
    v_add_f32 v57, v57, v198
    v_add_f32 v57, v57, v199
    v_cvt_pk_bf16_f32 v171, v198, v199
    v_fma_f32 v196, v92, s36, -v51
    v_fma_f32 v197, v93, s36, -v51
    v_exp_f32 v194, v194
    v_exp_f32 v195, v195
    v_add_f32 v57, v57, v192
    v_add_f32 v57, v57, v193
    v_cvt_pk_bf16_f32 v172, v192, v193
    v_fma_f32 v198, v94, s36, -v51
    v_fma_f32 v199, v95, s36, -v51
    v_exp_f32 v196, v196
    v_exp_f32 v197, v197
    v_add_f32 v57, v57, v194
    v_add_f32 v57, v57, v195
    v_cvt_pk_bf16_f32 v173, v194, v195
    v_exp_f32 v198, v198
    v_exp_f32 v199, v199
    v_add_f32 v57, v57, v196
    v_add_f32 v57, v57, v197
    v_cvt_pk_bf16_f32 v174, v196, v197
    v_add_f32 v57, v57, v198
    v_add_f32 v57, v57, v199
    v_cvt_pk_bf16_f32 v175, v198, v199
    v_fma_f32 v184, v96, s36, -v52
    v_fma_f32 v185, v97, s36, -v52
    v_fma_f32 v186, v98, s36, -v52
    v_fma_f32 v187, v99, s36, -v52
    v_exp_f32 v184, v184
    v_exp_f32 v185, v185
    v_fma_f32 v188, v100, s36, -v52
    v_fma_f32 v189, v101, s36, -v52
    v_exp_f32 v186, v186
    v_exp_f32 v187, v187
    v_add_f32 v58, v184, v185
    v_cvt_pk_bf16_f32 v176, v184, v185
    v_fma_f32 v190, v102, s36, -v52
    v_fma_f32 v191, v103, s36, -v52
    v_exp_f32 v188, v188
    v_exp_f32 v189, v189
    v_add_f32 v58, v58, v186
    v_add_f32 v58, v58, v187
    v_cvt_pk_bf16_f32 v177, v186, v187
    v_fma_f32 v184, v104, s36, -v52
    v_fma_f32 v185, v105, s36, -v52
    v_exp_f32 v190, v190
    v_exp_f32 v191, v191
    v_add_f32 v58, v58, v188
    v_add_f32 v58, v58, v189
    v_cvt_pk_bf16_f32 v178, v188, v189
    v_fma_f32 v186, v106, s36, -v52
    v_fma_f32 v187, v107, s36, -v52
    v_exp_f32 v184, v184
    v_exp_f32 v185, v185
    v_add_f32 v58, v58, v190
    v_add_f32 v58, v58, v191
    v_cvt_pk_bf16_f32 v179, v190, v191
    v_fma_f32 v188, v108, s36, -v52
    v_fma_f32 v189, v109, s36, -v52
    v_exp_f32 v186, v186
    v_exp_f32 v187, v187
    v_add_f32 v58, v58, v184
    v_add_f32 v58, v58, v185
    v_cvt_pk_bf16_f32 v180, v184, v185
    v_fma_f32 v190, v110, s36, -v52
    v_fma_f32 v191, v111, s36, -v52
    v_exp_f32 v188, v188
    v_exp_f32 v189, v189
    v_add_f32 v58, v58, v186
    v_add_f32 v58, v58, v187
    v_cvt_pk_bf16_f32 v181, v186, v187
    v_exp_f32 v190, v190
    v_exp_f32 v191, v191
    v_add_f32 v58, v58, v188
    v_add_f32 v58, v58, v189
    v_cvt_pk_bf16_f32 v182, v188, v189
    v_add_f32 v58, v58, v190
    v_add_f32 v58, v58, v191
    v_cvt_pk_bf16_f32 v183, v190, v191
    ds_write_b128 v28, v[160:163] offset:0
    ds_write_b128 v28, v[164:167] offset:3072
    ds_write_b128 v28, v[168:171] offset:1024
    ds_write_b128 v28, v[172:175] offset:4096
    ds_write_b128 v28, v[176:179] offset:2048
    ds_write_b128 v28, v[180:183] offset:5120
    s_waitcnt lgkmcnt(0)
    s_branch Lpost_77

.section .rodata,"a"
.p2align 6
.amdhsa_kernel concat_heads__mha_block_cached__gqa_block_cached__near_ridge_kernel
  .amdhsa_next_free_vgpr 512
  .amdhsa_next_free_sgpr 102
  .amdhsa_accum_offset 256
  .amdhsa_group_segment_fixed_size 0
  .amdhsa_kernarg_size 104
  .amdhsa_user_sgpr_count 2
  .amdhsa_user_sgpr_kernarg_segment_ptr 1
  .amdhsa_system_sgpr_workgroup_id_x 1
.end_amdhsa_kernel
```
